```python
import torch

def _softmax(x, axis=-1):
    return torch.softmax(x, dim=axis)
def _gelu(x):
    return torch.nn.functional.gelu(x, approximate="tanh")
def _silu(x):
    return torch.nn.functional.silu(x)
def _sigmoid(x):
    return torch.sigmoid(x)
def _layernorm(x, axis=-1, eps=1e-5):
    m = x.mean(dim=axis, keepdim=True)
    v = x.var(dim=axis, keepdim=True, unbiased=False)
    return (x - m) / torch.sqrt(v + eps)
def _scatter_add(tgt, idx, src, axis=0):
    return tgt.clone().index_add_(axis, idx, src)
def _segment_sum(src, seg, n):
    out = torch.zeros((n,) + src.shape[1:], dtype=src.dtype)
    return out.index_add_(0, seg, src)
def _pad(x, pw):
    flat = tuple(v for pair in reversed(pw) for v in pair)
    return torch.nn.functional.pad(x, flat)

kernel_name = 'gated_mix__ssm_conv_s4__swiglu_ffn__prompt'

def setup_inputs():

    _w = (lambda a: (lambda t: t.to(torch.bfloat16) if t.is_floating_point() else t)(torch.as_tensor(a)))
    def _A_setup():
        B, L, D, N = 1, 2048, 576, 128
        A_re = -(lambda _x: torch.exp(torch.as_tensor(_x)))((lambda *s: torch.randn(*s, dtype=torch.bfloat16) * 3.2)(D, N))
        A_im = torch.pi * (lambda *s: torch.randn(*s, dtype=torch.bfloat16) * 0.05)(D, N)
        B_re = (lambda *s: torch.randn(*s, dtype=torch.bfloat16) * 0.1)(D, N)
        B_im = (lambda *s: torch.randn(*s, dtype=torch.bfloat16) * 0.1)(D, N)
        C_re = (lambda *s: torch.randn(*s, dtype=torch.bfloat16) * 0.1)(D, N)
        C_im = (lambda *s: torch.randn(*s, dtype=torch.bfloat16) * 0.1)(D, N)
        log_dt = (lambda *s: torch.randn(*s, dtype=torch.bfloat16) * 0.05)(D) * 0.5 - 4.0
        Dskip = (lambda *s: torch.randn(*s, dtype=torch.bfloat16) * 0.05)(D)
        return {
            "u": _w((lambda *s: torch.randn(*s, dtype=torch.bfloat16) * 0.05)(B, L, D)),
            "A_re": _w(A_re),
            "A_im": _w(A_im),
            "B_re": _w(B_re),
            "B_im": _w(B_im),
            "C_re": _w(C_re),
            "C_im": _w(C_im),
            "log_dt": _w(log_dt),
            "Dskip": _w(Dskip),
        }
    _A_in = _A_setup()

    def _B_setup():
        B, S, D, F = 1, 2048, 576, 4608
        return {
            "x": _w((lambda *s: torch.randn(*s, dtype=torch.bfloat16) * 0.05)(B, S, D)),
            "w_gate": _w((lambda *s: torch.randn(*s, dtype=torch.bfloat16) * 0.05)(D, F)),
            "w_up": _w((lambda *s: torch.randn(*s, dtype=torch.bfloat16) * 0.05)(D, F)),
            "w_down": _w((lambda *s: torch.randn(*s, dtype=torch.bfloat16) * 0.05)(F, D)),
        }
    _B_in = _B_setup()

    return {
        "A_u": _A_in["u"],
        "A_A_re": _A_in["A_re"],
        "A_A_im": _A_in["A_im"],
        "A_B_re": _A_in["B_re"],
        "A_B_im": _A_in["B_im"],
        "A_C_re": _A_in["C_re"],
        "A_C_im": _A_in["C_im"],
        "A_log_dt": _A_in["log_dt"],
        "A_Dskip": _A_in["Dskip"],
        "B_x": _B_in["x"],
        "B_w_gate": _B_in["w_gate"],
        "B_w_up": _B_in["w_up"],
        "B_w_down": _B_in["w_down"],
        "gate_w": _w((lambda *s: torch.randn(*s, dtype=torch.bfloat16) * 0.05)(576) * 16.0),
    }

def reference(A_u, A_A_re, A_A_im, A_B_re, A_B_im, A_C_re, A_C_im, A_log_dt, A_Dskip, B_x, B_w_gate, B_w_up, B_w_down, gate_w):
    def _A_ref(u, A_re, A_im, B_re, B_im, C_re, C_im, log_dt, Dskip):
        Bsz, L, D = u.shape
        dt = torch.exp(log_dt)[:, None]
        A = A_re + 1j * A_im
        Bc = B_re + 1j * B_im
        Cc = C_re + 1j * C_im
        logdA = dt * A
        dB = dt * Bc
        l = (lambda x, dt: x.to(dt))(torch.arange(L), A_re.dtype)
        P = torch.exp(logdA[:, :, None] * l[None, None, :])
        K = torch.einsum("dn,dnl,dn->dl", Cc, P, dB).real
        L2 = 2 * L
        Kp = _pad(K, ((0, 0), (0, L)))
        up = (lambda x, *d: x.permute(*d))(u, 0, 2, 1)
        up = _pad(up, ((0, 0), (0, 0), (0, L)))
        Kf = (lambda x, axes=(-2,-1): torch.fft.rfft2(x.float(), dim=axes))(Kp[:, None, :], axes=(-2, -1))
        Uf = (lambda x, axes=(-2,-1): torch.fft.rfft2(x.float(), dim=axes))(up[:, :, None, :], axes=(-2, -1))
        Yf = Uf * Kf[None, :, :, :]
        y = (lambda x, s, axes=(-2,-1): torch.fft.irfft2(x, s=s, dim=axes).to(torch.bfloat16))(Yf, (1, L2), axes=(-2, -1))[:, :, 0, :L]
        y = (lambda x, *d: x.permute(*d))(y, 0, 2, 1) + u * Dskip[None, None, :]
        return y

    def _B_ref(x, w_gate, w_up, w_down):
        g = _silu(x @ w_gate)
        u = x @ w_up
        return (g * u) @ w_down

    x = A_u
    g = _sigmoid((x * gate_w).sum(-1, keepdims=True))
    a = _A_ref(x, A_A_re, A_A_im, A_B_re, A_B_im, A_C_re, A_C_im, A_log_dt, A_Dskip)
    b = _B_ref(x, B_w_gate, B_w_up, B_w_down)
    return g * a + (1 - g) * b
```

```asm
; @launch grid=(256,1,1) block=(512,1,1) lds=163840
.amdgcn_target "amdgcn-amd-amdhsa--gfx950"
.text
.globl gated_mix__ssm_conv_s4__swiglu_ffn__prompt_kernel
.p2align 8
.type gated_mix__ssm_conv_s4__swiglu_ffn__prompt_kernel,@function
gated_mix__ssm_conv_s4__swiglu_ffn__prompt_kernel:
s_cmp_ge_u32 s2, 256
s_cbranch_scc1 Lend
s_load_dwordx16 s[4:19], s[0:1], 0
s_load_dwordx16 s[20:35], s[0:1], 64
s_load_dwordx2 s[36:37], s[0:1], 128
v_lshrrev_b32 v1, 6, v0
v_and_b32 v0, 63, v0
s_nop 0
v_readfirstlane_b32 s38, v1
s_and_b32 s60, s2, 7
s_lshr_b32 s61, s2, 3
s_and_b32 s62, s60, 1
s_lshl_b32 s62, s62, 3
s_and_b32 s63, s61, 7
s_add_u32 s52, s62, s63
s_lshr_b32 s62, s60, 1
s_lshl_b32 s62, s62, 2
s_lshr_b32 s63, s61, 3
s_add_u32 s53, s62, s63
s_and_b32 s54, s38, 3
s_lshr_b32 s55, s38, 2
s_mov_b32 s42, 0x240000
s_mov_b32 s43, 0x20000
s_cmp_eq_u32 s55, 0
s_mov_b32 s46, 0x510000
s_mov_b32 s47, 0x20000
s_mov_b32 s50, 0x1200000
s_mov_b32 s51, 0x20000
s_and_b32 s60, s53, 1
s_mul_i32 s61, s53, 9
s_add_u32 s62, s61, s60
s_lshl_b32 s56, s62, 6
s_add_u32 s63, s56, 512
s_sub_u32 s64, s56, 128
s_cmp_eq_u32 s60, 0
s_cselect_b32 s57, s63, s64
s_add_u32 s62, s62, s55
s_lshl_b32 s66, s62, 10
s_lshl_b32 s64, s55, 9
s_add_u32 s63, s61, 8
s_cmp_eq_u32 s60, 0
s_cselect_b32 s63, s63, s61
s_lshl_b32 s63, s63, 10
s_add_u32 s67, s63, s64
s_lshl_b32 s58, s38, 11
v_lshrrev_b32 v10, 3, v0
v_bfe_u32 v11, v0, 1, 2
v_bfe_u32 v12, v0, 4, 1
v_xor_b32 v11, v11, v12
s_lshl_b32 s60, s55, 1
v_xor_b32 v11, s60, v11
v_and_b32 v12, 1, v0
v_lshlrev_b32 v12, 4, v12
v_lshl_add_u32 v11, v11, 5, v12
s_lshl_b32 s60, s54, 4
v_add_u32 v12, s60, v10
v_mul_u32_u24 v12, 9216, v12
v_add_u32 v4, v11, v12
v_add_u32 v5, v11, v12
v_add_u32 v5, 72704, v5
s_lshl_b32 s60, s52, 7
s_lshl_b32 s61, s38, 4
s_add_u32 s60, s60, s61
v_add_u32 v12, s60, v10
v_mul_u32_u24 v12, 1152, v12
v_and_b32 v11, 7, v0
v_lshrrev_b32 v13, 4, v0
v_xor_b32 v11, v11, v13
v_lshl_add_u32 v6, v11, 4, v12
v_xor_b32 v11, 4, v11
v_lshl_add_u32 v7, v11, 4, v12
v_add_u32 v7, 8192, v7
s_add_u32 m0, s58, 0
s_movk_i32 s59, 0
s_waitcnt lgkmcnt(0)
s_mov_b32 s40, s4
s_mov_b32 s41, s5
s_cmp_eq_u32 s55, 0
s_cselect_b32 s44, s24, s26
s_cselect_b32 s45, s25, s27
s_mov_b32 s48, s36
s_mov_b32 s49, s37
buffer_load_dwordx4 v6, s[40:43], s59 offen lds
buffer_load_dwordx4 v7, s[40:43], s59 offen offset:1024 lds
s_add_u32 m0, s58, 16384
s_add_u32 s59, s56, 0
buffer_load_dwordx4 v4, s[44:47], s59 offen lds
buffer_load_dwordx4 v5, s[44:47], s59 offen offset:1024 lds
s_mov_b32 s84, s34
s_mov_b32 s85, s35
s_mov_b32 s86, 0x100
s_mov_b32 s87, 0x20000
s_xor_b32 s60, s2, 0
s_or_b32 s60, s60, s38
s_cmp_lg_u32 s60, 0
s_cbranch_scc1 Lnonon
s_memrealtime s[60:61]
v_mov_b32 v20, 0
s_waitcnt lgkmcnt(0)
s_or_b32 s60, s60, 1
v_mov_b32 v21, s60
s_mov_b64 exec, 1
buffer_store_dword v21, v20, s[84:87], 0 offen sc1
s_mov_b64 exec, -1
Lnonon:
s_mov_b32 s68, s30
s_mov_b32 s69, s31
s_mov_b32 s70, 0x480
s_mov_b32 s71, 0x20000
s_lshl_b32 s70, s52, 7
s_mov_b32 s70, 1152
s_lshl_b32 s72, s52, 7
s_lshl_b32 s73, s53, 3
s_add_u32 s72, s72, s73
s_add_u32 s72, s72, s38
s_mul_i32 s73, s72, 1152
v_lshlrev_b32 v48, 4, v0
v_add_u32 v49, 1024, v48
v_cmp_gt_u32 vcc, 8, v0
v_mov_b32 v50, 0x40000000
s_nop 0
v_cndmask_b32 v49, v50, v49, vcc
buffer_load_dwordx4 v[50:53], v48, s[40:43], s73 offen
buffer_load_dwordx4 v[54:57], v49, s[40:43], s73 offen
buffer_load_dwordx4 v[58:61], v48, s[68:71], 0 offen
buffer_load_dwordx4 v[62:65], v49, s[68:71], 0 offen
s_add_u32 m0, s58, 32768
s_movk_i32 s59, 128
buffer_load_dwordx4 v6, s[40:43], s59 offen lds
buffer_load_dwordx4 v7, s[40:43], s59 offen offset:1024 lds
s_add_u32 m0, s58, 49152
s_add_u32 s59, s56, 589824
buffer_load_dwordx4 v4, s[44:47], s59 offen lds
buffer_load_dwordx4 v5, s[44:47], s59 offen offset:1024 lds
s_add_u32 m0, s58, 65536
s_movk_i32 s59, 256
buffer_load_dwordx4 v6, s[40:43], s59 offen lds
buffer_load_dwordx4 v7, s[40:43], s59 offen offset:1024 lds
s_add_u32 m0, s58, 81920
s_add_u32 s59, s56, 1179648
buffer_load_dwordx4 v4, s[44:47], s59 offen lds
buffer_load_dwordx4 v5, s[44:47], s59 offen offset:1024 lds
s_add_u32 m0, s58, 98304
s_movk_i32 s59, 384
buffer_load_dwordx4 v6, s[40:43], s59 offen lds
buffer_load_dwordx4 v7, s[40:43], s59 offen offset:1024 lds
s_add_u32 m0, s58, 114688
s_add_u32 s59, s56, 1769472
buffer_load_dwordx4 v4, s[44:47], s59 offen lds
buffer_load_dwordx4 v5, s[44:47], s59 offen offset:1024 lds
s_add_u32 m0, s58, 131072
s_movk_i32 s59, 512
buffer_load_dwordx4 v6, s[40:43], s59 offen lds
buffer_load_dwordx4 v7, s[40:43], s59 offen offset:1024 lds
s_add_u32 m0, s58, 147456
s_add_u32 s59, s56, 2359296
buffer_load_dwordx4 v4, s[44:47], s59 offen lds
buffer_load_dwordx4 v5, s[44:47], s59 offen offset:1024 lds
s_mov_b32 s76, s24
s_mov_b32 s77, s25
s_mov_b32 s78, 0x510000
s_mov_b32 s79, 0x20000
s_lshl_b32 s61, s2, 3
s_add_u32 s61, s61, s38
s_mul_i32 s61, s61, 2688
v_lshlrev_b32 v1, 7, v0
v_cmp_gt_u32 vcc, 21, v0
v_mov_b32 v29, 0x40000000
s_nop 0
v_cndmask_b32 v1, v29, v1, vcc
buffer_load_dword v29, v1, s[76:79], s61 offen
s_mov_b32 s76, s26
s_mov_b32 s77, s27
s_mov_b32 s78, 0x510000
s_mov_b32 s79, 0x20000
s_lshl_b32 s61, s2, 3
s_add_u32 s61, s61, s38
s_mul_i32 s61, s61, 2688
v_lshlrev_b32 v1, 7, v0
v_cmp_gt_u32 vcc, 21, v0
v_mov_b32 v29, 0x40000000
s_nop 0
v_cndmask_b32 v1, v29, v1, vcc
buffer_load_dword v29, v1, s[76:79], s61 offen
s_and_b32 s60, s2, 7
s_lshr_b32 s61, s2, 3
s_cmp_eq_u32 s60, 7
s_cselect_b32 s62, 24, 30
s_cselect_b32 s63, 48, 12
s_mul_i32 s80, s61, 2
s_mul_i32 s81, s62, 2
s_add_u32 s81, s81, s61
s_sub_u32 s82, s38, 4
s_add_u32 s80, s80, s82
s_cmp_lt_u32 s82, 2
s_cselect_b32 s80, s80, 72
s_cmp_eq_u32 s82, 2
s_cselect_b32 s80, s81, s80
s_add_u32 s80, s80, s63
s_sub_u32 s61, s61, s62
s_cselect_b32 s63, 1, 0
s_mul_i32 s61, s61, 6
s_sub_u32 s62, 7, s38
s_add_u32 s61, s61, s62
s_cmp_lt_u32 s62, 6
s_cselect_b32 s61, s61, 72
s_cmp_eq_u32 s63, 1
s_cselect_b32 s80, s80, s61
s_cmp_lt_u32 s80, 72
s_cselect_b32 s82, 1, 0
s_min_u32 s80, s80, 71
s_mul_i32 s60, s60, 72
s_add_u32 s80, s80, s60
s_and_b32 s62, s38, 3
s_mul_i32 s81, s62, 18176
s_cmp_lt_u32 s38, 4
s_cselect_b32 s62, 81920, 0
s_add_u32 s81, s81, s62
v_bfe_u32 v10, v0, 4, 1
v_lshrrev_b32 v11, 5, v0
v_bfe_u32 v12, v0, 2, 2
v_and_b32 v13, 3, v0
v_lshl_add_u32 v14, v11, 3, v12
v_lshlrev_b32 v14, 7, v14
v_lshl_add_u32 v14, v10, 13, v14
v_lshl_add_u32 v14, v13, 3, v14
v_lshrrev_b32 v12, 1, v12
v_lshl_or_b32 v12, v10, 1, v12
s_lshl_b32 s60, s55, 1
v_xor_b32 v15, s60, v12
v_lshl_add_u32 v2, v15, 5, v14
v_xor_b32 v15, 1, v15
v_lshl_add_u32 v3, v15, 5, v14
s_and_b32 s60, s53, 1
s_lshl_b32 s60, s60, 1
s_add_u32 s60, s60, s55
v_xor_b32 v15, s60, v12
v_lshl_add_u32 v9, v15, 5, v14
v_and_b32 v10, 31, v0
s_lshl_b32 s60, s54, 5
v_add_u32 v12, s60, v10
v_bfe_u32 v13, v10, 1, 3
v_xor_b32 v13, v13, v11
v_lshlrev_b32 v13, 4, v13
v_lshl_add_u32 v80, v12, 7, v13
v_xor_b32 v81, 32, v80
v_xor_b32 v82, 64, v80
v_xor_b32 v83, 96, v80
s_lshl_b32 s60, s52, 3
s_lshl_b32 s61, s54, 1
s_add_u32 s60, s60, s61
v_bfe_u32 v12, v0, 4, 1
v_add_u32 v12, s60, v12
s_mov_b32 s60, 147456
v_mul_lo_u32 v12, v12, s60
v_and_b32 v13, 15, v0
v_lshl_add_u32 v12, v13, 4, v12
v_lshl_add_u32 v8, v11, 8, v12
s_and_b32 s60, s2, 7
s_lshr_b32 s61, s2, 3
s_mul_i32 s62, s60, 30
s_add_u32 s62, s62, s61
s_cmp_lt_u32 s62, 234
s_cselect_b32 s101, 1, 0
s_cmp_lt_u32 s61, 30
s_cselect_b32 s101, s101, 0
s_cmp_lt_u32 s38, 4
s_cselect_b32 s101, s101, 0
s_mul_hi_u32 s92, s62, 0x1c71c71d
s_mul_i32 s63, s92, 9
s_sub_u32 s93, s62, s63
s_mul_i32 s60, s92, 80
s_add_u32 s61, s60, 79
s_lshr_b32 s60, s60, 7
s_lshr_b32 s61, s61, 7
s_min_u32 s60, s60, 15
s_min_u32 s61, s61, 15
s_lshl_b32 s60, s60, 7
s_lshl_b32 s61, s61, 7
v_and_b32 v12, 15, v0
v_and_b32 v13, 16, v0
v_cmp_eq_u32 vcc, 0, v13
v_mov_b32 v13, s60
v_mov_b32 v14, s61
v_cndmask_b32 v13, v14, v13, vcc
v_lshl_add_u32 v13, v12, 2, v13
s_lshr_b32 s60, s80, 6
s_lshl_b32 s60, s60, 2
v_lshl_add_u32 v14, v12, 7, s60
s_cmp_eq_u32 s101, 1
s_cselect_b64 vcc, -1, 0
v_cndmask_b32 v30, v14, v13, vcc
s_lshl_b32 s60, s52, 7
s_lshl_b32 s61, s53, 2
s_add_u32 s52, s60, s61
s_cmp_eq_u32 s38, 0
s_cselect_b32 s60, s52, 0x40000000
v_mov_b32 v28, 0x40000000
v_mov_b32 v1, s60
v_cmp_eq_u32 vcc, 0, v0
s_lshr_b32 s52, s52, 7
s_nop 0
v_cndmask_b32 v28, v28, v1, vcc
v_bfe_u32 v12, v0, 2, 2
v_and_b32 v13, 3, v0
v_lshrrev_b32 v14, 4, v0
v_lshl_add_u32 v15, v14, 2, v13
v_lshl_add_u32 v15, v15, 3, v12
v_lshrrev_b32 v16, 1, v12
v_and_b32 v17, 1, v13
v_lshl_or_b32 v16, v17, 2, v16
v_xor_b32 v16, s38, v16
v_lshlrev_b32 v16, 4, v16
v_lshl_add_u32 v10, v15, 7, v16
s_lshl_b32 s60, s53, 1
s_sub_u32 s61, s60, 10
s_cmp_ge_u32 s60, 10
s_cselect_b32 s60, s61, s60
s_lshl_b32 s60, s60, 14
v_add_u32 v10, s60, v10
v_xor_b32 v11, 32, v10
v_lshl_add_u32 v14, v14, 2, v12
v_lshlrev_b32 v14, 4, v14
v_lshl_add_u32 v31, v13, 12, v14
s_lshl_b32 s74, s53, 18
s_lshl_b32 s60, s38, 15
s_add_u32 s74, s74, s60
s_lshl_b32 s60, s52, 8
s_add_u32 s74, s74, s60
s_add_u32 s75, s74, 0x4000
s_waitcnt vmcnt(18)
s_add_u32 s68, s36, 0x1680000
s_addc_u32 s69, s37, 0
s_mov_b32 s70, 0x2000
s_mov_b32 s71, 0x20000
v_mov_b32 v48, 0
v_dot2c_f32_bf16 v48, v50, v58
v_dot2c_f32_bf16 v48, v51, v59
v_dot2c_f32_bf16 v48, v52, v60
v_dot2c_f32_bf16 v48, v53, v61
v_dot2c_f32_bf16 v48, v54, v62
v_dot2c_f32_bf16 v48, v55, v63
v_dot2c_f32_bf16 v48, v56, v64
v_dot2c_f32_bf16 v48, v57, v65
s_nop 2
v_add_f32_dpp v48, v48, v48 row_shr:1 row_mask:0xf bank_mask:0xf
s_nop 1
v_add_f32_dpp v48, v48, v48 row_shr:2 row_mask:0xf bank_mask:0xf
s_nop 1
v_add_f32_dpp v48, v48, v48 row_shr:4 row_mask:0xf bank_mask:0xf
s_nop 1
v_add_f32_dpp v48, v48, v48 row_shr:8 row_mask:0xf bank_mask:0xf
s_nop 1
v_add_f32_dpp v48, v48, v48 row_bcast:15 row_mask:0xa bank_mask:0xf
s_nop 1
v_add_f32_dpp v48, v48, v48 row_bcast:31 row_mask:0xc bank_mask:0xf
s_nop 1
v_mul_f32 v48, 0xbfb8aa3b, v48
v_exp_f32 v48, v48
s_nop 0
v_add_f32 v48, 1.0, v48
v_rcp_f32 v48, v48
s_lshl_b32 s73, s72, 2
v_mov_b32 v49, 0x40000000
v_cmp_eq_u32 vcc, 63, v0
s_nop 1
v_cndmask_b32 v49, v49, 0, vcc
buffer_store_dword v48, v49, s[68:71], s73 offen sc1
s_add_u32 s68, s36, 0x1200000
s_addc_u32 s69, s37, 0
s_mov_b32 s70, 0x240000
s_mov_b32 s71, 0x20000
s_barrier
ds_read_b64_tr_b16 v[32:33], v2 offset:16384
ds_read_b64_tr_b16 v[34:35], v2 offset:16896
ds_read_b64_tr_b16 v[36:37], v3 offset:16384
ds_read_b64_tr_b16 v[38:39], v3 offset:16896
ds_read_b128 v[112:115], v80 offset:0
s_cmp_lg_u32 s53, 0
s_cbranch_scc1 Lxt1
ds_read_b64_tr_b16 v[12:13], v10 offset:0
ds_read_b64_tr_b16 v[14:15], v11 offset:512
ds_read_b64_tr_b16 v[16:17], v10 offset:8
ds_read_b64_tr_b16 v[18:19], v11 offset:520
s_waitcnt lgkmcnt(0)
buffer_store_dwordx4 v[12:15], v31, s[68:71], s74 offen sc1
buffer_store_dwordx4 v[16:19], v31, s[68:71], s75 offen sc1
Lxt1:
ds_read_b64_tr_b16 v[40:41], v2 offset:18432
ds_read_b64_tr_b16 v[42:43], v2 offset:18944
ds_read_b64_tr_b16 v[44:45], v3 offset:18432
ds_read_b64_tr_b16 v[46:47], v3 offset:18944
ds_read_b128 v[116:119], v81 offset:0
s_waitcnt lgkmcnt(5)
v_mfma_f32_32x32x16_bf16 v[48:63], v[32:35], v[112:115], 0
v_mfma_f32_32x32x16_bf16 v[64:79], v[36:39], v[112:115], 0
ds_read_b64_tr_b16 v[32:33], v2 offset:20480
ds_read_b64_tr_b16 v[34:35], v2 offset:20992
ds_read_b64_tr_b16 v[36:37], v3 offset:20480
ds_read_b64_tr_b16 v[38:39], v3 offset:20992
ds_read_b128 v[120:123], v82 offset:0
s_waitcnt lgkmcnt(5)
v_mfma_f32_32x32x16_bf16 v[48:63], v[40:43], v[116:119], v[48:63]
v_mfma_f32_32x32x16_bf16 v[64:79], v[44:47], v[116:119], v[64:79]
ds_read_b64_tr_b16 v[40:41], v2 offset:22528
ds_read_b64_tr_b16 v[42:43], v2 offset:23040
ds_read_b64_tr_b16 v[44:45], v3 offset:22528
ds_read_b64_tr_b16 v[46:47], v3 offset:23040
ds_read_b128 v[124:127], v83 offset:0
s_waitcnt lgkmcnt(5)
v_mfma_f32_32x32x16_bf16 v[48:63], v[32:35], v[120:123], v[48:63]
v_mfma_f32_32x32x16_bf16 v[64:79], v[36:39], v[120:123], v[64:79]
s_waitcnt lgkmcnt(0)
s_waitcnt vmcnt(15)
s_barrier
v_add_u32 v2, 0xc000, v2
v_add_u32 v3, 0xc000, v3
v_add_u32 v9, 0xc000, v9
ds_read_b64_tr_b16 v[32:33], v2 offset:0
ds_read_b64_tr_b16 v[34:35], v2 offset:512
ds_read_b64_tr_b16 v[36:37], v3 offset:0
ds_read_b64_tr_b16 v[38:39], v3 offset:512
ds_read_b128 v[128:131], v80 offset:32768
v_mfma_f32_32x32x16_bf16 v[48:63], v[40:43], v[124:127], v[48:63]
s_add_u32 m0, s58, 0
s_movk_i32 s59, 640
buffer_load_dwordx4 v6, s[40:43], s59 offen lds
buffer_load_dwordx4 v7, s[40:43], s59 offen offset:1024 lds
s_add_u32 m0, s58, 16384
s_add_u32 s59, s56, 2949120
buffer_load_dwordx4 v4, s[44:47], s59 offen lds
buffer_load_dwordx4 v5, s[44:47], s59 offen offset:1024 lds
v_mfma_f32_32x32x16_bf16 v[64:79], v[44:47], v[124:127], v[64:79]
s_cmp_lg_u32 s53, 1
s_cbranch_scc1 Lxt2
ds_read_b64_tr_b16 v[12:13], v10 offset:0
ds_read_b64_tr_b16 v[14:15], v11 offset:512
ds_read_b64_tr_b16 v[16:17], v10 offset:8
ds_read_b64_tr_b16 v[18:19], v11 offset:520
s_waitcnt lgkmcnt(0)
buffer_store_dwordx4 v[12:15], v31, s[68:71], s74 offen sc1
buffer_store_dwordx4 v[16:19], v31, s[68:71], s75 offen sc1
Lxt2:
ds_read_b64_tr_b16 v[40:41], v2 offset:2048
ds_read_b64_tr_b16 v[42:43], v2 offset:2560
ds_read_b64_tr_b16 v[44:45], v3 offset:2048
ds_read_b64_tr_b16 v[46:47], v3 offset:2560
ds_read_b128 v[132:135], v81 offset:32768
s_waitcnt lgkmcnt(5)
v_mfma_f32_32x32x16_bf16 v[48:63], v[32:35], v[128:131], v[48:63]
v_mfma_f32_32x32x16_bf16 v[64:79], v[36:39], v[128:131], v[64:79]
ds_read_b64_tr_b16 v[32:33], v2 offset:4096
ds_read_b64_tr_b16 v[34:35], v2 offset:4608
ds_read_b64_tr_b16 v[36:37], v3 offset:4096
ds_read_b64_tr_b16 v[38:39], v3 offset:4608
ds_read_b128 v[136:139], v82 offset:32768
s_waitcnt lgkmcnt(5)
v_mfma_f32_32x32x16_bf16 v[48:63], v[40:43], v[132:135], v[48:63]
v_mfma_f32_32x32x16_bf16 v[64:79], v[44:47], v[132:135], v[64:79]
ds_read_b64_tr_b16 v[40:41], v2 offset:6144
ds_read_b64_tr_b16 v[42:43], v2 offset:6656
ds_read_b64_tr_b16 v[44:45], v3 offset:6144
ds_read_b64_tr_b16 v[46:47], v3 offset:6656
ds_read_b128 v[140:143], v83 offset:32768
s_waitcnt lgkmcnt(5)
v_mfma_f32_32x32x16_bf16 v[48:63], v[32:35], v[136:139], v[48:63]
v_mfma_f32_32x32x16_bf16 v[64:79], v[36:39], v[136:139], v[64:79]
s_waitcnt lgkmcnt(0)
s_waitcnt vmcnt(15)
s_barrier
ds_read_b64_tr_b16 v[32:33], v2 offset:32768
ds_read_b64_tr_b16 v[34:35], v2 offset:33280
ds_read_b64_tr_b16 v[36:37], v3 offset:32768
ds_read_b64_tr_b16 v[38:39], v3 offset:33280
v_add_u32 v80, 0xc000, v80
v_add_u32 v81, 0xc000, v81
v_add_u32 v82, 0xc000, v82
v_add_u32 v83, 0xc000, v83
ds_read_b128 v[144:147], v80 offset:16384
v_mfma_f32_32x32x16_bf16 v[48:63], v[40:43], v[140:143], v[48:63]
s_add_u32 m0, s58, 32768
s_movk_i32 s59, 768
buffer_load_dwordx4 v6, s[40:43], s59 offen lds
buffer_load_dwordx4 v7, s[40:43], s59 offen offset:1024 lds
s_add_u32 m0, s58, 49152
s_add_u32 s59, s56, 3538944
buffer_load_dwordx4 v4, s[44:47], s59 offen lds
buffer_load_dwordx4 v5, s[44:47], s59 offen offset:1024 lds
v_mfma_f32_32x32x16_bf16 v[64:79], v[44:47], v[140:143], v[64:79]
s_cmp_lg_u32 s53, 2
s_cbranch_scc1 Lxt3
ds_read_b64_tr_b16 v[12:13], v10 offset:0
ds_read_b64_tr_b16 v[14:15], v11 offset:512
ds_read_b64_tr_b16 v[16:17], v10 offset:8
ds_read_b64_tr_b16 v[18:19], v11 offset:520
s_waitcnt lgkmcnt(0)
buffer_store_dwordx4 v[12:15], v31, s[68:71], s74 offen sc1
buffer_store_dwordx4 v[16:19], v31, s[68:71], s75 offen sc1
Lxt3:
ds_read_b64_tr_b16 v[40:41], v2 offset:34816
ds_read_b64_tr_b16 v[42:43], v2 offset:35328
ds_read_b64_tr_b16 v[44:45], v3 offset:34816
ds_read_b64_tr_b16 v[46:47], v3 offset:35328
ds_read_b128 v[148:151], v81 offset:16384
s_waitcnt lgkmcnt(5)
v_mfma_f32_32x32x16_bf16 v[48:63], v[32:35], v[144:147], v[48:63]
v_mfma_f32_32x32x16_bf16 v[64:79], v[36:39], v[144:147], v[64:79]
ds_read_b64_tr_b16 v[32:33], v2 offset:36864
ds_read_b64_tr_b16 v[34:35], v2 offset:37376
ds_read_b64_tr_b16 v[36:37], v3 offset:36864
ds_read_b64_tr_b16 v[38:39], v3 offset:37376
ds_read_b128 v[152:155], v82 offset:16384
s_waitcnt lgkmcnt(5)
v_mfma_f32_32x32x16_bf16 v[48:63], v[40:43], v[148:151], v[48:63]
v_mfma_f32_32x32x16_bf16 v[64:79], v[44:47], v[148:151], v[64:79]
ds_read_b64_tr_b16 v[40:41], v2 offset:38912
ds_read_b64_tr_b16 v[42:43], v2 offset:39424
ds_read_b64_tr_b16 v[44:45], v3 offset:38912
ds_read_b64_tr_b16 v[46:47], v3 offset:39424
ds_read_b128 v[156:159], v83 offset:16384
s_waitcnt lgkmcnt(5)
v_mfma_f32_32x32x16_bf16 v[48:63], v[32:35], v[152:155], v[48:63]
v_mfma_f32_32x32x16_bf16 v[64:79], v[36:39], v[152:155], v[64:79]
s_waitcnt lgkmcnt(0)
s_waitcnt vmcnt(15)
s_barrier
v_add_u32 v2, 0xc000, v2
v_add_u32 v3, 0xc000, v3
v_add_u32 v9, 0xc000, v9
ds_read_b64_tr_b16 v[32:33], v2 offset:16384
ds_read_b64_tr_b16 v[34:35], v2 offset:16896
ds_read_b64_tr_b16 v[36:37], v3 offset:16384
ds_read_b64_tr_b16 v[38:39], v3 offset:16896
v_add_u32 v80, 0xc000, v80
v_add_u32 v81, 0xc000, v81
v_add_u32 v82, 0xc000, v82
v_add_u32 v83, 0xc000, v83
ds_read_b128 v[160:163], v80 offset:0
v_mfma_f32_32x32x16_bf16 v[48:63], v[40:43], v[156:159], v[48:63]
s_add_u32 m0, s58, 65536
s_movk_i32 s59, 896
buffer_load_dwordx4 v6, s[40:43], s59 offen lds
buffer_load_dwordx4 v7, s[40:43], s59 offen offset:1024 lds
s_add_u32 m0, s58, 81920
s_add_u32 s59, s56, 4128768
buffer_load_dwordx4 v4, s[44:47], s59 offen lds
buffer_load_dwordx4 v5, s[44:47], s59 offen offset:1024 lds
v_mfma_f32_32x32x16_bf16 v[64:79], v[44:47], v[156:159], v[64:79]
s_cmp_lg_u32 s53, 3
s_cbranch_scc1 Lxt4
ds_read_b64_tr_b16 v[12:13], v10 offset:0
ds_read_b64_tr_b16 v[14:15], v11 offset:512
ds_read_b64_tr_b16 v[16:17], v10 offset:8
ds_read_b64_tr_b16 v[18:19], v11 offset:520
s_waitcnt lgkmcnt(0)
buffer_store_dwordx4 v[12:15], v31, s[68:71], s74 offen sc1
buffer_store_dwordx4 v[16:19], v31, s[68:71], s75 offen sc1
Lxt4:
ds_read_b64_tr_b16 v[40:41], v2 offset:18432
ds_read_b64_tr_b16 v[42:43], v2 offset:18944
ds_read_b64_tr_b16 v[44:45], v3 offset:18432
ds_read_b64_tr_b16 v[46:47], v3 offset:18944
ds_read_b128 v[164:167], v81 offset:0
s_waitcnt lgkmcnt(5)
v_mfma_f32_32x32x16_bf16 v[48:63], v[32:35], v[160:163], v[48:63]
v_mfma_f32_32x32x16_bf16 v[64:79], v[36:39], v[160:163], v[64:79]
ds_read_b64_tr_b16 v[32:33], v2 offset:20480
ds_read_b64_tr_b16 v[34:35], v2 offset:20992
ds_read_b64_tr_b16 v[36:37], v3 offset:20480
ds_read_b64_tr_b16 v[38:39], v3 offset:20992
ds_read_b128 v[168:171], v82 offset:0
s_waitcnt lgkmcnt(5)
v_mfma_f32_32x32x16_bf16 v[48:63], v[40:43], v[164:167], v[48:63]
v_mfma_f32_32x32x16_bf16 v[64:79], v[44:47], v[164:167], v[64:79]
ds_read_b64_tr_b16 v[40:41], v2 offset:22528
ds_read_b64_tr_b16 v[42:43], v2 offset:23040
ds_read_b64_tr_b16 v[44:45], v3 offset:22528
ds_read_b64_tr_b16 v[46:47], v3 offset:23040
ds_read_b128 v[172:175], v83 offset:0
s_waitcnt lgkmcnt(5)
v_mfma_f32_32x32x16_bf16 v[48:63], v[32:35], v[168:171], v[48:63]
v_mfma_f32_32x32x16_bf16 v[64:79], v[36:39], v[168:171], v[64:79]
s_waitcnt lgkmcnt(0)
s_waitcnt vmcnt(15)
s_barrier
v_add_u32 v2, 0xc000, v2
v_add_u32 v3, 0xc000, v3
v_add_u32 v9, 0xc000, v9
ds_read_b64_tr_b16 v[32:33], v2 offset:0
ds_read_b64_tr_b16 v[34:35], v2 offset:512
ds_read_b64_tr_b16 v[36:37], v3 offset:0
ds_read_b64_tr_b16 v[38:39], v3 offset:512
ds_read_b128 v[176:179], v80 offset:32768
v_mfma_f32_32x32x16_bf16 v[48:63], v[40:43], v[172:175], v[48:63]
s_add_u32 m0, s58, 98304
s_movk_i32 s59, 1024
buffer_load_dwordx4 v6, s[40:43], s59 offen lds
buffer_load_dwordx4 v7, s[40:43], s59 offen offset:1024 lds
s_add_u32 m0, s58, 114688
s_add_u32 s59, s56, 4718592
buffer_load_dwordx4 v4, s[44:47], s59 offen lds
buffer_load_dwordx4 v5, s[44:47], s59 offen offset:1024 lds
v_mfma_f32_32x32x16_bf16 v[64:79], v[44:47], v[172:175], v[64:79]
s_cmp_lg_u32 s53, 4
s_cbranch_scc1 Lxt5
ds_read_b64_tr_b16 v[12:13], v10 offset:0
ds_read_b64_tr_b16 v[14:15], v11 offset:512
ds_read_b64_tr_b16 v[16:17], v10 offset:8
ds_read_b64_tr_b16 v[18:19], v11 offset:520
s_waitcnt lgkmcnt(0)
buffer_store_dwordx4 v[12:15], v31, s[68:71], s74 offen sc1
buffer_store_dwordx4 v[16:19], v31, s[68:71], s75 offen sc1
Lxt5:
ds_read_b64_tr_b16 v[40:41], v2 offset:2048
ds_read_b64_tr_b16 v[42:43], v2 offset:2560
ds_read_b64_tr_b16 v[44:45], v3 offset:2048
ds_read_b64_tr_b16 v[46:47], v3 offset:2560
ds_read_b128 v[180:183], v81 offset:32768
s_waitcnt lgkmcnt(5)
v_mfma_f32_32x32x16_bf16 v[48:63], v[32:35], v[176:179], v[48:63]
v_mfma_f32_32x32x16_bf16 v[64:79], v[36:39], v[176:179], v[64:79]
ds_read_b64_tr_b16 v[32:33], v2 offset:4096
ds_read_b64_tr_b16 v[34:35], v2 offset:4608
ds_read_b64_tr_b16 v[36:37], v3 offset:4096
ds_read_b64_tr_b16 v[38:39], v3 offset:4608
ds_read_b128 v[184:187], v82 offset:32768
s_waitcnt lgkmcnt(5)
v_mfma_f32_32x32x16_bf16 v[48:63], v[40:43], v[180:183], v[48:63]
v_mfma_f32_32x32x16_bf16 v[64:79], v[44:47], v[180:183], v[64:79]
ds_read_b64_tr_b16 v[40:41], v2 offset:6144
ds_read_b64_tr_b16 v[42:43], v2 offset:6656
ds_read_b64_tr_b16 v[44:45], v3 offset:6144
ds_read_b64_tr_b16 v[46:47], v3 offset:6656
ds_read_b128 v[188:191], v83 offset:32768
s_waitcnt lgkmcnt(5)
v_mfma_f32_32x32x16_bf16 v[48:63], v[32:35], v[184:187], v[48:63]
v_mfma_f32_32x32x16_bf16 v[64:79], v[36:39], v[184:187], v[64:79]
s_waitcnt lgkmcnt(0)
s_waitcnt vmcnt(12)
s_barrier
v_add_u32 v2, 0xfffdc000, v2
v_add_u32 v3, 0xfffdc000, v3
v_add_u32 v9, 0xfffdc000, v9
ds_read_b64_tr_b16 v[32:33], v2 offset:16384
ds_read_b64_tr_b16 v[34:35], v2 offset:16896
ds_read_b64_tr_b16 v[36:37], v3 offset:16384
ds_read_b64_tr_b16 v[38:39], v3 offset:16896
v_add_u32 v80, 0xfffe8000, v80
v_add_u32 v81, 0xfffe8000, v81
v_add_u32 v82, 0xfffe8000, v82
v_add_u32 v83, 0xfffe8000, v83
ds_read_b128 v[192:195], v80 offset:0
v_mfma_f32_32x32x16_bf16 v[48:63], v[40:43], v[188:191], v[48:63]
s_add_u32 m0, s58, 131072
s_add_u32 s59, s56, 128
buffer_load_dwordx4 v4, s[44:47], s59 offen lds
buffer_load_dwordx4 v5, s[44:47], s59 offen offset:1024 lds
s_add_u32 m0, s58, 147456
s_add_u32 s59, s56, 589952
buffer_load_dwordx4 v4, s[44:47], s59 offen lds
buffer_load_dwordx4 v5, s[44:47], s59 offen offset:1024 lds
v_mfma_f32_32x32x16_bf16 v[64:79], v[44:47], v[188:191], v[64:79]
s_cmp_lg_u32 s53, 5
s_cbranch_scc1 Lxt6
ds_read_b64_tr_b16 v[12:13], v10 offset:0
ds_read_b64_tr_b16 v[14:15], v11 offset:512
ds_read_b64_tr_b16 v[16:17], v10 offset:8
ds_read_b64_tr_b16 v[18:19], v11 offset:520
s_waitcnt lgkmcnt(0)
buffer_store_dwordx4 v[12:15], v31, s[68:71], s74 offen sc1
buffer_store_dwordx4 v[16:19], v31, s[68:71], s75 offen sc1
Lxt6:
ds_read_b64_tr_b16 v[40:41], v2 offset:18432
ds_read_b64_tr_b16 v[42:43], v2 offset:18944
ds_read_b64_tr_b16 v[44:45], v3 offset:18432
ds_read_b64_tr_b16 v[46:47], v3 offset:18944
ds_read_b128 v[196:199], v81 offset:0
s_waitcnt lgkmcnt(5)
v_mfma_f32_32x32x16_bf16 v[48:63], v[32:35], v[192:195], v[48:63]
v_mfma_f32_32x32x16_bf16 v[64:79], v[36:39], v[192:195], v[64:79]
ds_read_b64_tr_b16 v[32:33], v2 offset:20480
ds_read_b64_tr_b16 v[34:35], v2 offset:20992
ds_read_b64_tr_b16 v[36:37], v3 offset:20480
ds_read_b64_tr_b16 v[38:39], v3 offset:20992
ds_read_b128 v[200:203], v82 offset:0
s_waitcnt lgkmcnt(5)
v_mfma_f32_32x32x16_bf16 v[48:63], v[40:43], v[196:199], v[48:63]
v_mfma_f32_32x32x16_bf16 v[64:79], v[44:47], v[196:199], v[64:79]
ds_read_b64_tr_b16 v[40:41], v2 offset:22528
ds_read_b64_tr_b16 v[42:43], v2 offset:23040
ds_read_b64_tr_b16 v[44:45], v3 offset:22528
ds_read_b64_tr_b16 v[46:47], v3 offset:23040
ds_read_b128 v[204:207], v83 offset:0
s_waitcnt lgkmcnt(5)
v_mfma_f32_32x32x16_bf16 v[48:63], v[32:35], v[200:203], v[48:63]
v_mfma_f32_32x32x16_bf16 v[64:79], v[36:39], v[200:203], v[64:79]
s_waitcnt lgkmcnt(0)
s_waitcnt vmcnt(12)
s_barrier
v_add_u32 v2, 0xc000, v2
v_add_u32 v3, 0xc000, v3
v_add_u32 v9, 0xc000, v9
ds_read_b64_tr_b16 v[32:33], v2 offset:0
ds_read_b64_tr_b16 v[34:35], v2 offset:512
ds_read_b64_tr_b16 v[36:37], v3 offset:0
ds_read_b64_tr_b16 v[38:39], v3 offset:512
ds_read_b128 v[208:211], v80 offset:32768
v_mfma_f32_32x32x16_bf16 v[48:63], v[40:43], v[204:207], v[48:63]
s_add_u32 m0, s58, 0
s_add_u32 s59, s56, 1179776
buffer_load_dwordx4 v4, s[44:47], s59 offen lds
buffer_load_dwordx4 v5, s[44:47], s59 offen offset:1024 lds
s_add_u32 m0, s58, 16384
s_add_u32 s59, s56, 1769600
buffer_load_dwordx4 v4, s[44:47], s59 offen lds
buffer_load_dwordx4 v5, s[44:47], s59 offen offset:1024 lds
v_mfma_f32_32x32x16_bf16 v[64:79], v[44:47], v[204:207], v[64:79]
s_cmp_lg_u32 s53, 6
s_cbranch_scc1 Lxt7
ds_read_b64_tr_b16 v[12:13], v10 offset:0
ds_read_b64_tr_b16 v[14:15], v11 offset:512
ds_read_b64_tr_b16 v[16:17], v10 offset:8
ds_read_b64_tr_b16 v[18:19], v11 offset:520
s_waitcnt lgkmcnt(0)
buffer_store_dwordx4 v[12:15], v31, s[68:71], s74 offen sc1
buffer_store_dwordx4 v[16:19], v31, s[68:71], s75 offen sc1
Lxt7:
ds_read_b64_tr_b16 v[40:41], v2 offset:2048
ds_read_b64_tr_b16 v[42:43], v2 offset:2560
ds_read_b64_tr_b16 v[44:45], v3 offset:2048
ds_read_b64_tr_b16 v[46:47], v3 offset:2560
ds_read_b128 v[212:215], v81 offset:32768
s_waitcnt lgkmcnt(5)
v_mfma_f32_32x32x16_bf16 v[48:63], v[32:35], v[208:211], v[48:63]
v_mfma_f32_32x32x16_bf16 v[64:79], v[36:39], v[208:211], v[64:79]
ds_read_b64_tr_b16 v[32:33], v2 offset:4096
ds_read_b64_tr_b16 v[34:35], v2 offset:4608
ds_read_b64_tr_b16 v[36:37], v3 offset:4096
ds_read_b64_tr_b16 v[38:39], v3 offset:4608
ds_read_b128 v[216:219], v82 offset:32768
s_waitcnt lgkmcnt(5)
v_mfma_f32_32x32x16_bf16 v[48:63], v[40:43], v[212:215], v[48:63]
v_mfma_f32_32x32x16_bf16 v[64:79], v[44:47], v[212:215], v[64:79]
ds_read_b64_tr_b16 v[40:41], v2 offset:6144
ds_read_b64_tr_b16 v[42:43], v2 offset:6656
ds_read_b64_tr_b16 v[44:45], v3 offset:6144
ds_read_b64_tr_b16 v[46:47], v3 offset:6656
ds_read_b128 v[220:223], v83 offset:32768
s_waitcnt lgkmcnt(5)
v_mfma_f32_32x32x16_bf16 v[48:63], v[32:35], v[216:219], v[48:63]
v_mfma_f32_32x32x16_bf16 v[64:79], v[36:39], v[216:219], v[64:79]
s_waitcnt lgkmcnt(0)
s_waitcnt vmcnt(12)
s_barrier
ds_read_b64_tr_b16 v[32:33], v2 offset:32768
ds_read_b64_tr_b16 v[34:35], v2 offset:33280
ds_read_b64_tr_b16 v[36:37], v3 offset:32768
ds_read_b64_tr_b16 v[38:39], v3 offset:33280
v_add_u32 v80, 0xc000, v80
v_add_u32 v81, 0xc000, v81
v_add_u32 v82, 0xc000, v82
v_add_u32 v83, 0xc000, v83
ds_read_b128 v[224:227], v80 offset:16384
v_mfma_f32_32x32x16_bf16 v[48:63], v[40:43], v[220:223], v[48:63]
s_add_u32 m0, s58, 32768
s_add_u32 s59, s56, 2359424
buffer_load_dwordx4 v4, s[44:47], s59 offen lds
buffer_load_dwordx4 v5, s[44:47], s59 offen offset:1024 lds
s_add_u32 m0, s58, 49152
s_add_u32 s59, s56, 2949248
buffer_load_dwordx4 v4, s[44:47], s59 offen lds
buffer_load_dwordx4 v5, s[44:47], s59 offen offset:1024 lds
v_mfma_f32_32x32x16_bf16 v[64:79], v[44:47], v[220:223], v[64:79]
s_cmp_lg_u32 s53, 7
s_cbranch_scc1 Lxt8
ds_read_b64_tr_b16 v[12:13], v10 offset:0
ds_read_b64_tr_b16 v[14:15], v11 offset:512
ds_read_b64_tr_b16 v[16:17], v10 offset:8
ds_read_b64_tr_b16 v[18:19], v11 offset:520
s_waitcnt lgkmcnt(0)
buffer_store_dwordx4 v[12:15], v31, s[68:71], s74 offen sc1
buffer_store_dwordx4 v[16:19], v31, s[68:71], s75 offen sc1
Lxt8:
ds_read_b64_tr_b16 v[40:41], v2 offset:34816
ds_read_b64_tr_b16 v[42:43], v2 offset:35328
ds_read_b64_tr_b16 v[44:45], v3 offset:34816
ds_read_b64_tr_b16 v[46:47], v3 offset:35328
ds_read_b128 v[228:231], v81 offset:16384
s_waitcnt lgkmcnt(5)
v_mfma_f32_32x32x16_bf16 v[48:63], v[32:35], v[224:227], v[48:63]
v_mfma_f32_32x32x16_bf16 v[64:79], v[36:39], v[224:227], v[64:79]
ds_read_b64_tr_b16 v[32:33], v2 offset:36864
ds_read_b64_tr_b16 v[34:35], v2 offset:37376
ds_read_b64_tr_b16 v[36:37], v3 offset:36864
ds_read_b64_tr_b16 v[38:39], v3 offset:37376
ds_read_b128 v[232:235], v82 offset:16384
s_waitcnt lgkmcnt(5)
v_mfma_f32_32x32x16_bf16 v[48:63], v[40:43], v[228:231], v[48:63]
v_mfma_f32_32x32x16_bf16 v[64:79], v[44:47], v[228:231], v[64:79]
ds_read_b64_tr_b16 v[40:41], v2 offset:38912
ds_read_b64_tr_b16 v[42:43], v2 offset:39424
ds_read_b64_tr_b16 v[44:45], v3 offset:38912
ds_read_b64_tr_b16 v[46:47], v3 offset:39424
ds_read_b128 v[236:239], v83 offset:16384
s_waitcnt lgkmcnt(5)
v_mfma_f32_32x32x16_bf16 v[48:63], v[32:35], v[232:235], v[48:63]
v_mfma_f32_32x32x16_bf16 v[64:79], v[36:39], v[232:235], v[64:79]
s_waitcnt lgkmcnt(0)
s_waitcnt vmcnt(12)
s_barrier
v_add_u32 v2, 0xc000, v2
v_add_u32 v3, 0xc000, v3
v_add_u32 v9, 0xc000, v9
ds_read_b64_tr_b16 v[32:33], v2 offset:16384
ds_read_b64_tr_b16 v[34:35], v2 offset:16896
ds_read_b64_tr_b16 v[36:37], v3 offset:16384
ds_read_b64_tr_b16 v[38:39], v3 offset:16896
v_add_u32 v80, 0xc000, v80
v_add_u32 v81, 0xc000, v81
v_add_u32 v82, 0xc000, v82
v_add_u32 v83, 0xc000, v83
ds_read_b128 v[240:243], v80 offset:0
v_mfma_f32_32x32x16_bf16 v[48:63], v[40:43], v[236:239], v[48:63]
s_add_u32 m0, s58, 65536
s_add_u32 s59, s56, 3539072
buffer_load_dwordx4 v4, s[44:47], s59 offen lds
buffer_load_dwordx4 v5, s[44:47], s59 offen offset:1024 lds
s_add_u32 m0, s58, 81920
s_add_u32 s59, s56, 4128896
buffer_load_dwordx4 v4, s[44:47], s59 offen lds
buffer_load_dwordx4 v5, s[44:47], s59 offen offset:1024 lds
v_mfma_f32_32x32x16_bf16 v[64:79], v[44:47], v[236:239], v[64:79]
s_cmp_lg_u32 s53, 8
s_cbranch_scc1 Lxt9
ds_read_b64_tr_b16 v[12:13], v10 offset:0
ds_read_b64_tr_b16 v[14:15], v11 offset:512
ds_read_b64_tr_b16 v[16:17], v10 offset:8
ds_read_b64_tr_b16 v[18:19], v11 offset:520
s_waitcnt lgkmcnt(0)
buffer_store_dwordx4 v[12:15], v31, s[68:71], s74 offen sc1
buffer_store_dwordx4 v[16:19], v31, s[68:71], s75 offen sc1
Lxt9:
ds_read_b64_tr_b16 v[40:41], v2 offset:18432
ds_read_b64_tr_b16 v[42:43], v2 offset:18944
ds_read_b64_tr_b16 v[44:45], v3 offset:18432
ds_read_b64_tr_b16 v[46:47], v3 offset:18944
ds_read_b128 v[244:247], v81 offset:0
s_waitcnt lgkmcnt(5)
v_mfma_f32_32x32x16_bf16 v[48:63], v[32:35], v[240:243], v[48:63]
v_mfma_f32_32x32x16_bf16 v[64:79], v[36:39], v[240:243], v[64:79]
ds_read_b64_tr_b16 v[32:33], v2 offset:20480
ds_read_b64_tr_b16 v[34:35], v2 offset:20992
ds_read_b64_tr_b16 v[36:37], v3 offset:20480
ds_read_b64_tr_b16 v[38:39], v3 offset:20992
ds_read_b128 v[248:251], v82 offset:0
s_waitcnt lgkmcnt(5)
v_mfma_f32_32x32x16_bf16 v[48:63], v[40:43], v[244:247], v[48:63]
v_mfma_f32_32x32x16_bf16 v[64:79], v[44:47], v[244:247], v[64:79]
ds_read_b64_tr_b16 v[40:41], v2 offset:22528
ds_read_b64_tr_b16 v[42:43], v2 offset:23040
ds_read_b64_tr_b16 v[44:45], v3 offset:22528
ds_read_b64_tr_b16 v[46:47], v3 offset:23040
ds_read_b128 v[252:255], v83 offset:0
s_waitcnt lgkmcnt(5)
v_mfma_f32_32x32x16_bf16 v[48:63], v[32:35], v[248:251], v[48:63]
v_mfma_f32_32x32x16_bf16 v[64:79], v[36:39], v[248:251], v[64:79]
s_waitcnt lgkmcnt(0)
s_waitcnt vmcnt(12)
s_barrier
ds_read_b64_tr_b16 v[32:33], v2 offset:32768
ds_read_b64_tr_b16 v[34:35], v2 offset:33280
ds_read_b64_tr_b16 v[36:37], v3 offset:32768
ds_read_b64_tr_b16 v[38:39], v3 offset:33280
v_mfma_f32_32x32x16_bf16 v[48:63], v[40:43], v[252:255], v[48:63]
s_add_u32 m0, s58, 98304
s_add_u32 s59, s56, 4718720
buffer_load_dwordx4 v4, s[44:47], s59 offen lds
buffer_load_dwordx4 v5, s[44:47], s59 offen offset:1024 lds
s_add_u32 m0, s58, 114688
s_add_u32 s59, s56, 256
buffer_load_dwordx4 v4, s[44:47], s59 offen lds
buffer_load_dwordx4 v5, s[44:47], s59 offen offset:1024 lds
v_mfma_f32_32x32x16_bf16 v[64:79], v[44:47], v[252:255], v[64:79]
ds_read_b64_tr_b16 v[40:41], v2 offset:34816
ds_read_b64_tr_b16 v[42:43], v2 offset:35328
ds_read_b64_tr_b16 v[44:45], v3 offset:34816
ds_read_b64_tr_b16 v[46:47], v3 offset:35328
s_waitcnt lgkmcnt(4)
v_mfma_f32_32x32x16_bf16 v[80:95], v[32:35], v[112:115], 0
ds_read_b64_tr_b16 v[32:33], v2 offset:36864
ds_read_b64_tr_b16 v[34:35], v2 offset:37376
v_mfma_f32_32x32x16_bf16 v[96:111], v[36:39], v[112:115], 0
ds_read_b64_tr_b16 v[36:37], v3 offset:36864
ds_read_b64_tr_b16 v[38:39], v3 offset:37376
s_waitcnt lgkmcnt(4)
v_mfma_f32_32x32x16_bf16 v[80:95], v[40:43], v[116:119], v[80:95]
ds_read_b64_tr_b16 v[40:41], v2 offset:38912
ds_read_b64_tr_b16 v[42:43], v2 offset:39424
v_mfma_f32_32x32x16_bf16 v[96:111], v[44:47], v[116:119], v[96:111]
ds_read_b64_tr_b16 v[44:45], v3 offset:38912
ds_read_b64_tr_b16 v[46:47], v3 offset:39424
s_waitcnt lgkmcnt(6)
v_mfma_f32_32x32x16_bf16 v[80:95], v[32:35], v[120:123], v[80:95]
v_add_u32 v2, 0xc000, v2
v_add_u32 v3, 0xc000, v3
v_add_u32 v9, 0xc000, v9
ds_read_b64_tr_b16 v[32:33], v2 offset:0
ds_read_b64_tr_b16 v[34:35], v2 offset:512
s_waitcnt lgkmcnt(6)
v_mfma_f32_32x32x16_bf16 v[96:111], v[36:39], v[120:123], v[96:111]
ds_read_b64_tr_b16 v[36:37], v3 offset:0
ds_read_b64_tr_b16 v[38:39], v3 offset:512
s_waitcnt lgkmcnt(6)
v_mfma_f32_32x32x16_bf16 v[80:95], v[40:43], v[124:127], v[80:95]
ds_read_b64_tr_b16 v[40:41], v2 offset:2048
ds_read_b64_tr_b16 v[42:43], v2 offset:2560
v_mul_f32 v12, 0xbfb8aa3b, v48
v_mul_f32 v13, 0xbfb8aa3b, v49
s_waitcnt lgkmcnt(6)
v_mfma_f32_32x32x16_bf16 v[96:111], v[44:47], v[124:127], v[96:111]
ds_read_b64_tr_b16 v[44:45], v3 offset:2048
ds_read_b64_tr_b16 v[46:47], v3 offset:2560
v_mul_f32 v14, 0xbfb8aa3b, v50
v_mul_f32 v15, 0xbfb8aa3b, v51
s_waitcnt lgkmcnt(6)
v_mfma_f32_32x32x16_bf16 v[80:95], v[32:35], v[128:131], v[80:95]
ds_read_b64_tr_b16 v[32:33], v2 offset:4096
ds_read_b64_tr_b16 v[34:35], v2 offset:4608
v_mul_f32 v16, 0xbfb8aa3b, v52
v_mul_f32 v17, 0xbfb8aa3b, v53
s_waitcnt lgkmcnt(6)
v_mfma_f32_32x32x16_bf16 v[96:111], v[36:39], v[128:131], v[96:111]
ds_read_b64_tr_b16 v[36:37], v3 offset:4096
ds_read_b64_tr_b16 v[38:39], v3 offset:4608
v_mul_f32 v18, 0xbfb8aa3b, v54
v_mul_f32 v19, 0xbfb8aa3b, v55
s_waitcnt lgkmcnt(6)
v_mfma_f32_32x32x16_bf16 v[80:95], v[40:43], v[132:135], v[80:95]
ds_read_b64_tr_b16 v[40:41], v2 offset:6144
ds_read_b64_tr_b16 v[42:43], v2 offset:6656
v_exp_f32 v12, v12
v_exp_f32 v13, v13
s_waitcnt lgkmcnt(6)
v_mfma_f32_32x32x16_bf16 v[96:111], v[44:47], v[132:135], v[96:111]
ds_read_b64_tr_b16 v[44:45], v3 offset:6144
ds_read_b64_tr_b16 v[46:47], v3 offset:6656
v_exp_f32 v14, v14
v_exp_f32 v15, v15
s_waitcnt vmcnt(12)
s_barrier
s_waitcnt lgkmcnt(6)
v_mfma_f32_32x32x16_bf16 v[80:95], v[32:35], v[136:139], v[80:95]
v_add_u32 v2, 0xfffdc000, v2
v_add_u32 v3, 0xfffdc000, v3
v_add_u32 v9, 0xfffdc000, v9
ds_read_b64_tr_b16 v[32:33], v2 offset:0
ds_read_b64_tr_b16 v[34:35], v2 offset:512
s_add_u32 m0, s58, 131072
s_add_u32 s59, s56, 590080
buffer_load_dwordx4 v4, s[44:47], s59 offen lds
buffer_load_dwordx4 v5, s[44:47], s59 offen offset:1024 lds
v_exp_f32 v16, v16
v_exp_f32 v17, v17
s_waitcnt lgkmcnt(6)
v_mfma_f32_32x32x16_bf16 v[96:111], v[36:39], v[136:139], v[96:111]
ds_read_b64_tr_b16 v[36:37], v3 offset:0
ds_read_b64_tr_b16 v[38:39], v3 offset:512
v_exp_f32 v18, v18
v_exp_f32 v19, v19
s_waitcnt lgkmcnt(6)
v_mfma_f32_32x32x16_bf16 v[80:95], v[40:43], v[140:143], v[80:95]
ds_read_b64_tr_b16 v[40:41], v2 offset:2048
ds_read_b64_tr_b16 v[42:43], v2 offset:2560
v_mul_f32 v56, v48, v56
v_mul_f32 v57, v49, v57
s_waitcnt lgkmcnt(6)
v_mfma_f32_32x32x16_bf16 v[96:111], v[44:47], v[140:143], v[96:111]
ds_read_b64_tr_b16 v[44:45], v3 offset:2048
ds_read_b64_tr_b16 v[46:47], v3 offset:2560
v_mul_f32 v58, v50, v58
v_mul_f32 v59, v51, v59
s_waitcnt lgkmcnt(6)
v_mfma_f32_32x32x16_bf16 v[80:95], v[32:35], v[144:147], v[80:95]
ds_read_b64_tr_b16 v[32:33], v2 offset:4096
ds_read_b64_tr_b16 v[34:35], v2 offset:4608
v_mul_f32 v60, v52, v60
v_mul_f32 v61, v53, v61
s_waitcnt lgkmcnt(6)
v_mfma_f32_32x32x16_bf16 v[96:111], v[36:39], v[144:147], v[96:111]
ds_read_b64_tr_b16 v[36:37], v3 offset:4096
ds_read_b64_tr_b16 v[38:39], v3 offset:4608
v_mul_f32 v62, v54, v62
v_mul_f32 v63, v55, v63
v_mov_b32 v10, 0
buffer_load_dword v31, v10, s[84:87], 0 offen offset:0 sc1
s_waitcnt lgkmcnt(6)
v_mfma_f32_32x32x16_bf16 v[80:95], v[40:43], v[148:151], v[80:95]
ds_read_b64_tr_b16 v[40:41], v2 offset:6144
ds_read_b64_tr_b16 v[42:43], v2 offset:6656
v_add_f32 v12, 1.0, v12
v_add_f32 v13, 1.0, v13
s_waitcnt lgkmcnt(6)
v_mfma_f32_32x32x16_bf16 v[96:111], v[44:47], v[148:151], v[96:111]
ds_read_b64_tr_b16 v[44:45], v3 offset:6144
ds_read_b64_tr_b16 v[46:47], v3 offset:6656
v_add_f32 v14, 1.0, v14
v_add_f32 v15, 1.0, v15
s_waitcnt lgkmcnt(6)
v_mfma_f32_32x32x16_bf16 v[80:95], v[32:35], v[152:155], v[80:95]
ds_read_b64_tr_b16 v[32:33], v2 offset:16384
ds_read_b64_tr_b16 v[34:35], v2 offset:16896
v_add_f32 v16, 1.0, v16
v_add_f32 v17, 1.0, v17
s_waitcnt lgkmcnt(6)
v_mfma_f32_32x32x16_bf16 v[96:111], v[36:39], v[152:155], v[96:111]
ds_read_b64_tr_b16 v[36:37], v3 offset:16384
ds_read_b64_tr_b16 v[38:39], v3 offset:16896
v_add_f32 v18, 1.0, v18
v_add_f32 v19, 1.0, v19
s_waitcnt lgkmcnt(6)
v_mfma_f32_32x32x16_bf16 v[80:95], v[40:43], v[156:159], v[80:95]
ds_read_b64_tr_b16 v[40:41], v2 offset:18432
ds_read_b64_tr_b16 v[42:43], v2 offset:18944
v_rcp_f32 v12, v12
v_rcp_f32 v13, v13
s_waitcnt lgkmcnt(6)
v_mfma_f32_32x32x16_bf16 v[96:111], v[44:47], v[156:159], v[96:111]
ds_read_b64_tr_b16 v[44:45], v3 offset:18432
ds_read_b64_tr_b16 v[46:47], v3 offset:18944
v_rcp_f32 v14, v14
v_rcp_f32 v15, v15
s_waitcnt lgkmcnt(6)
v_mfma_f32_32x32x16_bf16 v[80:95], v[32:35], v[160:163], v[80:95]
ds_read_b64_tr_b16 v[32:33], v2 offset:20480
ds_read_b64_tr_b16 v[34:35], v2 offset:20992
v_rcp_f32 v16, v16
v_rcp_f32 v17, v17
s_waitcnt lgkmcnt(6)
v_mfma_f32_32x32x16_bf16 v[96:111], v[36:39], v[160:163], v[96:111]
ds_read_b64_tr_b16 v[36:37], v3 offset:20480
ds_read_b64_tr_b16 v[38:39], v3 offset:20992
v_rcp_f32 v18, v18
v_rcp_f32 v19, v19
s_waitcnt lgkmcnt(6)
v_mfma_f32_32x32x16_bf16 v[80:95], v[40:43], v[164:167], v[80:95]
ds_read_b64_tr_b16 v[40:41], v2 offset:22528
ds_read_b64_tr_b16 v[42:43], v2 offset:23040
s_nop 0
v_mul_f32 v56, v56, v12
s_waitcnt lgkmcnt(6)
v_mfma_f32_32x32x16_bf16 v[96:111], v[44:47], v[164:167], v[96:111]
ds_read_b64_tr_b16 v[44:45], v3 offset:22528
ds_read_b64_tr_b16 v[46:47], v3 offset:23040
v_mul_f32 v57, v57, v13
v_mul_f32 v58, v58, v14
s_waitcnt vmcnt(11)
s_barrier
s_waitcnt lgkmcnt(6)
v_mfma_f32_32x32x16_bf16 v[80:95], v[32:35], v[168:171], v[80:95]
ds_read_b64_tr_b16 v[32:33], v2 offset:32768
ds_read_b64_tr_b16 v[34:35], v2 offset:33280
s_add_u32 m0, s58, 147456
s_add_u32 s59, s56, 1179904
buffer_load_dwordx4 v4, s[44:47], s59 offen lds
buffer_load_dwordx4 v5, s[44:47], s59 offen offset:1024 lds
v_mul_f32 v59, v59, v15
v_mul_f32 v60, v60, v16
s_waitcnt lgkmcnt(6)
v_mfma_f32_32x32x16_bf16 v[96:111], v[36:39], v[168:171], v[96:111]
ds_read_b64_tr_b16 v[36:37], v3 offset:32768
ds_read_b64_tr_b16 v[38:39], v3 offset:33280
v_mul_f32 v61, v61, v17
v_mul_f32 v62, v62, v18
s_waitcnt lgkmcnt(6)
v_mfma_f32_32x32x16_bf16 v[80:95], v[40:43], v[172:175], v[80:95]
ds_read_b64_tr_b16 v[40:41], v2 offset:34816
ds_read_b64_tr_b16 v[42:43], v2 offset:35328
s_add_u32 m0, s58, 0
s_add_u32 s59, s56, 1769728
buffer_load_dwordx4 v4, s[44:47], s59 offen lds
buffer_load_dwordx4 v5, s[44:47], s59 offen offset:1024 lds
v_mul_f32 v63, v63, v19
v_cvt_pk_bf16_f32 v20, v56, v57
s_waitcnt lgkmcnt(6)
v_mfma_f32_32x32x16_bf16 v[96:111], v[44:47], v[172:175], v[96:111]
ds_read_b64_tr_b16 v[44:45], v3 offset:34816
ds_read_b64_tr_b16 v[46:47], v3 offset:35328
v_cvt_pk_bf16_f32 v21, v58, v59
v_cvt_pk_bf16_f32 v22, v60, v61
s_waitcnt lgkmcnt(6)
v_mfma_f32_32x32x16_bf16 v[80:95], v[32:35], v[176:179], v[80:95]
ds_read_b64_tr_b16 v[32:33], v2 offset:36864
ds_read_b64_tr_b16 v[34:35], v2 offset:37376
v_cvt_pk_bf16_f32 v23, v62, v63
s_add_u32 s59, s66, 0
buffer_store_dwordx4 v[20:23], v8, s[48:51], s59 offen sc1
s_waitcnt lgkmcnt(6)
v_mfma_f32_32x32x16_bf16 v[96:111], v[36:39], v[176:179], v[96:111]
ds_read_b64_tr_b16 v[36:37], v3 offset:36864
ds_read_b64_tr_b16 v[38:39], v3 offset:37376
v_mul_f32 v12, 0xbfb8aa3b, v64
v_mul_f32 v13, 0xbfb8aa3b, v65
s_waitcnt lgkmcnt(6)
v_mfma_f32_32x32x16_bf16 v[80:95], v[40:43], v[180:183], v[80:95]
ds_read_b64_tr_b16 v[40:41], v2 offset:38912
ds_read_b64_tr_b16 v[42:43], v2 offset:39424
v_mul_f32 v14, 0xbfb8aa3b, v66
v_mul_f32 v15, 0xbfb8aa3b, v67
s_waitcnt lgkmcnt(6)
v_mfma_f32_32x32x16_bf16 v[96:111], v[44:47], v[180:183], v[96:111]
ds_read_b64_tr_b16 v[44:45], v3 offset:38912
ds_read_b64_tr_b16 v[46:47], v3 offset:39424
v_mul_f32 v16, 0xbfb8aa3b, v68
v_mul_f32 v17, 0xbfb8aa3b, v69
s_waitcnt lgkmcnt(6)
v_mfma_f32_32x32x16_bf16 v[80:95], v[32:35], v[184:187], v[80:95]
v_add_u32 v2, 0xc000, v2
v_add_u32 v3, 0xc000, v3
v_add_u32 v9, 0xc000, v9
ds_read_b64_tr_b16 v[32:33], v2 offset:0
ds_read_b64_tr_b16 v[34:35], v2 offset:512
v_mul_f32 v18, 0xbfb8aa3b, v70
v_mul_f32 v19, 0xbfb8aa3b, v71
s_waitcnt lgkmcnt(6)
v_mfma_f32_32x32x16_bf16 v[96:111], v[36:39], v[184:187], v[96:111]
ds_read_b64_tr_b16 v[36:37], v3 offset:0
ds_read_b64_tr_b16 v[38:39], v3 offset:512
v_exp_f32 v12, v12
v_exp_f32 v13, v13
s_waitcnt lgkmcnt(6)
v_mfma_f32_32x32x16_bf16 v[80:95], v[40:43], v[188:191], v[80:95]
ds_read_b64_tr_b16 v[40:41], v2 offset:2048
ds_read_b64_tr_b16 v[42:43], v2 offset:2560
v_exp_f32 v14, v14
v_exp_f32 v15, v15
s_waitcnt lgkmcnt(6)
v_mfma_f32_32x32x16_bf16 v[96:111], v[44:47], v[188:191], v[96:111]
ds_read_b64_tr_b16 v[44:45], v3 offset:2048
ds_read_b64_tr_b16 v[46:47], v3 offset:2560
v_exp_f32 v16, v16
v_exp_f32 v17, v17
s_waitcnt lgkmcnt(6)
v_mfma_f32_32x32x16_bf16 v[80:95], v[32:35], v[192:195], v[80:95]
ds_read_b64_tr_b16 v[32:33], v2 offset:4096
ds_read_b64_tr_b16 v[34:35], v2 offset:4608
v_exp_f32 v18, v18
v_exp_f32 v19, v19
s_waitcnt lgkmcnt(6)
v_mfma_f32_32x32x16_bf16 v[96:111], v[36:39], v[192:195], v[96:111]
ds_read_b64_tr_b16 v[36:37], v3 offset:4096
ds_read_b64_tr_b16 v[38:39], v3 offset:4608
v_mul_f32 v72, v64, v72
v_mul_f32 v73, v65, v73
s_waitcnt lgkmcnt(6)
v_mfma_f32_32x32x16_bf16 v[80:95], v[40:43], v[196:199], v[80:95]
ds_read_b64_tr_b16 v[40:41], v2 offset:6144
ds_read_b64_tr_b16 v[42:43], v2 offset:6656
v_mul_f32 v74, v66, v74
v_mul_f32 v75, v67, v75
s_waitcnt lgkmcnt(6)
v_mfma_f32_32x32x16_bf16 v[96:111], v[44:47], v[196:199], v[96:111]
ds_read_b64_tr_b16 v[44:45], v3 offset:6144
ds_read_b64_tr_b16 v[46:47], v3 offset:6656
v_mul_f32 v76, v68, v76
v_mul_f32 v77, v69, v77
s_waitcnt vmcnt(12)
s_barrier
s_waitcnt lgkmcnt(6)
v_mfma_f32_32x32x16_bf16 v[80:95], v[32:35], v[200:203], v[80:95]
ds_read_b64_tr_b16 v[32:33], v2 offset:16384
ds_read_b64_tr_b16 v[34:35], v2 offset:16896
s_add_u32 m0, s58, 16384
s_add_u32 s59, s56, 2359552
buffer_load_dwordx4 v4, s[44:47], s59 offen lds
buffer_load_dwordx4 v5, s[44:47], s59 offen offset:1024 lds
v_mul_f32 v78, v70, v78
v_mul_f32 v79, v71, v79
s_waitcnt lgkmcnt(6)
v_mfma_f32_32x32x16_bf16 v[96:111], v[36:39], v[200:203], v[96:111]
ds_read_b64_tr_b16 v[36:37], v3 offset:16384
ds_read_b64_tr_b16 v[38:39], v3 offset:16896
v_add_f32 v12, 1.0, v12
v_add_f32 v13, 1.0, v13
s_waitcnt lgkmcnt(6)
v_mfma_f32_32x32x16_bf16 v[80:95], v[40:43], v[204:207], v[80:95]
ds_read_b64_tr_b16 v[40:41], v2 offset:18432
ds_read_b64_tr_b16 v[42:43], v2 offset:18944
s_add_u32 m0, s58, 32768
s_add_u32 s59, s56, 2949376
buffer_load_dwordx4 v4, s[44:47], s59 offen lds
buffer_load_dwordx4 v5, s[44:47], s59 offen offset:1024 lds
v_add_f32 v14, 1.0, v14
v_add_f32 v15, 1.0, v15
s_waitcnt lgkmcnt(6)
v_mfma_f32_32x32x16_bf16 v[96:111], v[44:47], v[204:207], v[96:111]
ds_read_b64_tr_b16 v[44:45], v3 offset:18432
ds_read_b64_tr_b16 v[46:47], v3 offset:18944
v_add_f32 v16, 1.0, v16
v_add_f32 v17, 1.0, v17
s_waitcnt lgkmcnt(6)
v_mfma_f32_32x32x16_bf16 v[80:95], v[32:35], v[208:211], v[80:95]
ds_read_b64_tr_b16 v[32:33], v2 offset:20480
ds_read_b64_tr_b16 v[34:35], v2 offset:20992
v_add_f32 v18, 1.0, v18
v_add_f32 v19, 1.0, v19
s_waitcnt lgkmcnt(6)
v_mfma_f32_32x32x16_bf16 v[96:111], v[36:39], v[208:211], v[96:111]
ds_read_b64_tr_b16 v[36:37], v3 offset:20480
ds_read_b64_tr_b16 v[38:39], v3 offset:20992
v_rcp_f32 v12, v12
v_rcp_f32 v13, v13
s_waitcnt lgkmcnt(6)
v_mfma_f32_32x32x16_bf16 v[80:95], v[40:43], v[212:215], v[80:95]
ds_read_b64_tr_b16 v[40:41], v2 offset:22528
ds_read_b64_tr_b16 v[42:43], v2 offset:23040
v_rcp_f32 v14, v14
v_rcp_f32 v15, v15
s_waitcnt lgkmcnt(6)
v_mfma_f32_32x32x16_bf16 v[96:111], v[44:47], v[212:215], v[96:111]
ds_read_b64_tr_b16 v[44:45], v3 offset:22528
ds_read_b64_tr_b16 v[46:47], v3 offset:23040
v_rcp_f32 v16, v16
v_rcp_f32 v17, v17
s_waitcnt lgkmcnt(6)
v_mfma_f32_32x32x16_bf16 v[80:95], v[32:35], v[216:219], v[80:95]
ds_read_b64_tr_b16 v[32:33], v2 offset:32768
ds_read_b64_tr_b16 v[34:35], v2 offset:33280
v_rcp_f32 v18, v18
v_rcp_f32 v19, v19
s_waitcnt lgkmcnt(6)
v_mfma_f32_32x32x16_bf16 v[96:111], v[36:39], v[216:219], v[96:111]
ds_read_b64_tr_b16 v[36:37], v3 offset:32768
ds_read_b64_tr_b16 v[38:39], v3 offset:33280
s_nop 0
v_mul_f32 v72, v72, v12
s_waitcnt lgkmcnt(6)
v_mfma_f32_32x32x16_bf16 v[80:95], v[40:43], v[220:223], v[80:95]
ds_read_b64_tr_b16 v[40:41], v2 offset:34816
ds_read_b64_tr_b16 v[42:43], v2 offset:35328
v_mul_f32 v73, v73, v13
v_mul_f32 v74, v74, v14
s_waitcnt lgkmcnt(6)
v_mfma_f32_32x32x16_bf16 v[96:111], v[44:47], v[220:223], v[96:111]
ds_read_b64_tr_b16 v[44:45], v3 offset:34816
ds_read_b64_tr_b16 v[46:47], v3 offset:35328
v_mul_f32 v75, v75, v15
v_mul_f32 v76, v76, v16
s_waitcnt lgkmcnt(6)
v_mfma_f32_32x32x16_bf16 v[80:95], v[32:35], v[224:227], v[80:95]
ds_read_b64_tr_b16 v[32:33], v2 offset:36864
ds_read_b64_tr_b16 v[34:35], v2 offset:37376
v_mul_f32 v77, v77, v17
v_mul_f32 v78, v78, v18
s_waitcnt lgkmcnt(6)
v_mfma_f32_32x32x16_bf16 v[96:111], v[36:39], v[224:227], v[96:111]
ds_read_b64_tr_b16 v[36:37], v3 offset:36864
ds_read_b64_tr_b16 v[38:39], v3 offset:37376
v_mul_f32 v79, v79, v19
v_cvt_pk_bf16_f32 v24, v72, v73
s_waitcnt lgkmcnt(6)
v_mfma_f32_32x32x16_bf16 v[80:95], v[40:43], v[228:231], v[80:95]
ds_read_b64_tr_b16 v[40:41], v2 offset:38912
ds_read_b64_tr_b16 v[42:43], v2 offset:39424
v_cvt_pk_bf16_f32 v25, v74, v75
v_cvt_pk_bf16_f32 v26, v76, v77
s_waitcnt lgkmcnt(6)
v_mfma_f32_32x32x16_bf16 v[96:111], v[44:47], v[228:231], v[96:111]
ds_read_b64_tr_b16 v[44:45], v3 offset:38912
ds_read_b64_tr_b16 v[46:47], v3 offset:39424
v_cvt_pk_bf16_f32 v27, v78, v79
s_add_u32 s59, s66, 512
buffer_store_dwordx4 v[24:27], v8, s[48:51], s59 offen sc1
s_waitcnt vmcnt(13)
s_barrier
s_waitcnt lgkmcnt(6)
v_mfma_f32_32x32x16_bf16 v[80:95], v[32:35], v[232:235], v[80:95]
v_add_u32 v2, 0xc000, v2
v_add_u32 v3, 0xc000, v3
v_add_u32 v9, 0xc000, v9
ds_read_b64_tr_b16 v[32:33], v2 offset:0
ds_read_b64_tr_b16 v[34:35], v2 offset:512
s_add_u32 m0, s58, 49152
s_add_u32 s59, s56, 3539200
buffer_load_dwordx4 v4, s[44:47], s59 offen lds
buffer_load_dwordx4 v5, s[44:47], s59 offen offset:1024 lds
s_waitcnt lgkmcnt(6)
v_mfma_f32_32x32x16_bf16 v[96:111], v[36:39], v[232:235], v[96:111]
ds_read_b64_tr_b16 v[36:37], v3 offset:0
ds_read_b64_tr_b16 v[38:39], v3 offset:512
s_waitcnt lgkmcnt(6)
v_mfma_f32_32x32x16_bf16 v[80:95], v[40:43], v[236:239], v[80:95]
ds_read_b64_tr_b16 v[40:41], v2 offset:2048
ds_read_b64_tr_b16 v[42:43], v2 offset:2560
s_add_u32 m0, s58, 65536
s_add_u32 s59, s56, 4129024
buffer_load_dwordx4 v4, s[44:47], s59 offen lds
buffer_load_dwordx4 v5, s[44:47], s59 offen offset:1024 lds
s_waitcnt lgkmcnt(6)
v_mfma_f32_32x32x16_bf16 v[96:111], v[44:47], v[236:239], v[96:111]
ds_read_b64_tr_b16 v[44:45], v3 offset:2048
ds_read_b64_tr_b16 v[46:47], v3 offset:2560
s_waitcnt lgkmcnt(6)
v_mfma_f32_32x32x16_bf16 v[80:95], v[32:35], v[240:243], v[80:95]
ds_read_b64_tr_b16 v[32:33], v2 offset:4096
ds_read_b64_tr_b16 v[34:35], v2 offset:4608
s_waitcnt lgkmcnt(6)
v_mfma_f32_32x32x16_bf16 v[96:111], v[36:39], v[240:243], v[96:111]
ds_read_b64_tr_b16 v[36:37], v3 offset:4096
ds_read_b64_tr_b16 v[38:39], v3 offset:4608
s_waitcnt lgkmcnt(6)
v_mfma_f32_32x32x16_bf16 v[80:95], v[40:43], v[244:247], v[80:95]
ds_read_b64_tr_b16 v[40:41], v2 offset:6144
ds_read_b64_tr_b16 v[42:43], v2 offset:6656
s_waitcnt lgkmcnt(6)
v_mfma_f32_32x32x16_bf16 v[96:111], v[44:47], v[244:247], v[96:111]
ds_read_b64_tr_b16 v[44:45], v3 offset:6144
ds_read_b64_tr_b16 v[46:47], v3 offset:6656
s_waitcnt lgkmcnt(6)
v_mfma_f32_32x32x16_bf16 v[80:95], v[32:35], v[248:251], v[80:95]
ds_read_b64_tr_b16 v[32:33], v2 offset:16384
ds_read_b64_tr_b16 v[34:35], v2 offset:16896
s_waitcnt lgkmcnt(6)
v_mfma_f32_32x32x16_bf16 v[96:111], v[36:39], v[248:251], v[96:111]
ds_read_b64_tr_b16 v[36:37], v3 offset:16384
ds_read_b64_tr_b16 v[38:39], v3 offset:16896
s_waitcnt lgkmcnt(6)
v_mfma_f32_32x32x16_bf16 v[80:95], v[40:43], v[252:255], v[80:95]
ds_read_b64_tr_b16 v[40:41], v2 offset:18432
ds_read_b64_tr_b16 v[42:43], v2 offset:18944
s_waitcnt lgkmcnt(6)
v_mfma_f32_32x32x16_bf16 v[96:111], v[44:47], v[252:255], v[96:111]
ds_read_b64_tr_b16 v[44:45], v3 offset:18432
ds_read_b64_tr_b16 v[46:47], v3 offset:18944
s_waitcnt lgkmcnt(6)
v_mfma_f32_32x32x16_bf16 v[48:63], v[32:35], v[112:115], 0
ds_read_b64_tr_b16 v[32:33], v2 offset:20480
ds_read_b64_tr_b16 v[34:35], v2 offset:20992
s_waitcnt lgkmcnt(6)
v_mfma_f32_32x32x16_bf16 v[64:79], v[36:39], v[112:115], 0
ds_read_b64_tr_b16 v[36:37], v3 offset:20480
ds_read_b64_tr_b16 v[38:39], v3 offset:20992
s_mov_b32 s76, s28
s_mov_b32 s77, s29
s_mov_b32 s78, 0x510000
s_mov_b32 s79, 0x20000
s_lshl_b32 s61, s2, 3
s_add_u32 s61, s61, s38
s_mul_i32 s61, s61, 2688
v_lshlrev_b32 v1, 7, v0
v_cmp_gt_u32 vcc, 21, v0
v_mov_b32 v29, 0x40000000
s_nop 0
v_cndmask_b32 v1, v29, v1, vcc
buffer_load_dword v29, v1, s[76:79], s61 offen
s_waitcnt lgkmcnt(6)
v_mfma_f32_32x32x16_bf16 v[48:63], v[40:43], v[116:119], v[48:63]
ds_read_b64_tr_b16 v[40:41], v2 offset:22528
ds_read_b64_tr_b16 v[42:43], v2 offset:23040
s_waitcnt lgkmcnt(6)
v_mfma_f32_32x32x16_bf16 v[64:79], v[44:47], v[116:119], v[64:79]
ds_read_b64_tr_b16 v[44:45], v3 offset:22528
ds_read_b64_tr_b16 v[46:47], v3 offset:23040
s_waitcnt vmcnt(13)
s_barrier
s_waitcnt lgkmcnt(6)
v_mfma_f32_32x32x16_bf16 v[48:63], v[32:35], v[120:123], v[48:63]
ds_read_b64_tr_b16 v[32:33], v2 offset:32768
ds_read_b64_tr_b16 v[34:35], v2 offset:33280
s_add_u32 m0, s58, 81920
s_add_u32 s59, s56, 4718848
buffer_load_dwordx4 v4, s[44:47], s59 offen lds
buffer_load_dwordx4 v5, s[44:47], s59 offen offset:1024 lds
s_waitcnt lgkmcnt(6)
v_mfma_f32_32x32x16_bf16 v[64:79], v[36:39], v[120:123], v[64:79]
ds_read_b64_tr_b16 v[36:37], v3 offset:32768
ds_read_b64_tr_b16 v[38:39], v3 offset:33280
s_waitcnt lgkmcnt(6)
v_mfma_f32_32x32x16_bf16 v[48:63], v[40:43], v[124:127], v[48:63]
ds_read_b64_tr_b16 v[40:41], v2 offset:34816
ds_read_b64_tr_b16 v[42:43], v2 offset:35328
s_add_u32 m0, s58, 98304
s_add_u32 s59, s56, 384
buffer_load_dwordx4 v4, s[44:47], s59 offen lds
buffer_load_dwordx4 v5, s[44:47], s59 offen offset:1024 lds
v_mul_f32 v12, 0xbfb8aa3b, v80
v_mul_f32 v13, 0xbfb8aa3b, v81
s_waitcnt lgkmcnt(6)
v_mfma_f32_32x32x16_bf16 v[64:79], v[44:47], v[124:127], v[64:79]
ds_read_b64_tr_b16 v[44:45], v3 offset:34816
ds_read_b64_tr_b16 v[46:47], v3 offset:35328
v_mul_f32 v14, 0xbfb8aa3b, v82
v_mul_f32 v15, 0xbfb8aa3b, v83
s_waitcnt lgkmcnt(6)
v_mfma_f32_32x32x16_bf16 v[48:63], v[32:35], v[128:131], v[48:63]
ds_read_b64_tr_b16 v[32:33], v2 offset:36864
ds_read_b64_tr_b16 v[34:35], v2 offset:37376
v_mul_f32 v16, 0xbfb8aa3b, v84
v_mul_f32 v17, 0xbfb8aa3b, v85
s_waitcnt lgkmcnt(6)
v_mfma_f32_32x32x16_bf16 v[64:79], v[36:39], v[128:131], v[64:79]
ds_read_b64_tr_b16 v[36:37], v3 offset:36864
ds_read_b64_tr_b16 v[38:39], v3 offset:37376
v_mul_f32 v18, 0xbfb8aa3b, v86
v_mul_f32 v19, 0xbfb8aa3b, v87
s_waitcnt lgkmcnt(6)
v_mfma_f32_32x32x16_bf16 v[48:63], v[40:43], v[132:135], v[48:63]
ds_read_b64_tr_b16 v[40:41], v2 offset:38912
ds_read_b64_tr_b16 v[42:43], v2 offset:39424
v_exp_f32 v12, v12
v_exp_f32 v13, v13
s_waitcnt lgkmcnt(6)
v_mfma_f32_32x32x16_bf16 v[64:79], v[44:47], v[132:135], v[64:79]
ds_read_b64_tr_b16 v[44:45], v3 offset:38912
ds_read_b64_tr_b16 v[46:47], v3 offset:39424
v_exp_f32 v14, v14
v_exp_f32 v15, v15
s_waitcnt lgkmcnt(6)
v_mfma_f32_32x32x16_bf16 v[48:63], v[32:35], v[136:139], v[48:63]
v_add_u32 v2, 0xc000, v2
v_add_u32 v3, 0xc000, v3
v_add_u32 v9, 0xc000, v9
ds_read_b64_tr_b16 v[32:33], v2 offset:0
ds_read_b64_tr_b16 v[34:35], v2 offset:512
v_exp_f32 v16, v16
v_exp_f32 v17, v17
s_waitcnt lgkmcnt(6)
v_mfma_f32_32x32x16_bf16 v[64:79], v[36:39], v[136:139], v[64:79]
ds_read_b64_tr_b16 v[36:37], v3 offset:0
ds_read_b64_tr_b16 v[38:39], v3 offset:512
v_exp_f32 v18, v18
v_exp_f32 v19, v19
s_waitcnt lgkmcnt(6)
v_mfma_f32_32x32x16_bf16 v[48:63], v[40:43], v[140:143], v[48:63]
ds_read_b64_tr_b16 v[40:41], v2 offset:2048
ds_read_b64_tr_b16 v[42:43], v2 offset:2560
v_mul_f32 v88, v80, v88
v_mul_f32 v89, v81, v89
s_waitcnt lgkmcnt(6)
v_mfma_f32_32x32x16_bf16 v[64:79], v[44:47], v[140:143], v[64:79]
ds_read_b64_tr_b16 v[44:45], v3 offset:2048
ds_read_b64_tr_b16 v[46:47], v3 offset:2560
v_mul_f32 v90, v82, v90
v_mul_f32 v91, v83, v91
s_waitcnt lgkmcnt(6)
v_mfma_f32_32x32x16_bf16 v[48:63], v[32:35], v[144:147], v[48:63]
ds_read_b64_tr_b16 v[32:33], v2 offset:4096
ds_read_b64_tr_b16 v[34:35], v2 offset:4608
v_mul_f32 v92, v84, v92
v_mul_f32 v93, v85, v93
s_waitcnt lgkmcnt(6)
v_mfma_f32_32x32x16_bf16 v[64:79], v[36:39], v[144:147], v[64:79]
ds_read_b64_tr_b16 v[36:37], v3 offset:4096
ds_read_b64_tr_b16 v[38:39], v3 offset:4608
v_mul_f32 v94, v86, v94
v_mul_f32 v95, v87, v95
v_cmp_eq_u32 vcc, 0, v31
s_nop 1
s_cbranch_vccz Lok10
s_mov_b32 s83, 20000
Llp11:
buffer_load_dword v31, v10, s[84:87], 0 offen offset:0 sc1
s_sub_u32 s83, s83, 1
s_cbranch_scc1 Lok10
s_waitcnt vmcnt(0)
v_cmp_eq_u32 vcc, 0, v31
s_nop 1
s_cbranch_vccnz Llp11
Lok10:
v_readfirstlane_b32 s100, v31
s_add_u32 s84, s36, 0x1690000
s_addc_u32 s85, s37, 0
s_mov_b32 s86, 0x4000
s_mov_b32 s87, 0x20000
s_waitcnt lgkmcnt(6)
v_mfma_f32_32x32x16_bf16 v[48:63], v[40:43], v[148:151], v[48:63]
ds_read_b64_tr_b16 v[40:41], v2 offset:6144
ds_read_b64_tr_b16 v[42:43], v2 offset:6656
v_add_f32 v12, 1.0, v12
v_add_f32 v13, 1.0, v13
s_waitcnt lgkmcnt(6)
v_mfma_f32_32x32x16_bf16 v[64:79], v[44:47], v[148:151], v[64:79]
ds_read_b64_tr_b16 v[44:45], v3 offset:6144
ds_read_b64_tr_b16 v[46:47], v3 offset:6656
v_add_f32 v14, 1.0, v14
v_add_f32 v15, 1.0, v15
s_waitcnt vmcnt(12)
s_barrier
s_waitcnt lgkmcnt(6)
v_mfma_f32_32x32x16_bf16 v[48:63], v[32:35], v[152:155], v[48:63]
v_add_u32 v2, 0xfffdc000, v2
v_add_u32 v3, 0xfffdc000, v3
v_add_u32 v9, 0xfffdc000, v9
ds_read_b64_tr_b16 v[32:33], v2 offset:0
ds_read_b64_tr_b16 v[34:35], v2 offset:512
s_add_u32 m0, s58, 114688
s_add_u32 s59, s56, 590208
buffer_load_dwordx4 v4, s[44:47], s59 offen lds
buffer_load_dwordx4 v5, s[44:47], s59 offen offset:1024 lds
v_add_f32 v16, 1.0, v16
v_add_f32 v17, 1.0, v17
s_waitcnt lgkmcnt(6)
v_mfma_f32_32x32x16_bf16 v[64:79], v[36:39], v[152:155], v[64:79]
ds_read_b64_tr_b16 v[36:37], v3 offset:0
ds_read_b64_tr_b16 v[38:39], v3 offset:512
v_add_f32 v18, 1.0, v18
v_add_f32 v19, 1.0, v19
s_waitcnt lgkmcnt(6)
v_mfma_f32_32x32x16_bf16 v[48:63], v[40:43], v[156:159], v[48:63]
ds_read_b64_tr_b16 v[40:41], v2 offset:2048
ds_read_b64_tr_b16 v[42:43], v2 offset:2560
s_add_u32 m0, s58, 131072
s_add_u32 s59, s56, 1180032
buffer_load_dwordx4 v4, s[44:47], s59 offen lds
buffer_load_dwordx4 v5, s[44:47], s59 offen offset:1024 lds
v_rcp_f32 v12, v12
v_rcp_f32 v13, v13
s_waitcnt lgkmcnt(6)
v_mfma_f32_32x32x16_bf16 v[64:79], v[44:47], v[156:159], v[64:79]
ds_read_b64_tr_b16 v[44:45], v3 offset:2048
ds_read_b64_tr_b16 v[46:47], v3 offset:2560
v_rcp_f32 v14, v14
v_rcp_f32 v15, v15
s_waitcnt lgkmcnt(6)
v_mfma_f32_32x32x16_bf16 v[48:63], v[32:35], v[160:163], v[48:63]
ds_read_b64_tr_b16 v[32:33], v2 offset:4096
ds_read_b64_tr_b16 v[34:35], v2 offset:4608
v_rcp_f32 v16, v16
v_rcp_f32 v17, v17
s_waitcnt lgkmcnt(6)
v_mfma_f32_32x32x16_bf16 v[64:79], v[36:39], v[160:163], v[64:79]
ds_read_b64_tr_b16 v[36:37], v3 offset:4096
ds_read_b64_tr_b16 v[38:39], v3 offset:4608
v_rcp_f32 v18, v18
v_rcp_f32 v19, v19
s_waitcnt lgkmcnt(6)
v_mfma_f32_32x32x16_bf16 v[48:63], v[40:43], v[164:167], v[48:63]
ds_read_b64_tr_b16 v[40:41], v2 offset:6144
ds_read_b64_tr_b16 v[42:43], v2 offset:6656
s_nop 0
v_mul_f32 v88, v88, v12
s_waitcnt lgkmcnt(6)
v_mfma_f32_32x32x16_bf16 v[64:79], v[44:47], v[164:167], v[64:79]
ds_read_b64_tr_b16 v[44:45], v3 offset:6144
ds_read_b64_tr_b16 v[46:47], v3 offset:6656
v_mul_f32 v89, v89, v13
v_mul_f32 v90, v90, v14
s_waitcnt lgkmcnt(6)
v_mfma_f32_32x32x16_bf16 v[48:63], v[32:35], v[168:171], v[48:63]
ds_read_b64_tr_b16 v[32:33], v2 offset:16384
ds_read_b64_tr_b16 v[34:35], v2 offset:16896
v_mul_f32 v91, v91, v15
v_mul_f32 v92, v92, v16
s_waitcnt lgkmcnt(6)
v_mfma_f32_32x32x16_bf16 v[64:79], v[36:39], v[168:171], v[64:79]
ds_read_b64_tr_b16 v[36:37], v3 offset:16384
ds_read_b64_tr_b16 v[38:39], v3 offset:16896
v_mul_f32 v93, v93, v17
v_mul_f32 v94, v94, v18
s_waitcnt lgkmcnt(6)
v_mfma_f32_32x32x16_bf16 v[48:63], v[40:43], v[172:175], v[48:63]
ds_read_b64_tr_b16 v[40:41], v2 offset:18432
ds_read_b64_tr_b16 v[42:43], v2 offset:18944
v_mul_f32 v95, v95, v19
v_cvt_pk_bf16_f32 v20, v88, v89
s_waitcnt lgkmcnt(6)
v_mfma_f32_32x32x16_bf16 v[64:79], v[44:47], v[172:175], v[64:79]
ds_read_b64_tr_b16 v[44:45], v3 offset:18432
ds_read_b64_tr_b16 v[46:47], v3 offset:18944
v_cvt_pk_bf16_f32 v21, v90, v91
v_cvt_pk_bf16_f32 v22, v92, v93
s_waitcnt lgkmcnt(6)
v_mfma_f32_32x32x16_bf16 v[48:63], v[32:35], v[176:179], v[48:63]
ds_read_b64_tr_b16 v[32:33], v2 offset:20480
ds_read_b64_tr_b16 v[34:35], v2 offset:20992
v_cvt_pk_bf16_f32 v23, v94, v95
s_add_u32 s59, s66, 2048
buffer_store_dwordx4 v[20:23], v8, s[48:51], s59 offen sc1
s_waitcnt lgkmcnt(6)
v_mfma_f32_32x32x16_bf16 v[64:79], v[36:39], v[176:179], v[64:79]
ds_read_b64_tr_b16 v[36:37], v3 offset:20480
ds_read_b64_tr_b16 v[38:39], v3 offset:20992
v_mul_f32 v12, 0xbfb8aa3b, v96
v_mul_f32 v13, 0xbfb8aa3b, v97
s_waitcnt lgkmcnt(6)
v_mfma_f32_32x32x16_bf16 v[48:63], v[40:43], v[180:183], v[48:63]
ds_read_b64_tr_b16 v[40:41], v2 offset:22528
ds_read_b64_tr_b16 v[42:43], v2 offset:23040
v_mul_f32 v14, 0xbfb8aa3b, v98
v_mul_f32 v15, 0xbfb8aa3b, v99
s_waitcnt lgkmcnt(6)
v_mfma_f32_32x32x16_bf16 v[64:79], v[44:47], v[180:183], v[64:79]
ds_read_b64_tr_b16 v[44:45], v3 offset:22528
ds_read_b64_tr_b16 v[46:47], v3 offset:23040
v_mul_f32 v16, 0xbfb8aa3b, v100
v_mul_f32 v17, 0xbfb8aa3b, v101
s_waitcnt vmcnt(12)
s_barrier
s_waitcnt lgkmcnt(6)
v_mfma_f32_32x32x16_bf16 v[48:63], v[32:35], v[184:187], v[48:63]
ds_read_b64_tr_b16 v[32:33], v2 offset:32768
ds_read_b64_tr_b16 v[34:35], v2 offset:33280
s_add_u32 m0, s58, 147456
s_add_u32 s59, s56, 1769856
buffer_load_dwordx4 v4, s[44:47], s59 offen lds
buffer_load_dwordx4 v5, s[44:47], s59 offen offset:1024 lds
v_mul_f32 v18, 0xbfb8aa3b, v102
v_mul_f32 v19, 0xbfb8aa3b, v103
s_waitcnt lgkmcnt(6)
v_mfma_f32_32x32x16_bf16 v[64:79], v[36:39], v[184:187], v[64:79]
ds_read_b64_tr_b16 v[36:37], v3 offset:32768
ds_read_b64_tr_b16 v[38:39], v3 offset:33280
v_exp_f32 v12, v12
v_exp_f32 v13, v13
s_waitcnt lgkmcnt(6)
v_mfma_f32_32x32x16_bf16 v[48:63], v[40:43], v[188:191], v[48:63]
ds_read_b64_tr_b16 v[40:41], v2 offset:34816
ds_read_b64_tr_b16 v[42:43], v2 offset:35328
s_add_u32 m0, s58, 0
s_add_u32 s59, s56, 2359680
buffer_load_dwordx4 v4, s[44:47], s59 offen lds
buffer_load_dwordx4 v5, s[44:47], s59 offen offset:1024 lds
v_exp_f32 v14, v14
v_exp_f32 v15, v15
s_waitcnt lgkmcnt(6)
v_mfma_f32_32x32x16_bf16 v[64:79], v[44:47], v[188:191], v[64:79]
ds_read_b64_tr_b16 v[44:45], v3 offset:34816
ds_read_b64_tr_b16 v[46:47], v3 offset:35328
v_exp_f32 v16, v16
v_exp_f32 v17, v17
s_waitcnt lgkmcnt(6)
v_mfma_f32_32x32x16_bf16 v[48:63], v[32:35], v[192:195], v[48:63]
ds_read_b64_tr_b16 v[32:33], v2 offset:36864
ds_read_b64_tr_b16 v[34:35], v2 offset:37376
v_exp_f32 v18, v18
v_exp_f32 v19, v19
s_waitcnt lgkmcnt(6)
v_mfma_f32_32x32x16_bf16 v[64:79], v[36:39], v[192:195], v[64:79]
ds_read_b64_tr_b16 v[36:37], v3 offset:36864
ds_read_b64_tr_b16 v[38:39], v3 offset:37376
v_mul_f32 v104, v96, v104
v_mul_f32 v105, v97, v105
s_waitcnt lgkmcnt(6)
v_mfma_f32_32x32x16_bf16 v[48:63], v[40:43], v[196:199], v[48:63]
ds_read_b64_tr_b16 v[40:41], v2 offset:38912
ds_read_b64_tr_b16 v[42:43], v2 offset:39424
v_mul_f32 v106, v98, v106
v_mul_f32 v107, v99, v107
s_waitcnt lgkmcnt(6)
v_mfma_f32_32x32x16_bf16 v[64:79], v[44:47], v[196:199], v[64:79]
ds_read_b64_tr_b16 v[44:45], v3 offset:38912
ds_read_b64_tr_b16 v[46:47], v3 offset:39424
v_mul_f32 v108, v100, v108
v_mul_f32 v109, v101, v109
s_waitcnt lgkmcnt(6)
v_mfma_f32_32x32x16_bf16 v[48:63], v[32:35], v[200:203], v[48:63]
v_add_u32 v2, 0xc000, v2
v_add_u32 v3, 0xc000, v3
v_add_u32 v9, 0xc000, v9
ds_read_b64_tr_b16 v[32:33], v2 offset:0
ds_read_b64_tr_b16 v[34:35], v2 offset:512
v_mul_f32 v110, v102, v110
v_mul_f32 v111, v103, v111
s_waitcnt lgkmcnt(6)
v_mfma_f32_32x32x16_bf16 v[64:79], v[36:39], v[200:203], v[64:79]
ds_read_b64_tr_b16 v[36:37], v3 offset:0
ds_read_b64_tr_b16 v[38:39], v3 offset:512
v_add_f32 v12, 1.0, v12
v_add_f32 v13, 1.0, v13
s_waitcnt lgkmcnt(6)
v_mfma_f32_32x32x16_bf16 v[48:63], v[40:43], v[204:207], v[48:63]
ds_read_b64_tr_b16 v[40:41], v2 offset:2048
ds_read_b64_tr_b16 v[42:43], v2 offset:2560
v_add_f32 v14, 1.0, v14
v_add_f32 v15, 1.0, v15
s_waitcnt lgkmcnt(6)
v_mfma_f32_32x32x16_bf16 v[64:79], v[44:47], v[204:207], v[64:79]
ds_read_b64_tr_b16 v[44:45], v3 offset:2048
ds_read_b64_tr_b16 v[46:47], v3 offset:2560
v_add_f32 v16, 1.0, v16
v_add_f32 v17, 1.0, v17
s_waitcnt lgkmcnt(6)
v_mfma_f32_32x32x16_bf16 v[48:63], v[32:35], v[208:211], v[48:63]
ds_read_b64_tr_b16 v[32:33], v2 offset:4096
ds_read_b64_tr_b16 v[34:35], v2 offset:4608
v_add_f32 v18, 1.0, v18
v_add_f32 v19, 1.0, v19
s_waitcnt lgkmcnt(6)
v_mfma_f32_32x32x16_bf16 v[64:79], v[36:39], v[208:211], v[64:79]
ds_read_b64_tr_b16 v[36:37], v3 offset:4096
ds_read_b64_tr_b16 v[38:39], v3 offset:4608
v_rcp_f32 v12, v12
v_rcp_f32 v13, v13
s_waitcnt lgkmcnt(6)
v_mfma_f32_32x32x16_bf16 v[48:63], v[40:43], v[212:215], v[48:63]
ds_read_b64_tr_b16 v[40:41], v2 offset:6144
ds_read_b64_tr_b16 v[42:43], v2 offset:6656
v_rcp_f32 v14, v14
v_rcp_f32 v15, v15
s_waitcnt lgkmcnt(6)
v_mfma_f32_32x32x16_bf16 v[64:79], v[44:47], v[212:215], v[64:79]
ds_read_b64_tr_b16 v[44:45], v3 offset:6144
ds_read_b64_tr_b16 v[46:47], v3 offset:6656
v_rcp_f32 v16, v16
v_rcp_f32 v17, v17
s_waitcnt vmcnt(11)
s_barrier
s_waitcnt lgkmcnt(6)
v_mfma_f32_32x32x16_bf16 v[48:63], v[32:35], v[216:219], v[48:63]
ds_read_b64_tr_b16 v[32:33], v2 offset:16384
ds_read_b64_tr_b16 v[34:35], v2 offset:16896
s_add_u32 m0, s58, 16384
s_add_u32 s59, s56, 2949504
buffer_load_dwordx4 v4, s[44:47], s59 offen lds
buffer_load_dwordx4 v5, s[44:47], s59 offen offset:1024 lds
v_rcp_f32 v18, v18
v_rcp_f32 v19, v19
s_waitcnt lgkmcnt(6)
v_mfma_f32_32x32x16_bf16 v[64:79], v[36:39], v[216:219], v[64:79]
ds_read_b64_tr_b16 v[36:37], v3 offset:16384
ds_read_b64_tr_b16 v[38:39], v3 offset:16896
s_nop 0
v_mul_f32 v104, v104, v12
s_waitcnt lgkmcnt(6)
v_mfma_f32_32x32x16_bf16 v[48:63], v[40:43], v[220:223], v[48:63]
ds_read_b64_tr_b16 v[40:41], v2 offset:18432
ds_read_b64_tr_b16 v[42:43], v2 offset:18944
s_add_u32 m0, s58, 32768
s_add_u32 s59, s56, 3539328
buffer_load_dwordx4 v4, s[44:47], s59 offen lds
buffer_load_dwordx4 v5, s[44:47], s59 offen offset:1024 lds
v_mul_f32 v105, v105, v13
v_mul_f32 v106, v106, v14
s_waitcnt lgkmcnt(6)
v_mfma_f32_32x32x16_bf16 v[64:79], v[44:47], v[220:223], v[64:79]
ds_read_b64_tr_b16 v[44:45], v3 offset:18432
ds_read_b64_tr_b16 v[46:47], v3 offset:18944
v_mul_f32 v107, v107, v15
v_mul_f32 v108, v108, v16
s_waitcnt lgkmcnt(6)
v_mfma_f32_32x32x16_bf16 v[48:63], v[32:35], v[224:227], v[48:63]
ds_read_b64_tr_b16 v[32:33], v2 offset:20480
ds_read_b64_tr_b16 v[34:35], v2 offset:20992
v_mul_f32 v109, v109, v17
v_mul_f32 v110, v110, v18
s_waitcnt lgkmcnt(6)
v_mfma_f32_32x32x16_bf16 v[64:79], v[36:39], v[224:227], v[64:79]
ds_read_b64_tr_b16 v[36:37], v3 offset:20480
ds_read_b64_tr_b16 v[38:39], v3 offset:20992
v_mul_f32 v111, v111, v19
v_cvt_pk_bf16_f32 v24, v104, v105
s_waitcnt lgkmcnt(6)
v_mfma_f32_32x32x16_bf16 v[48:63], v[40:43], v[228:231], v[48:63]
ds_read_b64_tr_b16 v[40:41], v2 offset:22528
ds_read_b64_tr_b16 v[42:43], v2 offset:23040
v_cvt_pk_bf16_f32 v25, v106, v107
v_cvt_pk_bf16_f32 v26, v108, v109
s_waitcnt lgkmcnt(6)
v_mfma_f32_32x32x16_bf16 v[64:79], v[44:47], v[228:231], v[64:79]
ds_read_b64_tr_b16 v[44:45], v3 offset:22528
ds_read_b64_tr_b16 v[46:47], v3 offset:23040
v_cvt_pk_bf16_f32 v27, v110, v111
s_add_u32 s59, s66, 2560
buffer_store_dwordx4 v[24:27], v8, s[48:51], s59 offen sc1
s_waitcnt lgkmcnt(6)
v_mfma_f32_32x32x16_bf16 v[48:63], v[32:35], v[232:235], v[48:63]
ds_read_b64_tr_b16 v[32:33], v2 offset:32768
ds_read_b64_tr_b16 v[34:35], v2 offset:33280
s_waitcnt lgkmcnt(6)
v_mfma_f32_32x32x16_bf16 v[64:79], v[36:39], v[232:235], v[64:79]
ds_read_b64_tr_b16 v[36:37], v3 offset:32768
ds_read_b64_tr_b16 v[38:39], v3 offset:33280
s_waitcnt lgkmcnt(6)
v_mfma_f32_32x32x16_bf16 v[48:63], v[40:43], v[236:239], v[48:63]
ds_read_b64_tr_b16 v[40:41], v2 offset:34816
ds_read_b64_tr_b16 v[42:43], v2 offset:35328
s_waitcnt lgkmcnt(6)
v_mfma_f32_32x32x16_bf16 v[64:79], v[44:47], v[236:239], v[64:79]
ds_read_b64_tr_b16 v[44:45], v3 offset:34816
ds_read_b64_tr_b16 v[46:47], v3 offset:35328
s_waitcnt lgkmcnt(6)
v_mfma_f32_32x32x16_bf16 v[48:63], v[32:35], v[240:243], v[48:63]
ds_read_b64_tr_b16 v[32:33], v2 offset:36864
ds_read_b64_tr_b16 v[34:35], v2 offset:37376
s_waitcnt lgkmcnt(6)
v_mfma_f32_32x32x16_bf16 v[64:79], v[36:39], v[240:243], v[64:79]
ds_read_b64_tr_b16 v[36:37], v3 offset:36864
ds_read_b64_tr_b16 v[38:39], v3 offset:37376
s_waitcnt lgkmcnt(6)
v_mfma_f32_32x32x16_bf16 v[48:63], v[40:43], v[244:247], v[48:63]
ds_read_b64_tr_b16 v[40:41], v2 offset:38912
ds_read_b64_tr_b16 v[42:43], v2 offset:39424
s_waitcnt lgkmcnt(6)
v_mfma_f32_32x32x16_bf16 v[64:79], v[44:47], v[244:247], v[64:79]
ds_read_b64_tr_b16 v[44:45], v3 offset:38912
ds_read_b64_tr_b16 v[46:47], v3 offset:39424
s_waitcnt vmcnt(12)
s_barrier
s_waitcnt lgkmcnt(6)
v_mfma_f32_32x32x16_bf16 v[48:63], v[32:35], v[248:251], v[48:63]
v_add_u32 v2, 0xc000, v2
v_add_u32 v3, 0xc000, v3
v_add_u32 v9, 0xc000, v9
ds_read_b64_tr_b16 v[32:33], v2 offset:0
ds_read_b64_tr_b16 v[34:35], v2 offset:512
s_add_u32 m0, s58, 49152
s_add_u32 s59, s56, 4129152
buffer_load_dwordx4 v4, s[44:47], s59 offen lds
buffer_load_dwordx4 v5, s[44:47], s59 offen offset:1024 lds
s_waitcnt lgkmcnt(6)
v_mfma_f32_32x32x16_bf16 v[64:79], v[36:39], v[248:251], v[64:79]
ds_read_b64_tr_b16 v[36:37], v3 offset:0
ds_read_b64_tr_b16 v[38:39], v3 offset:512
s_waitcnt lgkmcnt(6)
v_mfma_f32_32x32x16_bf16 v[48:63], v[40:43], v[252:255], v[48:63]
ds_read_b64_tr_b16 v[40:41], v2 offset:2048
ds_read_b64_tr_b16 v[42:43], v2 offset:2560
s_add_u32 m0, s58, 65536
s_add_u32 s59, s56, 4718976
buffer_load_dwordx4 v4, s[44:47], s59 offen lds
buffer_load_dwordx4 v5, s[44:47], s59 offen offset:1024 lds
s_waitcnt lgkmcnt(6)
v_mfma_f32_32x32x16_bf16 v[64:79], v[44:47], v[252:255], v[64:79]
ds_read_b64_tr_b16 v[44:45], v3 offset:2048
ds_read_b64_tr_b16 v[46:47], v3 offset:2560
s_waitcnt lgkmcnt(6)
v_mfma_f32_32x32x16_bf16 v[80:95], v[32:35], v[112:115], 0
ds_read_b64_tr_b16 v[32:33], v2 offset:4096
ds_read_b64_tr_b16 v[34:35], v2 offset:4608
s_waitcnt lgkmcnt(6)
v_mfma_f32_32x32x16_bf16 v[96:111], v[36:39], v[112:115], 0
ds_read_b64_tr_b16 v[36:37], v3 offset:4096
ds_read_b64_tr_b16 v[38:39], v3 offset:4608
s_waitcnt lgkmcnt(6)
v_mfma_f32_32x32x16_bf16 v[80:95], v[40:43], v[116:119], v[80:95]
ds_read_b64_tr_b16 v[40:41], v2 offset:6144
ds_read_b64_tr_b16 v[42:43], v2 offset:6656
s_waitcnt lgkmcnt(6)
v_mfma_f32_32x32x16_bf16 v[96:111], v[44:47], v[116:119], v[96:111]
ds_read_b64_tr_b16 v[44:45], v3 offset:6144
ds_read_b64_tr_b16 v[46:47], v3 offset:6656
s_waitcnt lgkmcnt(6)
v_mfma_f32_32x32x16_bf16 v[80:95], v[32:35], v[120:123], v[80:95]
ds_read_b64_tr_b16 v[32:33], v2 offset:16384
ds_read_b64_tr_b16 v[34:35], v2 offset:16896
s_waitcnt lgkmcnt(6)
v_mfma_f32_32x32x16_bf16 v[96:111], v[36:39], v[120:123], v[96:111]
ds_read_b64_tr_b16 v[36:37], v3 offset:16384
ds_read_b64_tr_b16 v[38:39], v3 offset:16896
s_waitcnt lgkmcnt(6)
v_mfma_f32_32x32x16_bf16 v[80:95], v[40:43], v[124:127], v[80:95]
ds_read_b64_tr_b16 v[40:41], v2 offset:18432
ds_read_b64_tr_b16 v[42:43], v2 offset:18944
v_mul_f32 v12, 0xbfb8aa3b, v48
v_mul_f32 v13, 0xbfb8aa3b, v49
s_waitcnt lgkmcnt(6)
v_mfma_f32_32x32x16_bf16 v[96:111], v[44:47], v[124:127], v[96:111]
ds_read_b64_tr_b16 v[44:45], v3 offset:18432
ds_read_b64_tr_b16 v[46:47], v3 offset:18944
v_mul_f32 v14, 0xbfb8aa3b, v50
v_mul_f32 v15, 0xbfb8aa3b, v51
s_waitcnt lgkmcnt(6)
v_mfma_f32_32x32x16_bf16 v[80:95], v[32:35], v[128:131], v[80:95]
ds_read_b64_tr_b16 v[32:33], v2 offset:20480
ds_read_b64_tr_b16 v[34:35], v2 offset:20992
v_mul_f32 v16, 0xbfb8aa3b, v52
v_mul_f32 v17, 0xbfb8aa3b, v53
s_waitcnt lgkmcnt(6)
v_mfma_f32_32x32x16_bf16 v[96:111], v[36:39], v[128:131], v[96:111]
ds_read_b64_tr_b16 v[36:37], v3 offset:20480
ds_read_b64_tr_b16 v[38:39], v3 offset:20992
v_mul_f32 v18, 0xbfb8aa3b, v54
v_mul_f32 v19, 0xbfb8aa3b, v55
s_waitcnt lgkmcnt(6)
v_mfma_f32_32x32x16_bf16 v[80:95], v[40:43], v[132:135], v[80:95]
ds_read_b64_tr_b16 v[40:41], v2 offset:22528
ds_read_b64_tr_b16 v[42:43], v2 offset:23040
v_exp_f32 v12, v12
v_exp_f32 v13, v13
s_waitcnt lgkmcnt(6)
v_mfma_f32_32x32x16_bf16 v[96:111], v[44:47], v[132:135], v[96:111]
ds_read_b64_tr_b16 v[44:45], v3 offset:22528
ds_read_b64_tr_b16 v[46:47], v3 offset:23040
v_exp_f32 v14, v14
v_exp_f32 v15, v15
s_waitcnt vmcnt(11)
s_waitcnt vmcnt(4)
s_barrier
v_mov_b32 v29, s100
buffer_store_dword v29, v28, s[84:87], 0 offen offset:0 sc1
s_waitcnt lgkmcnt(6)
v_mfma_f32_32x32x16_bf16 v[80:95], v[32:35], v[136:139], v[80:95]
ds_read_b64_tr_b16 v[32:33], v2 offset:32768
ds_read_b64_tr_b16 v[34:35], v2 offset:33280
s_add_u32 m0, s58, 81920
s_add_u32 s59, s57, 0
buffer_load_dwordx4 v4, s[44:47], s59 offen lds
buffer_load_dwordx4 v5, s[44:47], s59 offen offset:1024 lds
v_exp_f32 v16, v16
v_exp_f32 v17, v17
s_waitcnt lgkmcnt(6)
v_mfma_f32_32x32x16_bf16 v[96:111], v[36:39], v[136:139], v[96:111]
ds_read_b64_tr_b16 v[36:37], v3 offset:32768
ds_read_b64_tr_b16 v[38:39], v3 offset:33280
v_exp_f32 v18, v18
v_exp_f32 v19, v19
s_waitcnt lgkmcnt(6)
v_mfma_f32_32x32x16_bf16 v[80:95], v[40:43], v[140:143], v[80:95]
ds_read_b64_tr_b16 v[40:41], v2 offset:34816
ds_read_b64_tr_b16 v[42:43], v2 offset:35328
s_add_u32 m0, s58, 98304
s_add_u32 s59, s57, 589824
buffer_load_dwordx4 v4, s[44:47], s59 offen lds
buffer_load_dwordx4 v5, s[44:47], s59 offen offset:1024 lds
v_mul_f32 v56, v48, v56
v_mul_f32 v57, v49, v57
s_waitcnt lgkmcnt(6)
v_mfma_f32_32x32x16_bf16 v[96:111], v[44:47], v[140:143], v[96:111]
ds_read_b64_tr_b16 v[44:45], v3 offset:34816
ds_read_b64_tr_b16 v[46:47], v3 offset:35328
v_mul_f32 v58, v50, v58
v_mul_f32 v59, v51, v59
s_waitcnt lgkmcnt(6)
v_mfma_f32_32x32x16_bf16 v[80:95], v[32:35], v[144:147], v[80:95]
ds_read_b64_tr_b16 v[32:33], v2 offset:36864
ds_read_b64_tr_b16 v[34:35], v2 offset:37376
v_mul_f32 v60, v52, v60
v_mul_f32 v61, v53, v61
s_waitcnt lgkmcnt(6)
v_mfma_f32_32x32x16_bf16 v[96:111], v[36:39], v[144:147], v[96:111]
ds_read_b64_tr_b16 v[36:37], v3 offset:36864
ds_read_b64_tr_b16 v[38:39], v3 offset:37376
v_mul_f32 v62, v54, v62
v_mul_f32 v63, v55, v63
s_waitcnt lgkmcnt(6)
v_mfma_f32_32x32x16_bf16 v[80:95], v[40:43], v[148:151], v[80:95]
ds_read_b64_tr_b16 v[40:41], v2 offset:38912
ds_read_b64_tr_b16 v[42:43], v2 offset:39424
v_add_f32 v12, 1.0, v12
v_add_f32 v13, 1.0, v13
s_waitcnt lgkmcnt(6)
v_mfma_f32_32x32x16_bf16 v[96:111], v[44:47], v[148:151], v[96:111]
ds_read_b64_tr_b16 v[44:45], v3 offset:38912
ds_read_b64_tr_b16 v[46:47], v3 offset:39424
v_add_f32 v14, 1.0, v14
v_add_f32 v15, 1.0, v15
s_waitcnt lgkmcnt(6)
v_mfma_f32_32x32x16_bf16 v[80:95], v[32:35], v[152:155], v[80:95]
v_add_u32 v2, 0xc000, v2
v_add_u32 v3, 0xc000, v3
v_add_u32 v9, 0xc000, v9
ds_read_b64_tr_b16 v[32:33], v2 offset:0
ds_read_b64_tr_b16 v[34:35], v2 offset:512
v_add_f32 v16, 1.0, v16
v_add_f32 v17, 1.0, v17
s_waitcnt lgkmcnt(6)
v_mfma_f32_32x32x16_bf16 v[96:111], v[36:39], v[152:155], v[96:111]
ds_read_b64_tr_b16 v[36:37], v3 offset:0
ds_read_b64_tr_b16 v[38:39], v3 offset:512
v_add_f32 v18, 1.0, v18
v_add_f32 v19, 1.0, v19
s_waitcnt lgkmcnt(6)
v_mfma_f32_32x32x16_bf16 v[80:95], v[40:43], v[156:159], v[80:95]
ds_read_b64_tr_b16 v[40:41], v2 offset:2048
ds_read_b64_tr_b16 v[42:43], v2 offset:2560
v_rcp_f32 v12, v12
v_rcp_f32 v13, v13
s_waitcnt lgkmcnt(6)
v_mfma_f32_32x32x16_bf16 v[96:111], v[44:47], v[156:159], v[96:111]
ds_read_b64_tr_b16 v[44:45], v3 offset:2048
ds_read_b64_tr_b16 v[46:47], v3 offset:2560
v_rcp_f32 v14, v14
v_rcp_f32 v15, v15
s_waitcnt lgkmcnt(6)
v_mfma_f32_32x32x16_bf16 v[80:95], v[32:35], v[160:163], v[80:95]
ds_read_b64_tr_b16 v[32:33], v2 offset:4096
ds_read_b64_tr_b16 v[34:35], v2 offset:4608
v_rcp_f32 v16, v16
v_rcp_f32 v17, v17
s_waitcnt lgkmcnt(6)
v_mfma_f32_32x32x16_bf16 v[96:111], v[36:39], v[160:163], v[96:111]
ds_read_b64_tr_b16 v[36:37], v3 offset:4096
ds_read_b64_tr_b16 v[38:39], v3 offset:4608
v_rcp_f32 v18, v18
v_rcp_f32 v19, v19
s_waitcnt lgkmcnt(6)
v_mfma_f32_32x32x16_bf16 v[80:95], v[40:43], v[164:167], v[80:95]
ds_read_b64_tr_b16 v[40:41], v2 offset:6144
ds_read_b64_tr_b16 v[42:43], v2 offset:6656
s_nop 0
v_mul_f32 v56, v56, v12
s_waitcnt lgkmcnt(6)
v_mfma_f32_32x32x16_bf16 v[96:111], v[44:47], v[164:167], v[96:111]
ds_read_b64_tr_b16 v[44:45], v3 offset:6144
ds_read_b64_tr_b16 v[46:47], v3 offset:6656
v_mul_f32 v57, v57, v13
v_mul_f32 v58, v58, v14
s_barrier
s_waitcnt lgkmcnt(6)
v_mfma_f32_32x32x16_bf16 v[80:95], v[32:35], v[168:171], v[80:95]
v_add_u32 v2, 0xfffdc000, v2
v_add_u32 v3, 0xfffdc000, v3
v_add_u32 v9, 0xfffdc000, v9
ds_read_b64_tr_b16 v[32:33], v2 offset:0
ds_read_b64_tr_b16 v[34:35], v2 offset:512
s_add_u32 m0, s58, 114688
s_add_u32 s59, s57, 1179648
buffer_load_dwordx4 v4, s[44:47], s59 offen lds
buffer_load_dwordx4 v5, s[44:47], s59 offen offset:1024 lds
v_mul_f32 v59, v59, v15
v_mul_f32 v60, v60, v16
s_waitcnt lgkmcnt(6)
v_mfma_f32_32x32x16_bf16 v[96:111], v[36:39], v[168:171], v[96:111]
ds_read_b64_tr_b16 v[36:37], v3 offset:0
ds_read_b64_tr_b16 v[38:39], v3 offset:512
v_mul_f32 v61, v61, v17
v_mul_f32 v62, v62, v18
s_waitcnt lgkmcnt(6)
v_mfma_f32_32x32x16_bf16 v[80:95], v[40:43], v[172:175], v[80:95]
ds_read_b64_tr_b16 v[40:41], v2 offset:2048
ds_read_b64_tr_b16 v[42:43], v2 offset:2560
s_add_u32 m0, s58, 131072
s_add_u32 s59, s57, 1769472
buffer_load_dwordx4 v4, s[44:47], s59 offen lds
buffer_load_dwordx4 v5, s[44:47], s59 offen offset:1024 lds
v_mul_f32 v63, v63, v19
v_cvt_pk_bf16_f32 v20, v56, v57
s_waitcnt lgkmcnt(6)
v_mfma_f32_32x32x16_bf16 v[96:111], v[44:47], v[172:175], v[96:111]
ds_read_b64_tr_b16 v[44:45], v3 offset:2048
ds_read_b64_tr_b16 v[46:47], v3 offset:2560
v_cvt_pk_bf16_f32 v21, v58, v59
v_cvt_pk_bf16_f32 v22, v60, v61
s_waitcnt lgkmcnt(6)
v_mfma_f32_32x32x16_bf16 v[80:95], v[32:35], v[176:179], v[80:95]
ds_read_b64_tr_b16 v[32:33], v2 offset:4096
ds_read_b64_tr_b16 v[34:35], v2 offset:4608
v_cvt_pk_bf16_f32 v23, v62, v63
s_add_u32 s59, s66, 4096
buffer_store_dwordx4 v[20:23], v8, s[48:51], s59 offen sc1
s_waitcnt lgkmcnt(6)
v_mfma_f32_32x32x16_bf16 v[96:111], v[36:39], v[176:179], v[96:111]
ds_read_b64_tr_b16 v[36:37], v3 offset:4096
ds_read_b64_tr_b16 v[38:39], v3 offset:4608
v_mul_f32 v12, 0xbfb8aa3b, v64
v_mul_f32 v13, 0xbfb8aa3b, v65
s_waitcnt lgkmcnt(6)
v_mfma_f32_32x32x16_bf16 v[80:95], v[40:43], v[180:183], v[80:95]
ds_read_b64_tr_b16 v[40:41], v2 offset:6144
ds_read_b64_tr_b16 v[42:43], v2 offset:6656
v_mul_f32 v14, 0xbfb8aa3b, v66
v_mul_f32 v15, 0xbfb8aa3b, v67
s_waitcnt lgkmcnt(6)
v_mfma_f32_32x32x16_bf16 v[96:111], v[44:47], v[180:183], v[96:111]
ds_read_b64_tr_b16 v[44:45], v3 offset:6144
ds_read_b64_tr_b16 v[46:47], v3 offset:6656
v_mul_f32 v16, 0xbfb8aa3b, v68
v_mul_f32 v17, 0xbfb8aa3b, v69
s_waitcnt lgkmcnt(6)
v_mfma_f32_32x32x16_bf16 v[80:95], v[32:35], v[184:187], v[80:95]
ds_read_b64_tr_b16 v[32:33], v2 offset:16384
ds_read_b64_tr_b16 v[34:35], v2 offset:16896
v_mul_f32 v18, 0xbfb8aa3b, v70
v_mul_f32 v19, 0xbfb8aa3b, v71
s_waitcnt lgkmcnt(6)
v_mfma_f32_32x32x16_bf16 v[96:111], v[36:39], v[184:187], v[96:111]
ds_read_b64_tr_b16 v[36:37], v3 offset:16384
ds_read_b64_tr_b16 v[38:39], v3 offset:16896
v_exp_f32 v12, v12
v_exp_f32 v13, v13
s_waitcnt lgkmcnt(6)
v_mfma_f32_32x32x16_bf16 v[80:95], v[40:43], v[188:191], v[80:95]
ds_read_b64_tr_b16 v[40:41], v2 offset:18432
ds_read_b64_tr_b16 v[42:43], v2 offset:18944
v_exp_f32 v14, v14
v_exp_f32 v15, v15
s_waitcnt lgkmcnt(6)
v_mfma_f32_32x32x16_bf16 v[96:111], v[44:47], v[188:191], v[96:111]
ds_read_b64_tr_b16 v[44:45], v3 offset:18432
ds_read_b64_tr_b16 v[46:47], v3 offset:18944
v_exp_f32 v16, v16
v_exp_f32 v17, v17
s_waitcnt lgkmcnt(6)
v_mfma_f32_32x32x16_bf16 v[80:95], v[32:35], v[192:195], v[80:95]
ds_read_b64_tr_b16 v[32:33], v2 offset:20480
ds_read_b64_tr_b16 v[34:35], v2 offset:20992
v_exp_f32 v18, v18
v_exp_f32 v19, v19
s_waitcnt lgkmcnt(6)
v_mfma_f32_32x32x16_bf16 v[96:111], v[36:39], v[192:195], v[96:111]
ds_read_b64_tr_b16 v[36:37], v3 offset:20480
ds_read_b64_tr_b16 v[38:39], v3 offset:20992
v_mul_f32 v72, v64, v72
v_mul_f32 v73, v65, v73
s_waitcnt lgkmcnt(6)
v_mfma_f32_32x32x16_bf16 v[80:95], v[40:43], v[196:199], v[80:95]
ds_read_b64_tr_b16 v[40:41], v2 offset:22528
ds_read_b64_tr_b16 v[42:43], v2 offset:23040
v_mul_f32 v74, v66, v74
v_mul_f32 v75, v67, v75
s_waitcnt lgkmcnt(6)
v_mfma_f32_32x32x16_bf16 v[96:111], v[44:47], v[196:199], v[96:111]
ds_read_b64_tr_b16 v[44:45], v3 offset:22528
ds_read_b64_tr_b16 v[46:47], v3 offset:23040
v_mul_f32 v76, v68, v76
v_mul_f32 v77, v69, v77
s_waitcnt vmcnt(12)
s_barrier
s_waitcnt lgkmcnt(6)
v_mfma_f32_32x32x16_bf16 v[80:95], v[32:35], v[200:203], v[80:95]
ds_read_b64_tr_b16 v[32:33], v2 offset:32768
ds_read_b64_tr_b16 v[34:35], v2 offset:33280
s_add_u32 m0, s58, 147456
s_add_u32 s59, s57, 2359296
buffer_load_dwordx4 v4, s[44:47], s59 offen lds
buffer_load_dwordx4 v5, s[44:47], s59 offen offset:1024 lds
v_mul_f32 v78, v70, v78
v_mul_f32 v79, v71, v79
s_waitcnt lgkmcnt(6)
v_mfma_f32_32x32x16_bf16 v[96:111], v[36:39], v[200:203], v[96:111]
ds_read_b64_tr_b16 v[36:37], v3 offset:32768
ds_read_b64_tr_b16 v[38:39], v3 offset:33280
v_add_f32 v12, 1.0, v12
v_add_f32 v13, 1.0, v13
s_waitcnt lgkmcnt(6)
v_mfma_f32_32x32x16_bf16 v[80:95], v[40:43], v[204:207], v[80:95]
ds_read_b64_tr_b16 v[40:41], v2 offset:34816
ds_read_b64_tr_b16 v[42:43], v2 offset:35328
s_add_u32 m0, s58, 0
s_add_u32 s59, s57, 2949120
buffer_load_dwordx4 v4, s[44:47], s59 offen lds
buffer_load_dwordx4 v5, s[44:47], s59 offen offset:1024 lds
v_add_f32 v14, 1.0, v14
v_add_f32 v15, 1.0, v15
s_waitcnt lgkmcnt(6)
v_mfma_f32_32x32x16_bf16 v[96:111], v[44:47], v[204:207], v[96:111]
ds_read_b64_tr_b16 v[44:45], v3 offset:34816
ds_read_b64_tr_b16 v[46:47], v3 offset:35328
v_add_f32 v16, 1.0, v16
v_add_f32 v17, 1.0, v17
s_waitcnt lgkmcnt(6)
v_mfma_f32_32x32x16_bf16 v[80:95], v[32:35], v[208:211], v[80:95]
ds_read_b64_tr_b16 v[32:33], v2 offset:36864
ds_read_b64_tr_b16 v[34:35], v2 offset:37376
v_add_f32 v18, 1.0, v18
v_add_f32 v19, 1.0, v19
s_waitcnt lgkmcnt(6)
v_mfma_f32_32x32x16_bf16 v[96:111], v[36:39], v[208:211], v[96:111]
ds_read_b64_tr_b16 v[36:37], v3 offset:36864
ds_read_b64_tr_b16 v[38:39], v3 offset:37376
v_rcp_f32 v12, v12
v_rcp_f32 v13, v13
s_waitcnt lgkmcnt(6)
v_mfma_f32_32x32x16_bf16 v[80:95], v[40:43], v[212:215], v[80:95]
ds_read_b64_tr_b16 v[40:41], v2 offset:38912
ds_read_b64_tr_b16 v[42:43], v2 offset:39424
v_rcp_f32 v14, v14
v_rcp_f32 v15, v15
s_waitcnt lgkmcnt(6)
v_mfma_f32_32x32x16_bf16 v[96:111], v[44:47], v[212:215], v[96:111]
ds_read_b64_tr_b16 v[44:45], v3 offset:38912
ds_read_b64_tr_b16 v[46:47], v3 offset:39424
v_rcp_f32 v16, v16
v_rcp_f32 v17, v17
s_waitcnt lgkmcnt(6)
v_mfma_f32_32x32x16_bf16 v[80:95], v[32:35], v[216:219], v[80:95]
v_add_u32 v2, 0xc000, v2
v_add_u32 v3, 0xc000, v3
v_add_u32 v9, 0xc000, v9
ds_read_b64_tr_b16 v[32:33], v2 offset:0
ds_read_b64_tr_b16 v[34:35], v2 offset:512
v_rcp_f32 v18, v18
v_rcp_f32 v19, v19
s_waitcnt lgkmcnt(6)
v_mfma_f32_32x32x16_bf16 v[96:111], v[36:39], v[216:219], v[96:111]
ds_read_b64_tr_b16 v[36:37], v3 offset:0
ds_read_b64_tr_b16 v[38:39], v3 offset:512
s_nop 0
v_mul_f32 v72, v72, v12
s_waitcnt lgkmcnt(6)
v_mfma_f32_32x32x16_bf16 v[80:95], v[40:43], v[220:223], v[80:95]
ds_read_b64_tr_b16 v[40:41], v2 offset:2048
ds_read_b64_tr_b16 v[42:43], v2 offset:2560
v_mul_f32 v73, v73, v13
v_mul_f32 v74, v74, v14
s_waitcnt lgkmcnt(6)
v_mfma_f32_32x32x16_bf16 v[96:111], v[44:47], v[220:223], v[96:111]
ds_read_b64_tr_b16 v[44:45], v3 offset:2048
ds_read_b64_tr_b16 v[46:47], v3 offset:2560
v_mul_f32 v75, v75, v15
v_mul_f32 v76, v76, v16
s_waitcnt lgkmcnt(6)
v_mfma_f32_32x32x16_bf16 v[80:95], v[32:35], v[224:227], v[80:95]
ds_read_b64_tr_b16 v[32:33], v2 offset:4096
ds_read_b64_tr_b16 v[34:35], v2 offset:4608
v_mul_f32 v77, v77, v17
v_mul_f32 v78, v78, v18
s_waitcnt lgkmcnt(6)
v_mfma_f32_32x32x16_bf16 v[96:111], v[36:39], v[224:227], v[96:111]
ds_read_b64_tr_b16 v[36:37], v3 offset:4096
ds_read_b64_tr_b16 v[38:39], v3 offset:4608
v_mul_f32 v79, v79, v19
v_cvt_pk_bf16_f32 v24, v72, v73
s_waitcnt lgkmcnt(6)
v_mfma_f32_32x32x16_bf16 v[80:95], v[40:43], v[228:231], v[80:95]
ds_read_b64_tr_b16 v[40:41], v2 offset:6144
ds_read_b64_tr_b16 v[42:43], v2 offset:6656
v_cvt_pk_bf16_f32 v25, v74, v75
v_cvt_pk_bf16_f32 v26, v76, v77
s_waitcnt lgkmcnt(6)
v_mfma_f32_32x32x16_bf16 v[96:111], v[44:47], v[228:231], v[96:111]
ds_read_b64_tr_b16 v[44:45], v3 offset:6144
ds_read_b64_tr_b16 v[46:47], v3 offset:6656
v_cvt_pk_bf16_f32 v27, v78, v79
s_add_u32 s59, s66, 4608
buffer_store_dwordx4 v[24:27], v8, s[48:51], s59 offen sc1
s_waitcnt vmcnt(12)
s_barrier
s_waitcnt lgkmcnt(6)
v_mfma_f32_32x32x16_bf16 v[80:95], v[32:35], v[232:235], v[80:95]
ds_read_b64_tr_b16 v[32:33], v2 offset:16384
ds_read_b64_tr_b16 v[34:35], v2 offset:16896
s_add_u32 m0, s58, 16384
s_add_u32 s59, s57, 3538944
buffer_load_dwordx4 v4, s[44:47], s59 offen lds
buffer_load_dwordx4 v5, s[44:47], s59 offen offset:1024 lds
s_waitcnt lgkmcnt(6)
v_mfma_f32_32x32x16_bf16 v[96:111], v[36:39], v[232:235], v[96:111]
ds_read_b64_tr_b16 v[36:37], v3 offset:16384
ds_read_b64_tr_b16 v[38:39], v3 offset:16896
s_waitcnt lgkmcnt(6)
v_mfma_f32_32x32x16_bf16 v[80:95], v[40:43], v[236:239], v[80:95]
ds_read_b64_tr_b16 v[40:41], v2 offset:18432
ds_read_b64_tr_b16 v[42:43], v2 offset:18944
s_add_u32 m0, s58, 32768
s_add_u32 s59, s57, 4128768
buffer_load_dwordx4 v4, s[44:47], s59 offen lds
buffer_load_dwordx4 v5, s[44:47], s59 offen offset:1024 lds
s_waitcnt lgkmcnt(6)
v_mfma_f32_32x32x16_bf16 v[96:111], v[44:47], v[236:239], v[96:111]
ds_read_b64_tr_b16 v[44:45], v3 offset:18432
ds_read_b64_tr_b16 v[46:47], v3 offset:18944
s_waitcnt lgkmcnt(6)
v_mfma_f32_32x32x16_bf16 v[80:95], v[32:35], v[240:243], v[80:95]
ds_read_b64_tr_b16 v[32:33], v2 offset:20480
ds_read_b64_tr_b16 v[34:35], v2 offset:20992
s_waitcnt lgkmcnt(6)
v_mfma_f32_32x32x16_bf16 v[96:111], v[36:39], v[240:243], v[96:111]
ds_read_b64_tr_b16 v[36:37], v3 offset:20480
ds_read_b64_tr_b16 v[38:39], v3 offset:20992
s_waitcnt lgkmcnt(6)
v_mfma_f32_32x32x16_bf16 v[80:95], v[40:43], v[244:247], v[80:95]
ds_read_b64_tr_b16 v[40:41], v2 offset:22528
ds_read_b64_tr_b16 v[42:43], v2 offset:23040
s_waitcnt lgkmcnt(6)
v_mfma_f32_32x32x16_bf16 v[96:111], v[44:47], v[244:247], v[96:111]
ds_read_b64_tr_b16 v[44:45], v3 offset:22528
ds_read_b64_tr_b16 v[46:47], v3 offset:23040
s_waitcnt lgkmcnt(6)
v_mfma_f32_32x32x16_bf16 v[80:95], v[32:35], v[248:251], v[80:95]
ds_read_b64_tr_b16 v[32:33], v9 offset:32768
ds_read_b64_tr_b16 v[34:35], v9 offset:33280
s_waitcnt lgkmcnt(6)
v_mfma_f32_32x32x16_bf16 v[96:111], v[36:39], v[248:251], v[96:111]
s_waitcnt lgkmcnt(4)
v_mfma_f32_32x32x16_bf16 v[80:95], v[40:43], v[252:255], v[80:95]
ds_read_b64_tr_b16 v[40:41], v9 offset:34816
ds_read_b64_tr_b16 v[42:43], v9 offset:35328
s_waitcnt lgkmcnt(4)
v_mfma_f32_32x32x16_bf16 v[96:111], v[44:47], v[252:255], v[96:111]
s_waitcnt lgkmcnt(2)
v_mfma_f32_32x32x16_bf16 v[48:63], v[32:35], v[112:115], 0
ds_read_b64_tr_b16 v[32:33], v9 offset:36864
ds_read_b64_tr_b16 v[34:35], v9 offset:37376
s_waitcnt lgkmcnt(2)
v_mfma_f32_32x32x16_bf16 v[48:63], v[40:43], v[116:119], v[48:63]
ds_read_b64_tr_b16 v[40:41], v9 offset:38912
ds_read_b64_tr_b16 v[42:43], v9 offset:39424
s_waitcnt vmcnt(12)
s_barrier
v_mov_b32 v1, 72768
v_mov_b32 v10, 0
v_mov_b32 v11, 0
ds_write_b64 v1, v[10:11]
s_waitcnt lgkmcnt(3)
v_mfma_f32_32x32x16_bf16 v[48:63], v[32:35], v[120:123], v[48:63]
v_add_u32 v2, 0xc000, v2
v_add_u32 v3, 0xc000, v3
v_add_u32 v9, 0xc000, v9
ds_read_b64_tr_b16 v[32:33], v9 offset:0
ds_read_b64_tr_b16 v[34:35], v9 offset:512
s_add_u32 m0, s58, 49152
s_add_u32 s59, s57, 4718592
buffer_load_dwordx4 v4, s[44:47], s59 offen lds
buffer_load_dwordx4 v5, s[44:47], s59 offen offset:1024 lds
s_waitcnt lgkmcnt(3)
v_mfma_f32_32x32x16_bf16 v[48:63], v[40:43], v[124:127], v[48:63]
ds_read_b64_tr_b16 v[40:41], v9 offset:2048
ds_read_b64_tr_b16 v[42:43], v9 offset:2560
v_mul_f32 v12, 0xbfb8aa3b, v80
v_mul_f32 v13, 0xbfb8aa3b, v81
v_mul_f32 v14, 0xbfb8aa3b, v82
v_mul_f32 v15, 0xbfb8aa3b, v83
s_waitcnt lgkmcnt(2)
v_mfma_f32_32x32x16_bf16 v[48:63], v[32:35], v[128:131], v[48:63]
ds_read_b64_tr_b16 v[32:33], v9 offset:4096
ds_read_b64_tr_b16 v[34:35], v9 offset:4608
v_mul_f32 v16, 0xbfb8aa3b, v84
v_mul_f32 v17, 0xbfb8aa3b, v85
v_mul_f32 v18, 0xbfb8aa3b, v86
v_mul_f32 v19, 0xbfb8aa3b, v87
s_waitcnt lgkmcnt(2)
v_mfma_f32_32x32x16_bf16 v[48:63], v[40:43], v[132:135], v[48:63]
ds_read_b64_tr_b16 v[40:41], v9 offset:6144
ds_read_b64_tr_b16 v[42:43], v9 offset:6656
v_exp_f32 v12, v12
v_exp_f32 v13, v13
v_exp_f32 v14, v14
v_exp_f32 v15, v15
s_waitcnt lgkmcnt(2)
v_mfma_f32_32x32x16_bf16 v[48:63], v[32:35], v[136:139], v[48:63]
ds_read_b64_tr_b16 v[32:33], v9 offset:16384
ds_read_b64_tr_b16 v[34:35], v9 offset:16896
v_exp_f32 v16, v16
v_exp_f32 v17, v17
v_exp_f32 v18, v18
v_exp_f32 v19, v19
s_waitcnt lgkmcnt(2)
v_mfma_f32_32x32x16_bf16 v[48:63], v[40:43], v[140:143], v[48:63]
ds_read_b64_tr_b16 v[40:41], v9 offset:18432
ds_read_b64_tr_b16 v[42:43], v9 offset:18944
v_mul_f32 v88, v80, v88
v_mul_f32 v89, v81, v89
v_mul_f32 v90, v82, v90
v_mul_f32 v91, v83, v91
s_waitcnt lgkmcnt(2)
v_mfma_f32_32x32x16_bf16 v[48:63], v[32:35], v[144:147], v[48:63]
ds_read_b64_tr_b16 v[32:33], v9 offset:20480
ds_read_b64_tr_b16 v[34:35], v9 offset:20992
v_mul_f32 v92, v84, v92
v_mul_f32 v93, v85, v93
v_mul_f32 v94, v86, v94
v_mul_f32 v95, v87, v95
s_waitcnt lgkmcnt(2)
v_mfma_f32_32x32x16_bf16 v[48:63], v[40:43], v[148:151], v[48:63]
ds_read_b64_tr_b16 v[40:41], v9 offset:22528
ds_read_b64_tr_b16 v[42:43], v9 offset:23040
v_add_f32 v12, 1.0, v12
v_add_f32 v13, 1.0, v13
v_add_f32 v14, 1.0, v14
v_add_f32 v15, 1.0, v15
s_waitcnt vmcnt(9)
s_waitcnt vmcnt(6)
s_barrier
v_mov_b32 v29, s100
buffer_store_dword v29, v28, s[84:87], 0 offen offset:2048 sc1
buffer_load_dword v31, v30, s[84:87], 0 offen offset:0 sc1
s_waitcnt lgkmcnt(2)
v_mfma_f32_32x32x16_bf16 v[48:63], v[32:35], v[152:155], v[48:63]
ds_read_b64_tr_b16 v[32:33], v9 offset:32768
ds_read_b64_tr_b16 v[34:35], v9 offset:33280
v_add_f32 v16, 1.0, v16
v_add_f32 v17, 1.0, v17
v_add_f32 v18, 1.0, v18
v_add_f32 v19, 1.0, v19
s_waitcnt lgkmcnt(2)
v_mfma_f32_32x32x16_bf16 v[48:63], v[40:43], v[156:159], v[48:63]
ds_read_b64_tr_b16 v[40:41], v9 offset:34816
ds_read_b64_tr_b16 v[42:43], v9 offset:35328
v_rcp_f32 v12, v12
v_rcp_f32 v13, v13
v_rcp_f32 v14, v14
v_rcp_f32 v15, v15
s_waitcnt lgkmcnt(2)
v_mfma_f32_32x32x16_bf16 v[48:63], v[32:35], v[160:163], v[48:63]
ds_read_b64_tr_b16 v[32:33], v9 offset:36864
ds_read_b64_tr_b16 v[34:35], v9 offset:37376
v_rcp_f32 v16, v16
v_rcp_f32 v17, v17
v_rcp_f32 v18, v18
v_rcp_f32 v19, v19
s_waitcnt lgkmcnt(2)
v_mfma_f32_32x32x16_bf16 v[48:63], v[40:43], v[164:167], v[48:63]
ds_read_b64_tr_b16 v[40:41], v9 offset:38912
ds_read_b64_tr_b16 v[42:43], v9 offset:39424
s_nop 0
v_mul_f32 v88, v88, v12
v_mul_f32 v89, v89, v13
v_mul_f32 v90, v90, v14
s_waitcnt lgkmcnt(2)
v_mfma_f32_32x32x16_bf16 v[48:63], v[32:35], v[168:171], v[48:63]
v_add_u32 v2, 0xc000, v2
v_add_u32 v3, 0xc000, v3
v_add_u32 v9, 0xc000, v9
ds_read_b64_tr_b16 v[32:33], v9 offset:0
ds_read_b64_tr_b16 v[34:35], v9 offset:512
v_mul_f32 v91, v91, v15
v_mul_f32 v92, v92, v16
v_mul_f32 v93, v93, v17
v_mul_f32 v94, v94, v18
s_waitcnt lgkmcnt(2)
v_mfma_f32_32x32x16_bf16 v[48:63], v[40:43], v[172:175], v[48:63]
ds_read_b64_tr_b16 v[40:41], v9 offset:2048
ds_read_b64_tr_b16 v[42:43], v9 offset:2560
v_mul_f32 v95, v95, v19
v_cvt_pk_bf16_f32 v20, v88, v89
v_cvt_pk_bf16_f32 v21, v90, v91
v_cvt_pk_bf16_f32 v22, v92, v93
s_waitcnt lgkmcnt(2)
v_mfma_f32_32x32x16_bf16 v[48:63], v[32:35], v[176:179], v[48:63]
ds_read_b64_tr_b16 v[32:33], v9 offset:4096
ds_read_b64_tr_b16 v[34:35], v9 offset:4608
v_cvt_pk_bf16_f32 v23, v94, v95
s_add_u32 s59, s66, 6144
buffer_store_dwordx4 v[20:23], v8, s[48:51], s59 offen sc1
v_mul_f32 v12, 0xbfb8aa3b, v96
v_mul_f32 v13, 0xbfb8aa3b, v97
s_waitcnt lgkmcnt(2)
v_mfma_f32_32x32x16_bf16 v[48:63], v[40:43], v[180:183], v[48:63]
ds_read_b64_tr_b16 v[40:41], v9 offset:6144
ds_read_b64_tr_b16 v[42:43], v9 offset:6656
v_mul_f32 v14, 0xbfb8aa3b, v98
v_mul_f32 v15, 0xbfb8aa3b, v99
v_mul_f32 v16, 0xbfb8aa3b, v100
v_mul_f32 v17, 0xbfb8aa3b, v101
s_waitcnt lgkmcnt(0)
s_waitcnt vmcnt(7)
s_barrier
s_cmp_eq_u32 s101, 0
s_cbranch_scc1 Lsrole
s_waitcnt vmcnt(1)
v_cmp_ne_u32 vcc, s100, v31
s_nop 1
s_cbranch_vccz Lok12
s_mov_b32 s83, 20000
Llp13:
buffer_load_dword v31, v30, s[84:87], 0 offen offset:0 sc1
s_sub_u32 s83, s83, 1
s_cbranch_scc1 Lok12
s_waitcnt vmcnt(0)
v_cmp_ne_u32 vcc, s100, v31
s_nop 1
s_cbranch_vccnz Llp13
Lok12:
s_mov_b32 s94, s38
s_mov_b32 s44, s28
s_mov_b32 s45, s29
s_mov_b32 s46, 0x510000
s_mov_b32 s47, 0x20000
s_mul_i32 s95, s94, 36864
s_mul_i32 s96, s94, 1327104
s_mul_i32 s97, s94, 20480
s_add_u32 s97, s97, 81920
v_lshrrev_b32 v31, 3, v0
v_bfe_u32 v1, v0, 1, 2
v_bfe_u32 v70, v0, 4, 2
v_xor_b32 v1, v1, v70
v_and_b32 v70, 1, v0
v_lshlrev_b32 v70, 4, v70
v_lshl_add_u32 v1, v1, 5, v70
v_mul_u32_u24 v31, 1152, v31
s_mul_i32 s60, s93, 128
v_add3_u32 v69, v1, v31, s60
v_add_u32 v70, 8192, v69
v_add_u32 v71, 16384, v69
v_add_u32 v72, 24576, v69
v_mfma_f32_32x32x16_bf16 v[48:63], v[32:35], v[184:187], v[48:63]
v_add_u32 v2, 0xfffdc000, v2
v_add_u32 v3, 0xfffdc000, v3
v_add_u32 v9, 0xfffdc000, v9
ds_read_b64_tr_b16 v[32:33], v9 offset:0
ds_read_b64_tr_b16 v[34:35], v9 offset:512
v_mul_f32 v18, 0xbfb8aa3b, v102
v_mul_f32 v19, 0xbfb8aa3b, v103
v_exp_f32 v12, v12
v_exp_f32 v13, v13
s_add_u32 m0, s97, 0
s_add_u32 s99, s96, 0x0
buffer_load_dwordx4 v69, s[44:47], s99 offen offset:0 lds
v_mfma_f32_32x32x16_bf16 v[48:63], v[40:43], v[188:191], v[48:63]
ds_read_b64_tr_b16 v[40:41], v9 offset:2048
ds_read_b64_tr_b16 v[42:43], v9 offset:2560
v_exp_f32 v14, v14
v_exp_f32 v15, v15
v_exp_f32 v16, v16
v_exp_f32 v17, v17
buffer_load_dwordx4 v70, s[44:47], s99 offen offset:1024 lds
s_waitcnt lgkmcnt(2)
v_mfma_f32_32x32x16_bf16 v[48:63], v[32:35], v[192:195], v[48:63]
ds_read_b64_tr_b16 v[32:33], v9 offset:4096
ds_read_b64_tr_b16 v[34:35], v9 offset:4608
v_exp_f32 v18, v18
v_exp_f32 v19, v19
v_mul_f32 v104, v96, v104
v_mul_f32 v105, v97, v105
buffer_load_dwordx4 v71, s[44:47], s99 offen offset:2048 lds
s_waitcnt lgkmcnt(2)
v_mfma_f32_32x32x16_bf16 v[48:63], v[40:43], v[196:199], v[48:63]
ds_read_b64_tr_b16 v[40:41], v9 offset:6144
ds_read_b64_tr_b16 v[42:43], v9 offset:6656
v_mul_f32 v106, v98, v106
v_mul_f32 v107, v99, v107
v_mul_f32 v108, v100, v108
v_mul_f32 v109, v101, v109
buffer_load_dwordx4 v72, s[44:47], s99 offen offset:3072 lds
s_waitcnt lgkmcnt(2)
v_mfma_f32_32x32x16_bf16 v[48:63], v[32:35], v[200:203], v[48:63]
ds_read_b64_tr_b16 v[32:33], v9 offset:16384
ds_read_b64_tr_b16 v[34:35], v9 offset:16896
v_mul_f32 v110, v102, v110
v_mul_f32 v111, v103, v111
v_add_f32 v12, 1.0, v12
v_add_f32 v13, 1.0, v13
s_mul_i32 s60, s92, 737280
v_lshl_add_u32 v64, v0, 4, s60
v_add_u32 v65, 147456, v64
v_add_u32 v66, 294912, v64
v_add_u32 v67, 442368, v64
v_add_u32 v68, 589824, v64
s_waitcnt lgkmcnt(2)
v_mfma_f32_32x32x16_bf16 v[48:63], v[40:43], v[204:207], v[48:63]
ds_read_b64_tr_b16 v[40:41], v9 offset:18432
ds_read_b64_tr_b16 v[42:43], v9 offset:18944
v_add_f32 v14, 1.0, v14
v_add_f32 v15, 1.0, v15
v_add_f32 v16, 1.0, v16
v_add_f32 v17, 1.0, v17
s_add_u32 s98, s95, 0x0
buffer_load_dwordx4 v[112:115], v64, s[48:51], s98 offen sc1
s_waitcnt lgkmcnt(2)
v_mfma_f32_32x32x16_bf16 v[48:63], v[32:35], v[208:211], v[48:63]
ds_read_b64_tr_b16 v[32:33], v9 offset:20480
ds_read_b64_tr_b16 v[34:35], v9 offset:20992
v_add_f32 v18, 1.0, v18
v_add_f32 v19, 1.0, v19
v_rcp_f32 v12, v12
v_rcp_f32 v13, v13
buffer_load_dwordx4 v[116:119], v65, s[48:51], s98 offen sc1
s_waitcnt lgkmcnt(2)
v_mfma_f32_32x32x16_bf16 v[48:63], v[40:43], v[212:215], v[48:63]
ds_read_b64_tr_b16 v[40:41], v9 offset:22528
ds_read_b64_tr_b16 v[42:43], v9 offset:23040
v_rcp_f32 v14, v14
v_rcp_f32 v15, v15
v_rcp_f32 v16, v16
v_rcp_f32 v17, v17
buffer_load_dwordx4 v[120:123], v66, s[48:51], s98 offen sc1
s_barrier
s_waitcnt lgkmcnt(2)
v_mfma_f32_32x32x16_bf16 v[48:63], v[32:35], v[216:219], v[48:63]
ds_read_b64_tr_b16 v[32:33], v9 offset:32768
ds_read_b64_tr_b16 v[34:35], v9 offset:33280
v_rcp_f32 v18, v18
v_rcp_f32 v19, v19
s_nop 0
v_mul_f32 v104, v104, v12
buffer_load_dwordx4 v[124:127], v67, s[48:51], s98 offen sc1
s_waitcnt lgkmcnt(2)
v_mfma_f32_32x32x16_bf16 v[48:63], v[40:43], v[220:223], v[48:63]
ds_read_b64_tr_b16 v[40:41], v9 offset:34816
ds_read_b64_tr_b16 v[42:43], v9 offset:35328
v_mul_f32 v105, v105, v13
v_mul_f32 v106, v106, v14
v_mul_f32 v107, v107, v15
v_mul_f32 v108, v108, v16
buffer_load_dwordx4 v[128:131], v68, s[48:51], s98 offen sc1
s_waitcnt lgkmcnt(2)
v_mfma_f32_32x32x16_bf16 v[48:63], v[32:35], v[224:227], v[48:63]
ds_read_b64_tr_b16 v[32:33], v9 offset:36864
ds_read_b64_tr_b16 v[34:35], v9 offset:37376
v_mul_f32 v109, v109, v17
v_mul_f32 v110, v110, v18
v_mul_f32 v111, v111, v19
v_cvt_pk_bf16_f32 v24, v104, v105
s_add_u32 m0, s97, 4096
s_add_u32 s99, s96, 0x9000
buffer_load_dwordx4 v69, s[44:47], s99 offen offset:0 lds
s_waitcnt lgkmcnt(2)
v_mfma_f32_32x32x16_bf16 v[48:63], v[40:43], v[228:231], v[48:63]
ds_read_b64_tr_b16 v[40:41], v9 offset:38912
ds_read_b64_tr_b16 v[42:43], v9 offset:39424
v_cvt_pk_bf16_f32 v25, v106, v107
v_cvt_pk_bf16_f32 v26, v108, v109
v_cvt_pk_bf16_f32 v27, v110, v111
s_add_u32 s59, s66, 6656
buffer_store_dwordx4 v[24:27], v8, s[48:51], s59 offen sc1
buffer_load_dwordx4 v70, s[44:47], s99 offen offset:1024 lds
s_waitcnt lgkmcnt(2)
v_mfma_f32_32x32x16_bf16 v[48:63], v[32:35], v[232:235], v[48:63]
v_add_u32 v2, 0xc000, v2
v_add_u32 v3, 0xc000, v3
v_add_u32 v9, 0xc000, v9
ds_read_b64_tr_b16 v[32:33], v9 offset:0
ds_read_b64_tr_b16 v[34:35], v9 offset:512
buffer_load_dwordx4 v71, s[44:47], s99 offen offset:2048 lds
s_waitcnt lgkmcnt(2)
v_mfma_f32_32x32x16_bf16 v[48:63], v[40:43], v[236:239], v[48:63]
ds_read_b64_tr_b16 v[40:41], v9 offset:2048
ds_read_b64_tr_b16 v[42:43], v9 offset:2560
buffer_load_dwordx4 v72, s[44:47], s99 offen offset:3072 lds
s_waitcnt lgkmcnt(2)
v_mfma_f32_32x32x16_bf16 v[48:63], v[32:35], v[240:243], v[48:63]
ds_read_b64_tr_b16 v[32:33], v9 offset:4096
ds_read_b64_tr_b16 v[34:35], v9 offset:4608
s_add_u32 s98, s95, 0x400
buffer_load_dwordx4 v[132:135], v64, s[48:51], s98 offen sc1
s_waitcnt lgkmcnt(2)
v_mfma_f32_32x32x16_bf16 v[48:63], v[40:43], v[244:247], v[48:63]
ds_read_b64_tr_b16 v[40:41], v9 offset:6144
ds_read_b64_tr_b16 v[42:43], v9 offset:6656
buffer_load_dwordx4 v[136:139], v65, s[48:51], s98 offen sc1
s_waitcnt lgkmcnt(2)
v_mfma_f32_32x32x16_bf16 v[48:63], v[32:35], v[248:251], v[48:63]
buffer_load_dwordx4 v[140:143], v66, s[48:51], s98 offen sc1
s_waitcnt lgkmcnt(0)
s_barrier
v_mfma_f32_32x32x16_bf16 v[48:63], v[40:43], v[252:255], v[48:63]
buffer_load_dwordx4 v[144:147], v67, s[48:51], s98 offen sc1
v_bfe_u32 v1, v0, 2, 3
v_lshrrev_b32 v31, 5, v0
v_lshl_add_u32 v31, v31, 4, v1
v_lshrrev_b32 v1, 1, v1
v_lshlrev_b32 v1, 5, v1
v_lshl_add_u32 v1, v31, 7, v1
v_and_b32 v31, 3, v0
v_lshl_add_u32 v1, v31, 3, v1
v_add_u32 v75, s97, v1
v_xor_b32 v76, 32, v75
v_xor_b32 v77, 64, v75
v_xor_b32 v78, 96, v75
s_nop 3
v_mul_f32 v12, 0xbfb8aa3b, v48
v_mul_f32 v13, 0xbfb8aa3b, v49
v_mul_f32 v14, 0xbfb8aa3b, v50
buffer_load_dwordx4 v[148:151], v68, s[48:51], s98 offen sc1
v_mul_f32 v15, 0xbfb8aa3b, v51
v_mul_f32 v16, 0xbfb8aa3b, v52
v_mul_f32 v17, 0xbfb8aa3b, v53
s_add_u32 m0, s97, 8192
s_add_u32 s99, s96, 0x5a000
buffer_load_dwordx4 v69, s[44:47], s99 offen offset:0 lds
v_mul_f32 v18, 0xbfb8aa3b, v54
v_mul_f32 v19, 0xbfb8aa3b, v55
v_exp_f32 v12, v12
buffer_load_dwordx4 v70, s[44:47], s99 offen offset:1024 lds
v_exp_f32 v13, v13
v_exp_f32 v14, v14
v_exp_f32 v15, v15
buffer_load_dwordx4 v71, s[44:47], s99 offen offset:2048 lds
v_exp_f32 v16, v16
v_exp_f32 v17, v17
v_exp_f32 v18, v18
buffer_load_dwordx4 v72, s[44:47], s99 offen offset:3072 lds
v_exp_f32 v19, v19
v_mul_f32 v56, v48, v56
v_mul_f32 v57, v49, v57
s_add_u32 s98, s95, 0x2800
buffer_load_dwordx4 v[152:155], v64, s[48:51], s98 offen sc1
v_mul_f32 v58, v50, v58
v_mul_f32 v59, v51, v59
v_mul_f32 v60, v52, v60
buffer_load_dwordx4 v[156:159], v65, s[48:51], s98 offen sc1
v_mul_f32 v61, v53, v61
v_mul_f32 v62, v54, v62
v_mul_f32 v63, v55, v63
buffer_load_dwordx4 v[160:163], v66, s[48:51], s98 offen sc1
v_add_f32 v12, 1.0, v12
v_add_f32 v13, 1.0, v13
v_add_f32 v14, 1.0, v14
buffer_load_dwordx4 v[164:167], v67, s[48:51], s98 offen sc1
v_add_f32 v15, 1.0, v15
v_add_f32 v16, 1.0, v16
v_add_f32 v17, 1.0, v17
buffer_load_dwordx4 v[168:171], v68, s[48:51], s98 offen sc1
v_add_f32 v18, 1.0, v18
v_add_f32 v19, 1.0, v19
v_rcp_f32 v12, v12
s_add_u32 m0, s97, 12288
s_add_u32 s99, s96, 0x63000
buffer_load_dwordx4 v69, s[44:47], s99 offen offset:0 lds
v_rcp_f32 v13, v13
v_rcp_f32 v14, v14
v_rcp_f32 v15, v15
buffer_load_dwordx4 v70, s[44:47], s99 offen offset:1024 lds
v_rcp_f32 v16, v16
v_rcp_f32 v17, v17
v_rcp_f32 v18, v18
buffer_load_dwordx4 v71, s[44:47], s99 offen offset:2048 lds
v_rcp_f32 v19, v19
s_nop 0
v_mul_f32 v56, v56, v12
buffer_load_dwordx4 v72, s[44:47], s99 offen offset:3072 lds
v_mul_f32 v57, v57, v13
v_mul_f32 v58, v58, v14
v_mul_f32 v59, v59, v15
s_add_u32 s98, s95, 0x2c00
buffer_load_dwordx4 v[172:175], v64, s[48:51], s98 offen sc1
v_mul_f32 v60, v60, v16
v_mul_f32 v61, v61, v17
v_mul_f32 v62, v62, v18
buffer_load_dwordx4 v[176:179], v65, s[48:51], s98 offen sc1
v_mul_f32 v63, v63, v19
v_cvt_pk_bf16_f32 v20, v56, v57
v_cvt_pk_bf16_f32 v21, v58, v59
buffer_load_dwordx4 v[180:183], v66, s[48:51], s98 offen sc1
v_cvt_pk_bf16_f32 v22, v60, v61
v_cvt_pk_bf16_f32 v23, v62, v63
s_mov_b32 s59, s67
buffer_store_dwordx4 v[20:23], v8, s[48:51], s59 offen sc1
buffer_load_dwordx4 v[184:187], v67, s[48:51], s98 offen sc1
buffer_load_dwordx4 v[188:191], v68, s[48:51], s98 offen sc1
s_add_u32 m0, s97, 16384
s_add_u32 s99, s96, 0xa2000
buffer_load_dwordx4 v69, s[44:47], s99 offen offset:0 lds
buffer_load_dwordx4 v70, s[44:47], s99 offen offset:1024 lds
buffer_load_dwordx4 v71, s[44:47], s99 offen offset:2048 lds
buffer_load_dwordx4 v72, s[44:47], s99 offen offset:3072 lds
s_waitcnt vmcnt(38)
ds_read_b64_tr_b16 v[32:33], v75 offset:0
ds_read_b64_tr_b16 v[34:35], v75 offset:1024
ds_read_b64_tr_b16 v[36:37], v76 offset:0
ds_read_b64_tr_b16 v[38:39], v76 offset:1024
ds_read_b64_tr_b16 v[40:41], v77 offset:0
ds_read_b64_tr_b16 v[42:43], v77 offset:1024
ds_read_b64_tr_b16 v[44:45], v78 offset:0
ds_read_b64_tr_b16 v[46:47], v78 offset:1024
s_mov_b32 s40, s32
s_mov_b32 s41, s33
s_mov_b32 s42, 0x240000
s_mov_b32 s43, 0x20000
s_add_u32 s68, s36, 0x1440000
s_addc_u32 s69, s37, 0
s_mov_b32 s70, 0x240000
s_mov_b32 s71, 0x20000
s_add_u32 s72, s36, 0x1680000
s_addc_u32 s73, s37, 0
s_mov_b32 s74, 0x2000
s_mov_b32 s75, 0x20000
s_cmp_lt_u32 s94, 2
s_cbranch_scc1 Lbshort
s_waitcnt vmcnt(33)
s_waitcnt vmcnt(28)
s_waitcnt lgkmcnt(0)
ds_read_b64_tr_b16 v[48:49], v75 offset:4096
ds_read_b64_tr_b16 v[50:51], v75 offset:5120
ds_read_b64_tr_b16 v[52:53], v76 offset:4096
ds_read_b64_tr_b16 v[54:55], v76 offset:5120
ds_read_b64_tr_b16 v[56:57], v77 offset:4096
ds_read_b64_tr_b16 v[58:59], v77 offset:5120
ds_read_b64_tr_b16 v[60:61], v78 offset:4096
ds_read_b64_tr_b16 v[62:63], v78 offset:5120
v_mfma_f32_16x16x32_bf16 v[192:195], v[32:35], v[112:115], 0
s_add_u32 m0, s97, 0
s_add_u32 s99, s96, 0xab000
buffer_load_dwordx4 v69, s[44:47], s99 offen offset:0 lds
v_mfma_f32_16x16x32_bf16 v[196:199], v[36:39], v[112:115], 0
v_mfma_f32_16x16x32_bf16 v[200:203], v[40:43], v[112:115], 0
v_mfma_f32_16x16x32_bf16 v[204:207], v[44:47], v[112:115], 0
s_add_u32 s98, s95, 0x4800
buffer_load_dwordx4 v[112:115], v64, s[48:51], s98 offen sc1
v_mfma_f32_16x16x32_bf16 v[208:211], v[32:35], v[116:119], 0
buffer_load_dwordx4 v70, s[44:47], s99 offen offset:1024 lds
v_mfma_f32_16x16x32_bf16 v[212:215], v[36:39], v[116:119], 0
v_mfma_f32_16x16x32_bf16 v[216:219], v[40:43], v[116:119], 0
v_mfma_f32_16x16x32_bf16 v[220:223], v[44:47], v[116:119], 0
buffer_load_dwordx4 v[116:119], v65, s[48:51], s98 offen sc1
v_mfma_f32_16x16x32_bf16 v[224:227], v[32:35], v[120:123], 0
buffer_load_dwordx4 v71, s[44:47], s99 offen offset:2048 lds
v_mfma_f32_16x16x32_bf16 v[228:231], v[36:39], v[120:123], 0
v_mfma_f32_16x16x32_bf16 v[232:235], v[40:43], v[120:123], 0
v_mfma_f32_16x16x32_bf16 v[236:239], v[44:47], v[120:123], 0
buffer_load_dwordx4 v[120:123], v66, s[48:51], s98 offen sc1
v_mfma_f32_16x16x32_bf16 v[240:243], v[32:35], v[124:127], 0
buffer_load_dwordx4 v72, s[44:47], s99 offen offset:3072 lds
v_mfma_f32_16x16x32_bf16 v[244:247], v[36:39], v[124:127], 0
v_mfma_f32_16x16x32_bf16 v[248:251], v[40:43], v[124:127], 0
v_mfma_f32_16x16x32_bf16 v[252:255], v[44:47], v[124:127], 0
buffer_load_dwordx4 v[124:127], v67, s[48:51], s98 offen sc1
v_mfma_f32_16x16x32_bf16 v[80:83], v[32:35], v[128:131], 0
v_mfma_f32_16x16x32_bf16 v[84:87], v[36:39], v[128:131], 0
v_mfma_f32_16x16x32_bf16 v[88:91], v[40:43], v[128:131], 0
v_mfma_f32_16x16x32_bf16 v[92:95], v[44:47], v[128:131], 0
buffer_load_dwordx4 v[128:131], v68, s[48:51], s98 offen sc1
s_waitcnt vmcnt(32)
s_waitcnt vmcnt(28)
s_waitcnt lgkmcnt(0)
ds_read_b64_tr_b16 v[32:33], v75 offset:8192
ds_read_b64_tr_b16 v[34:35], v75 offset:9216
ds_read_b64_tr_b16 v[36:37], v76 offset:8192
ds_read_b64_tr_b16 v[38:39], v76 offset:9216
ds_read_b64_tr_b16 v[40:41], v77 offset:8192
ds_read_b64_tr_b16 v[42:43], v77 offset:9216
ds_read_b64_tr_b16 v[44:45], v78 offset:8192
ds_read_b64_tr_b16 v[46:47], v78 offset:9216
v_mfma_f32_16x16x32_bf16 v[192:195], v[48:51], v[132:135], v[192:195]
s_add_u32 m0, s97, 4096
s_add_u32 s99, s96, 0xfc000
buffer_load_dwordx4 v69, s[44:47], s99 offen offset:0 lds
v_mfma_f32_16x16x32_bf16 v[196:199], v[52:55], v[132:135], v[196:199]
v_mfma_f32_16x16x32_bf16 v[200:203], v[56:59], v[132:135], v[200:203]
v_mfma_f32_16x16x32_bf16 v[204:207], v[60:63], v[132:135], v[204:207]
s_add_u32 s98, s95, 0x4c00
buffer_load_dwordx4 v[132:135], v64, s[48:51], s98 offen sc1
v_mfma_f32_16x16x32_bf16 v[208:211], v[48:51], v[136:139], v[208:211]
buffer_load_dwordx4 v70, s[44:47], s99 offen offset:1024 lds
v_mfma_f32_16x16x32_bf16 v[212:215], v[52:55], v[136:139], v[212:215]
v_mfma_f32_16x16x32_bf16 v[216:219], v[56:59], v[136:139], v[216:219]
v_mfma_f32_16x16x32_bf16 v[220:223], v[60:63], v[136:139], v[220:223]
buffer_load_dwordx4 v[136:139], v65, s[48:51], s98 offen sc1
v_mfma_f32_16x16x32_bf16 v[224:227], v[48:51], v[140:143], v[224:227]
buffer_load_dwordx4 v71, s[44:47], s99 offen offset:2048 lds
v_mfma_f32_16x16x32_bf16 v[228:231], v[52:55], v[140:143], v[228:231]
v_mfma_f32_16x16x32_bf16 v[232:235], v[56:59], v[140:143], v[232:235]
v_mfma_f32_16x16x32_bf16 v[236:239], v[60:63], v[140:143], v[236:239]
buffer_load_dwordx4 v[140:143], v66, s[48:51], s98 offen sc1
v_mfma_f32_16x16x32_bf16 v[240:243], v[48:51], v[144:147], v[240:243]
buffer_load_dwordx4 v72, s[44:47], s99 offen offset:3072 lds
v_mfma_f32_16x16x32_bf16 v[244:247], v[52:55], v[144:147], v[244:247]
v_mfma_f32_16x16x32_bf16 v[248:251], v[56:59], v[144:147], v[248:251]
v_mfma_f32_16x16x32_bf16 v[252:255], v[60:63], v[144:147], v[252:255]
buffer_load_dwordx4 v[144:147], v67, s[48:51], s98 offen sc1
v_mfma_f32_16x16x32_bf16 v[80:83], v[48:51], v[148:151], v[80:83]
v_mfma_f32_16x16x32_bf16 v[84:87], v[52:55], v[148:151], v[84:87]
v_mfma_f32_16x16x32_bf16 v[88:91], v[56:59], v[148:151], v[88:91]
v_mfma_f32_16x16x32_bf16 v[92:95], v[60:63], v[148:151], v[92:95]
buffer_load_dwordx4 v[148:151], v68, s[48:51], s98 offen sc1
s_lshl_b32 s60, s93, 6
s_lshl_b32 s61, s94, 4
s_add_u32 s60, s60, s61
s_lshl_b32 s61, s60, 12
s_mul_i32 s62, s92, 160
s_add_u32 s61, s61, s62
v_add_u32 v1, 0, v0
v_mul_u32_u24 v12, 6554, v1
v_lshrrev_b32 v12, 16, v12
v_mul_u32_u24 v98, 3936, v12
v_lshl_add_u32 v98, v1, 4, v98
v_add_u32 v98, s61, v98
v_add_u32 v1, 64, v0
v_mul_u32_u24 v12, 6554, v1
v_lshrrev_b32 v12, 16, v12
v_mul_u32_u24 v99, 3936, v12
v_lshl_add_u32 v99, v1, 4, v99
v_add_u32 v99, s61, v99
v_add_u32 v1, 128, v0
v_mul_u32_u24 v12, 6554, v1
v_lshrrev_b32 v12, 16, v12
v_mul_u32_u24 v100, 3936, v12
v_lshl_add_u32 v100, v1, 4, v100
v_add_u32 v100, s61, v100
v_cmp_gt_u32 vcc, 32, v0
v_mov_b32 v1, 0x40000000
s_nop 0
v_cndmask_b32 v100, v1, v100, vcc
v_lshrrev_b32 v1, 2, v0
v_mul_u32_u24 v1, 160, v1
v_and_b32 v12, 3, v0
v_lshl_add_u32 v1, v12, 3, v1
v_add_u32 v97, s97, v1
s_mul_i32 s62, s92, 80
v_and_b32 v1, 15, v0
v_add_u32 v1, s62, v1
v_lshlrev_b32 v101, 2, v1
v_mul_u32_u24 v1, 1152, v1
v_lshrrev_b32 v12, 4, v0
v_lshl_add_u32 v1, v12, 3, v1
s_lshl_b32 s60, s60, 1
v_add_u32 v96, s60, v1
v_lshl_add_u32 v79, v0, 4, s97
s_lshl_b32 s60, s93, 8
s_add_u32 s60, s60, 6144
v_and_b32 v13, 63, v0
v_lshl_add_u32 v13, v13, 2, s60
v_add_u32 v28, 2048, v30
s_waitcnt vmcnt(32)
s_waitcnt vmcnt(28)
s_waitcnt lgkmcnt(0)
ds_read_b64_tr_b16 v[48:49], v75 offset:12288
ds_read_b64_tr_b16 v[50:51], v75 offset:13312
ds_read_b64_tr_b16 v[52:53], v76 offset:12288
ds_read_b64_tr_b16 v[54:55], v76 offset:13312
ds_read_b64_tr_b16 v[56:57], v77 offset:12288
ds_read_b64_tr_b16 v[58:59], v77 offset:13312
ds_read_b64_tr_b16 v[60:61], v78 offset:12288
ds_read_b64_tr_b16 v[62:63], v78 offset:13312
v_mfma_f32_16x16x32_bf16 v[192:195], v[32:35], v[152:155], v[192:195]
s_add_u32 m0, s97, 8192
s_add_u32 s99, s96, 0x105000
buffer_load_dwordx4 v69, s[44:47], s99 offen offset:0 lds
v_mfma_f32_16x16x32_bf16 v[196:199], v[36:39], v[152:155], v[196:199]
v_mfma_f32_16x16x32_bf16 v[200:203], v[40:43], v[152:155], v[200:203]
v_mfma_f32_16x16x32_bf16 v[204:207], v[44:47], v[152:155], v[204:207]
s_add_u32 s98, s95, 0x7000
buffer_load_dwordx4 v[152:155], v64, s[48:51], s98 offen sc1
v_mfma_f32_16x16x32_bf16 v[208:211], v[32:35], v[156:159], v[208:211]
buffer_load_dwordx4 v70, s[44:47], s99 offen offset:1024 lds
v_mfma_f32_16x16x32_bf16 v[212:215], v[36:39], v[156:159], v[212:215]
v_mfma_f32_16x16x32_bf16 v[216:219], v[40:43], v[156:159], v[216:219]
v_mfma_f32_16x16x32_bf16 v[220:223], v[44:47], v[156:159], v[220:223]
buffer_load_dwordx4 v[156:159], v65, s[48:51], s98 offen sc1
v_mfma_f32_16x16x32_bf16 v[224:227], v[32:35], v[160:163], v[224:227]
buffer_load_dwordx4 v71, s[44:47], s99 offen offset:2048 lds
v_mfma_f32_16x16x32_bf16 v[228:231], v[36:39], v[160:163], v[228:231]
v_mfma_f32_16x16x32_bf16 v[232:235], v[40:43], v[160:163], v[232:235]
v_mfma_f32_16x16x32_bf16 v[236:239], v[44:47], v[160:163], v[236:239]
buffer_load_dwordx4 v[160:163], v66, s[48:51], s98 offen sc1
v_mfma_f32_16x16x32_bf16 v[240:243], v[32:35], v[164:167], v[240:243]
buffer_load_dwordx4 v72, s[44:47], s99 offen offset:3072 lds
v_mfma_f32_16x16x32_bf16 v[244:247], v[36:39], v[164:167], v[244:247]
v_mfma_f32_16x16x32_bf16 v[248:251], v[40:43], v[164:167], v[248:251]
v_mfma_f32_16x16x32_bf16 v[252:255], v[44:47], v[164:167], v[252:255]
buffer_load_dwordx4 v[164:167], v67, s[48:51], s98 offen sc1
v_mfma_f32_16x16x32_bf16 v[80:83], v[32:35], v[168:171], v[80:83]
v_mfma_f32_16x16x32_bf16 v[84:87], v[36:39], v[168:171], v[84:87]
v_mfma_f32_16x16x32_bf16 v[88:91], v[40:43], v[168:171], v[88:91]
v_mfma_f32_16x16x32_bf16 v[92:95], v[44:47], v[168:171], v[92:95]
buffer_load_dwordx4 v[168:171], v68, s[48:51], s98 offen sc1
s_waitcnt vmcnt(31)
s_waitcnt vmcnt(27)
s_waitcnt lgkmcnt(0)
ds_read_b64_tr_b16 v[32:33], v75 offset:16384
ds_read_b64_tr_b16 v[34:35], v75 offset:17408
ds_read_b64_tr_b16 v[36:37], v76 offset:16384
ds_read_b64_tr_b16 v[38:39], v76 offset:17408
ds_read_b64_tr_b16 v[40:41], v77 offset:16384
ds_read_b64_tr_b16 v[42:43], v77 offset:17408
ds_read_b64_tr_b16 v[44:45], v78 offset:16384
ds_read_b64_tr_b16 v[46:47], v78 offset:17408
v_mfma_f32_16x16x32_bf16 v[192:195], v[48:51], v[172:175], v[192:195]
s_add_u32 m0, s97, 12288
s_add_u32 s99, s96, 0x12000
buffer_load_dwordx4 v69, s[44:47], s99 offen offset:0 lds
v_mfma_f32_16x16x32_bf16 v[196:199], v[52:55], v[172:175], v[196:199]
v_mfma_f32_16x16x32_bf16 v[200:203], v[56:59], v[172:175], v[200:203]
v_mfma_f32_16x16x32_bf16 v[204:207], v[60:63], v[172:175], v[204:207]
s_add_u32 s98, s95, 0x7400
buffer_load_dwordx4 v[172:175], v64, s[48:51], s98 offen sc1
v_mfma_f32_16x16x32_bf16 v[208:211], v[48:51], v[176:179], v[208:211]
buffer_load_dwordx4 v70, s[44:47], s99 offen offset:1024 lds
v_mfma_f32_16x16x32_bf16 v[212:215], v[52:55], v[176:179], v[212:215]
v_mfma_f32_16x16x32_bf16 v[216:219], v[56:59], v[176:179], v[216:219]
v_mfma_f32_16x16x32_bf16 v[220:223], v[60:63], v[176:179], v[220:223]
buffer_load_dwordx4 v[176:179], v65, s[48:51], s98 offen sc1
v_mfma_f32_16x16x32_bf16 v[224:227], v[48:51], v[180:183], v[224:227]
buffer_load_dwordx4 v71, s[44:47], s99 offen offset:2048 lds
v_mfma_f32_16x16x32_bf16 v[228:231], v[52:55], v[180:183], v[228:231]
v_mfma_f32_16x16x32_bf16 v[232:235], v[56:59], v[180:183], v[232:235]
v_mfma_f32_16x16x32_bf16 v[236:239], v[60:63], v[180:183], v[236:239]
buffer_load_dwordx4 v[180:183], v66, s[48:51], s98 offen sc1
v_mfma_f32_16x16x32_bf16 v[240:243], v[48:51], v[184:187], v[240:243]
buffer_load_dwordx4 v72, s[44:47], s99 offen offset:3072 lds
v_mfma_f32_16x16x32_bf16 v[244:247], v[52:55], v[184:187], v[244:247]
v_mfma_f32_16x16x32_bf16 v[248:251], v[56:59], v[184:187], v[248:251]
v_mfma_f32_16x16x32_bf16 v[252:255], v[60:63], v[184:187], v[252:255]
buffer_load_dwordx4 v[184:187], v67, s[48:51], s98 offen sc1
v_mfma_f32_16x16x32_bf16 v[80:83], v[48:51], v[188:191], v[80:83]
v_mfma_f32_16x16x32_bf16 v[84:87], v[52:55], v[188:191], v[84:87]
v_mfma_f32_16x16x32_bf16 v[88:91], v[56:59], v[188:191], v[88:91]
v_mfma_f32_16x16x32_bf16 v[92:95], v[60:63], v[188:191], v[92:95]
buffer_load_dwordx4 v[188:191], v68, s[48:51], s98 offen sc1
s_waitcnt vmcnt(27)
s_lshl_b32 s60, s52, 7
s_lshl_b32 s61, s53, 2
s_add_u32 s60, s60, s61
s_add_u32 s60, s60, 4096
s_mov_b64 exec, 1
v_mov_b32 v14, 72768
v_mov_b32 v15, 1
ds_add_rtn_u32 v14, v14, v15
s_waitcnt lgkmcnt(0)
v_cmp_ne_u32 vcc, 7, v14
v_mov_b32 v14, s60
v_mov_b32 v15, s100
s_cbranch_vccnz Lsk21
buffer_store_dword v15, v14, s[84:87], 0 offen sc1
Lsk21:
s_mov_b64 exec, -1
ds_read_b64_tr_b16 v[48:49], v75 offset:0
ds_read_b64_tr_b16 v[50:51], v75 offset:1024
ds_read_b64_tr_b16 v[52:53], v76 offset:0
ds_read_b64_tr_b16 v[54:55], v76 offset:1024
ds_read_b64_tr_b16 v[56:57], v77 offset:0
ds_read_b64_tr_b16 v[58:59], v77 offset:1024
ds_read_b64_tr_b16 v[60:61], v78 offset:0
ds_read_b64_tr_b16 v[62:63], v78 offset:1024
v_mfma_f32_16x16x32_bf16 v[192:195], v[32:35], v[112:115], v[192:195]
s_add_u32 m0, s97, 16384
s_add_u32 s99, s96, 0x1b000
buffer_load_dwordx4 v69, s[44:47], s99 offen offset:0 lds
v_mfma_f32_16x16x32_bf16 v[196:199], v[36:39], v[112:115], v[196:199]
v_mfma_f32_16x16x32_bf16 v[200:203], v[40:43], v[112:115], v[200:203]
v_mfma_f32_16x16x32_bf16 v[204:207], v[44:47], v[112:115], v[204:207]
s_add_u32 s98, s95, 0x800
buffer_load_dwordx4 v[112:115], v64, s[48:51], s98 offen sc1
v_mfma_f32_16x16x32_bf16 v[208:211], v[32:35], v[116:119], v[208:211]
buffer_load_dwordx4 v70, s[44:47], s99 offen offset:1024 lds
v_mfma_f32_16x16x32_bf16 v[212:215], v[36:39], v[116:119], v[212:215]
v_mfma_f32_16x16x32_bf16 v[216:219], v[40:43], v[116:119], v[216:219]
v_mfma_f32_16x16x32_bf16 v[220:223], v[44:47], v[116:119], v[220:223]
buffer_load_dwordx4 v[116:119], v65, s[48:51], s98 offen sc1
v_mfma_f32_16x16x32_bf16 v[224:227], v[32:35], v[120:123], v[224:227]
buffer_load_dwordx4 v71, s[44:47], s99 offen offset:2048 lds
v_mfma_f32_16x16x32_bf16 v[228:231], v[36:39], v[120:123], v[228:231]
v_mfma_f32_16x16x32_bf16 v[232:235], v[40:43], v[120:123], v[232:235]
v_mfma_f32_16x16x32_bf16 v[236:239], v[44:47], v[120:123], v[236:239]
buffer_load_dwordx4 v[120:123], v66, s[48:51], s98 offen sc1
v_mfma_f32_16x16x32_bf16 v[240:243], v[32:35], v[124:127], v[240:243]
buffer_load_dwordx4 v72, s[44:47], s99 offen offset:3072 lds
v_mfma_f32_16x16x32_bf16 v[244:247], v[36:39], v[124:127], v[244:247]
v_mfma_f32_16x16x32_bf16 v[248:251], v[40:43], v[124:127], v[248:251]
v_mfma_f32_16x16x32_bf16 v[252:255], v[44:47], v[124:127], v[252:255]
buffer_load_dwordx4 v[124:127], v67, s[48:51], s98 offen sc1
v_mfma_f32_16x16x32_bf16 v[80:83], v[32:35], v[128:131], v[80:83]
v_mfma_f32_16x16x32_bf16 v[84:87], v[36:39], v[128:131], v[84:87]
v_mfma_f32_16x16x32_bf16 v[88:91], v[40:43], v[128:131], v[88:91]
v_mfma_f32_16x16x32_bf16 v[92:95], v[44:47], v[128:131], v[92:95]
buffer_load_dwordx4 v[128:131], v68, s[48:51], s98 offen sc1
s_waitcnt vmcnt(27)
s_waitcnt lgkmcnt(0)
ds_read_b64_tr_b16 v[32:33], v75 offset:4096
ds_read_b64_tr_b16 v[34:35], v75 offset:5120
ds_read_b64_tr_b16 v[36:37], v76 offset:4096
ds_read_b64_tr_b16 v[38:39], v76 offset:5120
ds_read_b64_tr_b16 v[40:41], v77 offset:4096
ds_read_b64_tr_b16 v[42:43], v77 offset:5120
ds_read_b64_tr_b16 v[44:45], v78 offset:4096
ds_read_b64_tr_b16 v[46:47], v78 offset:5120
v_mfma_f32_16x16x32_bf16 v[192:195], v[48:51], v[132:135], v[192:195]
s_add_u32 m0, s97, 0
s_add_u32 s99, s96, 0x6c000
buffer_load_dwordx4 v69, s[44:47], s99 offen offset:0 lds
v_mfma_f32_16x16x32_bf16 v[196:199], v[52:55], v[132:135], v[196:199]
v_mfma_f32_16x16x32_bf16 v[200:203], v[56:59], v[132:135], v[200:203]
v_mfma_f32_16x16x32_bf16 v[204:207], v[60:63], v[132:135], v[204:207]
s_add_u32 s98, s95, 0xc00
buffer_load_dwordx4 v[132:135], v64, s[48:51], s98 offen sc1
v_mfma_f32_16x16x32_bf16 v[208:211], v[48:51], v[136:139], v[208:211]
buffer_load_dwordx4 v70, s[44:47], s99 offen offset:1024 lds
v_mfma_f32_16x16x32_bf16 v[212:215], v[52:55], v[136:139], v[212:215]
v_mfma_f32_16x16x32_bf16 v[216:219], v[56:59], v[136:139], v[216:219]
v_mfma_f32_16x16x32_bf16 v[220:223], v[60:63], v[136:139], v[220:223]
buffer_load_dwordx4 v[136:139], v65, s[48:51], s98 offen sc1
v_mfma_f32_16x16x32_bf16 v[224:227], v[48:51], v[140:143], v[224:227]
buffer_load_dwordx4 v71, s[44:47], s99 offen offset:2048 lds
v_mfma_f32_16x16x32_bf16 v[228:231], v[52:55], v[140:143], v[228:231]
v_mfma_f32_16x16x32_bf16 v[232:235], v[56:59], v[140:143], v[232:235]
v_mfma_f32_16x16x32_bf16 v[236:239], v[60:63], v[140:143], v[236:239]
buffer_load_dwordx4 v[140:143], v66, s[48:51], s98 offen sc1
v_mfma_f32_16x16x32_bf16 v[240:243], v[48:51], v[144:147], v[240:243]
buffer_load_dwordx4 v72, s[44:47], s99 offen offset:3072 lds
v_mfma_f32_16x16x32_bf16 v[244:247], v[52:55], v[144:147], v[244:247]
v_mfma_f32_16x16x32_bf16 v[248:251], v[56:59], v[144:147], v[248:251]
v_mfma_f32_16x16x32_bf16 v[252:255], v[60:63], v[144:147], v[252:255]
buffer_load_dwordx4 v[144:147], v67, s[48:51], s98 offen sc1
v_mfma_f32_16x16x32_bf16 v[80:83], v[48:51], v[148:151], v[80:83]
v_mfma_f32_16x16x32_bf16 v[84:87], v[52:55], v[148:151], v[84:87]
v_mfma_f32_16x16x32_bf16 v[88:91], v[56:59], v[148:151], v[88:91]
v_mfma_f32_16x16x32_bf16 v[92:95], v[60:63], v[148:151], v[92:95]
buffer_load_dwordx4 v[148:151], v68, s[48:51], s98 offen sc1
s_waitcnt vmcnt(27)
s_waitcnt lgkmcnt(0)
ds_read_b64_tr_b16 v[48:49], v75 offset:8192
ds_read_b64_tr_b16 v[50:51], v75 offset:9216
ds_read_b64_tr_b16 v[52:53], v76 offset:8192
ds_read_b64_tr_b16 v[54:55], v76 offset:9216
ds_read_b64_tr_b16 v[56:57], v77 offset:8192
ds_read_b64_tr_b16 v[58:59], v77 offset:9216
ds_read_b64_tr_b16 v[60:61], v78 offset:8192
ds_read_b64_tr_b16 v[62:63], v78 offset:9216
v_mfma_f32_16x16x32_bf16 v[192:195], v[32:35], v[152:155], v[192:195]
s_add_u32 m0, s97, 4096
s_add_u32 s99, s96, 0x75000
buffer_load_dwordx4 v69, s[44:47], s99 offen offset:0 lds
v_mfma_f32_16x16x32_bf16 v[196:199], v[36:39], v[152:155], v[196:199]
v_mfma_f32_16x16x32_bf16 v[200:203], v[40:43], v[152:155], v[200:203]
v_mfma_f32_16x16x32_bf16 v[204:207], v[44:47], v[152:155], v[204:207]
s_add_u32 s98, s95, 0x3000
buffer_load_dwordx4 v[152:155], v64, s[48:51], s98 offen sc1
v_mfma_f32_16x16x32_bf16 v[208:211], v[32:35], v[156:159], v[208:211]
buffer_load_dwordx4 v70, s[44:47], s99 offen offset:1024 lds
v_mfma_f32_16x16x32_bf16 v[212:215], v[36:39], v[156:159], v[212:215]
v_mfma_f32_16x16x32_bf16 v[216:219], v[40:43], v[156:159], v[216:219]
v_mfma_f32_16x16x32_bf16 v[220:223], v[44:47], v[156:159], v[220:223]
buffer_load_dwordx4 v[156:159], v65, s[48:51], s98 offen sc1
v_mfma_f32_16x16x32_bf16 v[224:227], v[32:35], v[160:163], v[224:227]
buffer_load_dwordx4 v71, s[44:47], s99 offen offset:2048 lds
v_mfma_f32_16x16x32_bf16 v[228:231], v[36:39], v[160:163], v[228:231]
v_mfma_f32_16x16x32_bf16 v[232:235], v[40:43], v[160:163], v[232:235]
v_mfma_f32_16x16x32_bf16 v[236:239], v[44:47], v[160:163], v[236:239]
buffer_load_dwordx4 v[160:163], v66, s[48:51], s98 offen sc1
v_mfma_f32_16x16x32_bf16 v[240:243], v[32:35], v[164:167], v[240:243]
buffer_load_dwordx4 v72, s[44:47], s99 offen offset:3072 lds
v_mfma_f32_16x16x32_bf16 v[244:247], v[36:39], v[164:167], v[244:247]
v_mfma_f32_16x16x32_bf16 v[248:251], v[40:43], v[164:167], v[248:251]
v_mfma_f32_16x16x32_bf16 v[252:255], v[44:47], v[164:167], v[252:255]
buffer_load_dwordx4 v[164:167], v67, s[48:51], s98 offen sc1
v_mfma_f32_16x16x32_bf16 v[80:83], v[32:35], v[168:171], v[80:83]
v_mfma_f32_16x16x32_bf16 v[84:87], v[36:39], v[168:171], v[84:87]
v_mfma_f32_16x16x32_bf16 v[88:91], v[40:43], v[168:171], v[88:91]
v_mfma_f32_16x16x32_bf16 v[92:95], v[44:47], v[168:171], v[92:95]
buffer_load_dwordx4 v[168:171], v68, s[48:51], s98 offen sc1
s_waitcnt vmcnt(27)
s_waitcnt lgkmcnt(0)
ds_read_b64_tr_b16 v[32:33], v75 offset:12288
ds_read_b64_tr_b16 v[34:35], v75 offset:13312
ds_read_b64_tr_b16 v[36:37], v76 offset:12288
ds_read_b64_tr_b16 v[38:39], v76 offset:13312
ds_read_b64_tr_b16 v[40:41], v77 offset:12288
ds_read_b64_tr_b16 v[42:43], v77 offset:13312
ds_read_b64_tr_b16 v[44:45], v78 offset:12288
ds_read_b64_tr_b16 v[46:47], v78 offset:13312
v_mfma_f32_16x16x32_bf16 v[192:195], v[48:51], v[172:175], v[192:195]
s_add_u32 m0, s97, 8192
s_add_u32 s99, s96, 0xb4000
buffer_load_dwordx4 v69, s[44:47], s99 offen offset:0 lds
v_mfma_f32_16x16x32_bf16 v[196:199], v[52:55], v[172:175], v[196:199]
v_mfma_f32_16x16x32_bf16 v[200:203], v[56:59], v[172:175], v[200:203]
v_mfma_f32_16x16x32_bf16 v[204:207], v[60:63], v[172:175], v[204:207]
s_add_u32 s98, s95, 0x3400
buffer_load_dwordx4 v[172:175], v64, s[48:51], s98 offen sc1
v_mfma_f32_16x16x32_bf16 v[208:211], v[48:51], v[176:179], v[208:211]
buffer_load_dwordx4 v70, s[44:47], s99 offen offset:1024 lds
v_mfma_f32_16x16x32_bf16 v[212:215], v[52:55], v[176:179], v[212:215]
v_mfma_f32_16x16x32_bf16 v[216:219], v[56:59], v[176:179], v[216:219]
v_mfma_f32_16x16x32_bf16 v[220:223], v[60:63], v[176:179], v[220:223]
buffer_load_dwordx4 v[176:179], v65, s[48:51], s98 offen sc1
v_mfma_f32_16x16x32_bf16 v[224:227], v[48:51], v[180:183], v[224:227]
buffer_load_dwordx4 v71, s[44:47], s99 offen offset:2048 lds
v_mfma_f32_16x16x32_bf16 v[228:231], v[52:55], v[180:183], v[228:231]
v_mfma_f32_16x16x32_bf16 v[232:235], v[56:59], v[180:183], v[232:235]
v_mfma_f32_16x16x32_bf16 v[236:239], v[60:63], v[180:183], v[236:239]
buffer_load_dwordx4 v[180:183], v66, s[48:51], s98 offen sc1
v_mfma_f32_16x16x32_bf16 v[240:243], v[48:51], v[184:187], v[240:243]
buffer_load_dwordx4 v72, s[44:47], s99 offen offset:3072 lds
v_mfma_f32_16x16x32_bf16 v[244:247], v[52:55], v[184:187], v[244:247]
v_mfma_f32_16x16x32_bf16 v[248:251], v[56:59], v[184:187], v[248:251]
v_mfma_f32_16x16x32_bf16 v[252:255], v[60:63], v[184:187], v[252:255]
buffer_load_dwordx4 v[184:187], v67, s[48:51], s98 offen sc1
v_mfma_f32_16x16x32_bf16 v[80:83], v[48:51], v[188:191], v[80:83]
v_mfma_f32_16x16x32_bf16 v[84:87], v[52:55], v[188:191], v[84:87]
v_mfma_f32_16x16x32_bf16 v[88:91], v[56:59], v[188:191], v[88:91]
v_mfma_f32_16x16x32_bf16 v[92:95], v[60:63], v[188:191], v[92:95]
buffer_load_dwordx4 v[188:191], v68, s[48:51], s98 offen sc1
s_waitcnt vmcnt(27)
s_waitcnt lgkmcnt(0)
ds_read_b64_tr_b16 v[48:49], v75 offset:16384
ds_read_b64_tr_b16 v[50:51], v75 offset:17408
ds_read_b64_tr_b16 v[52:53], v76 offset:16384
ds_read_b64_tr_b16 v[54:55], v76 offset:17408
ds_read_b64_tr_b16 v[56:57], v77 offset:16384
ds_read_b64_tr_b16 v[58:59], v77 offset:17408
ds_read_b64_tr_b16 v[60:61], v78 offset:16384
ds_read_b64_tr_b16 v[62:63], v78 offset:17408
v_mfma_f32_16x16x32_bf16 v[192:195], v[32:35], v[112:115], v[192:195]
s_add_u32 m0, s97, 12288
s_add_u32 s99, s96, 0xbd000
buffer_load_dwordx4 v69, s[44:47], s99 offen offset:0 lds
v_mfma_f32_16x16x32_bf16 v[196:199], v[36:39], v[112:115], v[196:199]
v_mfma_f32_16x16x32_bf16 v[200:203], v[40:43], v[112:115], v[200:203]
v_mfma_f32_16x16x32_bf16 v[204:207], v[44:47], v[112:115], v[204:207]
s_add_u32 s98, s95, 0x5000
buffer_load_dwordx4 v[112:115], v64, s[48:51], s98 offen sc1
v_mfma_f32_16x16x32_bf16 v[208:211], v[32:35], v[116:119], v[208:211]
buffer_load_dwordx4 v70, s[44:47], s99 offen offset:1024 lds
v_mfma_f32_16x16x32_bf16 v[212:215], v[36:39], v[116:119], v[212:215]
v_mfma_f32_16x16x32_bf16 v[216:219], v[40:43], v[116:119], v[216:219]
v_mfma_f32_16x16x32_bf16 v[220:223], v[44:47], v[116:119], v[220:223]
buffer_load_dwordx4 v[116:119], v65, s[48:51], s98 offen sc1
v_mfma_f32_16x16x32_bf16 v[224:227], v[32:35], v[120:123], v[224:227]
buffer_load_dwordx4 v71, s[44:47], s99 offen offset:2048 lds
v_mfma_f32_16x16x32_bf16 v[228:231], v[36:39], v[120:123], v[228:231]
v_mfma_f32_16x16x32_bf16 v[232:235], v[40:43], v[120:123], v[232:235]
v_mfma_f32_16x16x32_bf16 v[236:239], v[44:47], v[120:123], v[236:239]
buffer_load_dwordx4 v[120:123], v66, s[48:51], s98 offen sc1
v_mfma_f32_16x16x32_bf16 v[240:243], v[32:35], v[124:127], v[240:243]
buffer_load_dwordx4 v72, s[44:47], s99 offen offset:3072 lds
v_mfma_f32_16x16x32_bf16 v[244:247], v[36:39], v[124:127], v[244:247]
v_mfma_f32_16x16x32_bf16 v[248:251], v[40:43], v[124:127], v[248:251]
v_mfma_f32_16x16x32_bf16 v[252:255], v[44:47], v[124:127], v[252:255]
buffer_load_dwordx4 v[124:127], v67, s[48:51], s98 offen sc1
v_mfma_f32_16x16x32_bf16 v[80:83], v[32:35], v[128:131], v[80:83]
v_mfma_f32_16x16x32_bf16 v[84:87], v[36:39], v[128:131], v[84:87]
v_mfma_f32_16x16x32_bf16 v[88:91], v[40:43], v[128:131], v[88:91]
v_mfma_f32_16x16x32_bf16 v[92:95], v[44:47], v[128:131], v[92:95]
buffer_load_dwordx4 v[128:131], v68, s[48:51], s98 offen sc1
s_waitcnt vmcnt(27)
s_waitcnt lgkmcnt(0)
ds_read_b64_tr_b16 v[32:33], v75 offset:0
ds_read_b64_tr_b16 v[34:35], v75 offset:1024
ds_read_b64_tr_b16 v[36:37], v76 offset:0
ds_read_b64_tr_b16 v[38:39], v76 offset:1024
ds_read_b64_tr_b16 v[40:41], v77 offset:0
ds_read_b64_tr_b16 v[42:43], v77 offset:1024
ds_read_b64_tr_b16 v[44:45], v78 offset:0
ds_read_b64_tr_b16 v[46:47], v78 offset:1024
v_mfma_f32_16x16x32_bf16 v[192:195], v[48:51], v[132:135], v[192:195]
s_add_u32 m0, s97, 16384
s_add_u32 s99, s96, 0x10e000
buffer_load_dwordx4 v69, s[44:47], s99 offen offset:0 lds
v_mfma_f32_16x16x32_bf16 v[196:199], v[52:55], v[132:135], v[196:199]
v_mfma_f32_16x16x32_bf16 v[200:203], v[56:59], v[132:135], v[200:203]
v_mfma_f32_16x16x32_bf16 v[204:207], v[60:63], v[132:135], v[204:207]
s_add_u32 s98, s95, 0x5400
buffer_load_dwordx4 v[132:135], v64, s[48:51], s98 offen sc1
v_mfma_f32_16x16x32_bf16 v[208:211], v[48:51], v[136:139], v[208:211]
buffer_load_dwordx4 v70, s[44:47], s99 offen offset:1024 lds
v_mfma_f32_16x16x32_bf16 v[212:215], v[52:55], v[136:139], v[212:215]
v_mfma_f32_16x16x32_bf16 v[216:219], v[56:59], v[136:139], v[216:219]
v_mfma_f32_16x16x32_bf16 v[220:223], v[60:63], v[136:139], v[220:223]
buffer_load_dwordx4 v[136:139], v65, s[48:51], s98 offen sc1
v_mfma_f32_16x16x32_bf16 v[224:227], v[48:51], v[140:143], v[224:227]
buffer_load_dwordx4 v71, s[44:47], s99 offen offset:2048 lds
v_mfma_f32_16x16x32_bf16 v[228:231], v[52:55], v[140:143], v[228:231]
v_mfma_f32_16x16x32_bf16 v[232:235], v[56:59], v[140:143], v[232:235]
v_mfma_f32_16x16x32_bf16 v[236:239], v[60:63], v[140:143], v[236:239]
buffer_load_dwordx4 v[140:143], v66, s[48:51], s98 offen sc1
v_mfma_f32_16x16x32_bf16 v[240:243], v[48:51], v[144:147], v[240:243]
buffer_load_dwordx4 v72, s[44:47], s99 offen offset:3072 lds
v_mfma_f32_16x16x32_bf16 v[244:247], v[52:55], v[144:147], v[244:247]
v_mfma_f32_16x16x32_bf16 v[248:251], v[56:59], v[144:147], v[248:251]
v_mfma_f32_16x16x32_bf16 v[252:255], v[60:63], v[144:147], v[252:255]
buffer_load_dwordx4 v[144:147], v67, s[48:51], s98 offen sc1
v_mfma_f32_16x16x32_bf16 v[80:83], v[48:51], v[148:151], v[80:83]
v_mfma_f32_16x16x32_bf16 v[84:87], v[52:55], v[148:151], v[84:87]
v_mfma_f32_16x16x32_bf16 v[88:91], v[56:59], v[148:151], v[88:91]
v_mfma_f32_16x16x32_bf16 v[92:95], v[60:63], v[148:151], v[92:95]
buffer_load_dwordx4 v[148:151], v68, s[48:51], s98 offen sc1
s_waitcnt vmcnt(27)
s_waitcnt lgkmcnt(0)
ds_read_b64_tr_b16 v[48:49], v75 offset:4096
ds_read_b64_tr_b16 v[50:51], v75 offset:5120
ds_read_b64_tr_b16 v[52:53], v76 offset:4096
ds_read_b64_tr_b16 v[54:55], v76 offset:5120
ds_read_b64_tr_b16 v[56:57], v77 offset:4096
ds_read_b64_tr_b16 v[58:59], v77 offset:5120
ds_read_b64_tr_b16 v[60:61], v78 offset:4096
ds_read_b64_tr_b16 v[62:63], v78 offset:5120
v_mfma_f32_16x16x32_bf16 v[192:195], v[32:35], v[152:155], v[192:195]
s_add_u32 m0, s97, 0
s_add_u32 s99, s96, 0x117000
buffer_load_dwordx4 v69, s[44:47], s99 offen offset:0 lds
v_mfma_f32_16x16x32_bf16 v[196:199], v[36:39], v[152:155], v[196:199]
v_mfma_f32_16x16x32_bf16 v[200:203], v[40:43], v[152:155], v[200:203]
v_mfma_f32_16x16x32_bf16 v[204:207], v[44:47], v[152:155], v[204:207]
s_add_u32 s98, s95, 0x7800
buffer_load_dwordx4 v[152:155], v64, s[48:51], s98 offen sc1
v_mfma_f32_16x16x32_bf16 v[208:211], v[32:35], v[156:159], v[208:211]
buffer_load_dwordx4 v70, s[44:47], s99 offen offset:1024 lds
v_mfma_f32_16x16x32_bf16 v[212:215], v[36:39], v[156:159], v[212:215]
v_mfma_f32_16x16x32_bf16 v[216:219], v[40:43], v[156:159], v[216:219]
v_mfma_f32_16x16x32_bf16 v[220:223], v[44:47], v[156:159], v[220:223]
buffer_load_dwordx4 v[156:159], v65, s[48:51], s98 offen sc1
v_mfma_f32_16x16x32_bf16 v[224:227], v[32:35], v[160:163], v[224:227]
buffer_load_dwordx4 v71, s[44:47], s99 offen offset:2048 lds
v_mfma_f32_16x16x32_bf16 v[228:231], v[36:39], v[160:163], v[228:231]
v_mfma_f32_16x16x32_bf16 v[232:235], v[40:43], v[160:163], v[232:235]
v_mfma_f32_16x16x32_bf16 v[236:239], v[44:47], v[160:163], v[236:239]
buffer_load_dwordx4 v[160:163], v66, s[48:51], s98 offen sc1
v_mfma_f32_16x16x32_bf16 v[240:243], v[32:35], v[164:167], v[240:243]
buffer_load_dwordx4 v72, s[44:47], s99 offen offset:3072 lds
v_mfma_f32_16x16x32_bf16 v[244:247], v[36:39], v[164:167], v[244:247]
v_mfma_f32_16x16x32_bf16 v[248:251], v[40:43], v[164:167], v[248:251]
v_mfma_f32_16x16x32_bf16 v[252:255], v[44:47], v[164:167], v[252:255]
buffer_load_dwordx4 v[164:167], v67, s[48:51], s98 offen sc1
v_mfma_f32_16x16x32_bf16 v[80:83], v[32:35], v[168:171], v[80:83]
v_mfma_f32_16x16x32_bf16 v[84:87], v[36:39], v[168:171], v[84:87]
v_mfma_f32_16x16x32_bf16 v[88:91], v[40:43], v[168:171], v[88:91]
v_mfma_f32_16x16x32_bf16 v[92:95], v[44:47], v[168:171], v[92:95]
buffer_load_dwordx4 v[168:171], v68, s[48:51], s98 offen sc1
s_waitcnt vmcnt(27)
s_waitcnt lgkmcnt(0)
ds_read_b64_tr_b16 v[32:33], v75 offset:8192
ds_read_b64_tr_b16 v[34:35], v75 offset:9216
ds_read_b64_tr_b16 v[36:37], v76 offset:8192
ds_read_b64_tr_b16 v[38:39], v76 offset:9216
ds_read_b64_tr_b16 v[40:41], v77 offset:8192
ds_read_b64_tr_b16 v[42:43], v77 offset:9216
ds_read_b64_tr_b16 v[44:45], v78 offset:8192
ds_read_b64_tr_b16 v[46:47], v78 offset:9216
v_mfma_f32_16x16x32_bf16 v[192:195], v[48:51], v[172:175], v[192:195]
s_add_u32 m0, s97, 4096
s_add_u32 s99, s96, 0xffd93000
buffer_load_dwordx4 v69, s[44:47], s99 offen offset:0 lds
v_mfma_f32_16x16x32_bf16 v[196:199], v[52:55], v[172:175], v[196:199]
v_mfma_f32_16x16x32_bf16 v[200:203], v[56:59], v[172:175], v[200:203]
v_mfma_f32_16x16x32_bf16 v[204:207], v[60:63], v[172:175], v[204:207]
s_add_u32 s98, s95, 0x7c00
buffer_load_dwordx4 v[172:175], v64, s[48:51], s98 offen sc1
v_mfma_f32_16x16x32_bf16 v[208:211], v[48:51], v[176:179], v[208:211]
buffer_load_dwordx4 v70, s[44:47], s99 offen offset:1024 lds
v_mfma_f32_16x16x32_bf16 v[212:215], v[52:55], v[176:179], v[212:215]
v_mfma_f32_16x16x32_bf16 v[216:219], v[56:59], v[176:179], v[216:219]
v_mfma_f32_16x16x32_bf16 v[220:223], v[60:63], v[176:179], v[220:223]
buffer_load_dwordx4 v[176:179], v65, s[48:51], s98 offen sc1
v_mfma_f32_16x16x32_bf16 v[224:227], v[48:51], v[180:183], v[224:227]
buffer_load_dwordx4 v71, s[44:47], s99 offen offset:2048 lds
v_mfma_f32_16x16x32_bf16 v[228:231], v[52:55], v[180:183], v[228:231]
v_mfma_f32_16x16x32_bf16 v[232:235], v[56:59], v[180:183], v[232:235]
v_mfma_f32_16x16x32_bf16 v[236:239], v[60:63], v[180:183], v[236:239]
buffer_load_dwordx4 v[180:183], v66, s[48:51], s98 offen sc1
v_mfma_f32_16x16x32_bf16 v[240:243], v[48:51], v[184:187], v[240:243]
buffer_load_dwordx4 v72, s[44:47], s99 offen offset:3072 lds
v_mfma_f32_16x16x32_bf16 v[244:247], v[52:55], v[184:187], v[244:247]
v_mfma_f32_16x16x32_bf16 v[248:251], v[56:59], v[184:187], v[248:251]
v_mfma_f32_16x16x32_bf16 v[252:255], v[60:63], v[184:187], v[252:255]
buffer_load_dwordx4 v[184:187], v67, s[48:51], s98 offen sc1
v_mfma_f32_16x16x32_bf16 v[80:83], v[48:51], v[188:191], v[80:83]
v_mfma_f32_16x16x32_bf16 v[84:87], v[52:55], v[188:191], v[84:87]
v_mfma_f32_16x16x32_bf16 v[88:91], v[56:59], v[188:191], v[88:91]
v_mfma_f32_16x16x32_bf16 v[92:95], v[60:63], v[188:191], v[92:95]
buffer_load_dwordx4 v[188:191], v68, s[48:51], s98 offen sc1
s_waitcnt vmcnt(27)
s_waitcnt lgkmcnt(0)
ds_read_b64_tr_b16 v[48:49], v75 offset:12288
ds_read_b64_tr_b16 v[50:51], v75 offset:13312
ds_read_b64_tr_b16 v[52:53], v76 offset:12288
ds_read_b64_tr_b16 v[54:55], v76 offset:13312
ds_read_b64_tr_b16 v[56:57], v77 offset:12288
ds_read_b64_tr_b16 v[58:59], v77 offset:13312
ds_read_b64_tr_b16 v[60:61], v78 offset:12288
ds_read_b64_tr_b16 v[62:63], v78 offset:13312
v_mfma_f32_16x16x32_bf16 v[192:195], v[32:35], v[112:115], v[192:195]
s_add_u32 m0, s97, 8192
s_add_u32 s99, s96, 0xffde4000
buffer_load_dwordx4 v69, s[44:47], s99 offen offset:0 lds
v_mfma_f32_16x16x32_bf16 v[196:199], v[36:39], v[112:115], v[196:199]
v_mfma_f32_16x16x32_bf16 v[200:203], v[40:43], v[112:115], v[200:203]
v_mfma_f32_16x16x32_bf16 v[204:207], v[44:47], v[112:115], v[204:207]
s_add_u32 s98, s95, 0xfffeec00
buffer_load_dwordx4 v[112:115], v64, s[48:51], s98 offen sc1
v_mfma_f32_16x16x32_bf16 v[208:211], v[32:35], v[116:119], v[208:211]
buffer_load_dwordx4 v70, s[44:47], s99 offen offset:1024 lds
v_mfma_f32_16x16x32_bf16 v[212:215], v[36:39], v[116:119], v[212:215]
v_mfma_f32_16x16x32_bf16 v[216:219], v[40:43], v[116:119], v[216:219]
v_mfma_f32_16x16x32_bf16 v[220:223], v[44:47], v[116:119], v[220:223]
buffer_load_dwordx4 v[116:119], v65, s[48:51], s98 offen sc1
v_mfma_f32_16x16x32_bf16 v[224:227], v[32:35], v[120:123], v[224:227]
buffer_load_dwordx4 v71, s[44:47], s99 offen offset:2048 lds
v_mfma_f32_16x16x32_bf16 v[228:231], v[36:39], v[120:123], v[228:231]
v_mfma_f32_16x16x32_bf16 v[232:235], v[40:43], v[120:123], v[232:235]
v_mfma_f32_16x16x32_bf16 v[236:239], v[44:47], v[120:123], v[236:239]
buffer_load_dwordx4 v[120:123], v66, s[48:51], s98 offen sc1
v_mfma_f32_16x16x32_bf16 v[240:243], v[32:35], v[124:127], v[240:243]
buffer_load_dwordx4 v72, s[44:47], s99 offen offset:3072 lds
v_mfma_f32_16x16x32_bf16 v[244:247], v[36:39], v[124:127], v[244:247]
v_mfma_f32_16x16x32_bf16 v[248:251], v[40:43], v[124:127], v[248:251]
v_mfma_f32_16x16x32_bf16 v[252:255], v[44:47], v[124:127], v[252:255]
buffer_load_dwordx4 v[124:127], v67, s[48:51], s98 offen sc1
v_mfma_f32_16x16x32_bf16 v[80:83], v[32:35], v[128:131], v[80:83]
v_mfma_f32_16x16x32_bf16 v[84:87], v[36:39], v[128:131], v[84:87]
v_mfma_f32_16x16x32_bf16 v[88:91], v[40:43], v[128:131], v[88:91]
v_mfma_f32_16x16x32_bf16 v[92:95], v[44:47], v[128:131], v[92:95]
buffer_load_dwordx4 v[128:131], v68, s[48:51], s98 offen sc1
s_waitcnt vmcnt(27)
s_waitcnt lgkmcnt(0)
ds_read_b64_tr_b16 v[32:33], v75 offset:16384
ds_read_b64_tr_b16 v[34:35], v75 offset:17408
ds_read_b64_tr_b16 v[36:37], v76 offset:16384
ds_read_b64_tr_b16 v[38:39], v76 offset:17408
ds_read_b64_tr_b16 v[40:41], v77 offset:16384
ds_read_b64_tr_b16 v[42:43], v77 offset:17408
ds_read_b64_tr_b16 v[44:45], v78 offset:16384
ds_read_b64_tr_b16 v[46:47], v78 offset:17408
v_mfma_f32_16x16x32_bf16 v[192:195], v[48:51], v[132:135], v[192:195]
s_add_u32 m0, s97, 12288
s_add_u32 s99, s96, 0xffded000
buffer_load_dwordx4 v69, s[44:47], s99 offen offset:0 lds
v_mfma_f32_16x16x32_bf16 v[196:199], v[52:55], v[132:135], v[196:199]
v_mfma_f32_16x16x32_bf16 v[200:203], v[56:59], v[132:135], v[200:203]
v_mfma_f32_16x16x32_bf16 v[204:207], v[60:63], v[132:135], v[204:207]
s_add_u32 s98, s95, 0xffff1000
buffer_load_dwordx4 v[132:135], v64, s[48:51], s98 offen sc1
v_mfma_f32_16x16x32_bf16 v[208:211], v[48:51], v[136:139], v[208:211]
buffer_load_dwordx4 v70, s[44:47], s99 offen offset:1024 lds
v_mfma_f32_16x16x32_bf16 v[212:215], v[52:55], v[136:139], v[212:215]
v_mfma_f32_16x16x32_bf16 v[216:219], v[56:59], v[136:139], v[216:219]
v_mfma_f32_16x16x32_bf16 v[220:223], v[60:63], v[136:139], v[220:223]
buffer_load_dwordx4 v[136:139], v65, s[48:51], s98 offen sc1
v_mfma_f32_16x16x32_bf16 v[224:227], v[48:51], v[140:143], v[224:227]
buffer_load_dwordx4 v71, s[44:47], s99 offen offset:2048 lds
v_mfma_f32_16x16x32_bf16 v[228:231], v[52:55], v[140:143], v[228:231]
v_mfma_f32_16x16x32_bf16 v[232:235], v[56:59], v[140:143], v[232:235]
v_mfma_f32_16x16x32_bf16 v[236:239], v[60:63], v[140:143], v[236:239]
buffer_load_dwordx4 v[140:143], v66, s[48:51], s98 offen sc1
v_mfma_f32_16x16x32_bf16 v[240:243], v[48:51], v[144:147], v[240:243]
buffer_load_dwordx4 v72, s[44:47], s99 offen offset:3072 lds
v_mfma_f32_16x16x32_bf16 v[244:247], v[52:55], v[144:147], v[244:247]
v_mfma_f32_16x16x32_bf16 v[248:251], v[56:59], v[144:147], v[248:251]
v_mfma_f32_16x16x32_bf16 v[252:255], v[60:63], v[144:147], v[252:255]
buffer_load_dwordx4 v[144:147], v67, s[48:51], s98 offen sc1
v_mfma_f32_16x16x32_bf16 v[80:83], v[48:51], v[148:151], v[80:83]
v_mfma_f32_16x16x32_bf16 v[84:87], v[52:55], v[148:151], v[84:87]
v_mfma_f32_16x16x32_bf16 v[88:91], v[56:59], v[148:151], v[88:91]
v_mfma_f32_16x16x32_bf16 v[92:95], v[60:63], v[148:151], v[92:95]
buffer_load_dwordx4 v[148:151], v68, s[48:51], s98 offen sc1
s_waitcnt vmcnt(27)
s_waitcnt lgkmcnt(0)
ds_read_b64_tr_b16 v[48:49], v75 offset:0
ds_read_b64_tr_b16 v[50:51], v75 offset:1024
ds_read_b64_tr_b16 v[52:53], v76 offset:0
ds_read_b64_tr_b16 v[54:55], v76 offset:1024
ds_read_b64_tr_b16 v[56:57], v77 offset:0
ds_read_b64_tr_b16 v[58:59], v77 offset:1024
ds_read_b64_tr_b16 v[60:61], v78 offset:0
ds_read_b64_tr_b16 v[62:63], v78 offset:1024
v_mfma_f32_16x16x32_bf16 v[192:195], v[32:35], v[152:155], v[192:195]
s_add_u32 m0, s97, 16384
s_add_u32 s99, s96, 0xffe2c000
buffer_load_dwordx4 v69, s[44:47], s99 offen offset:0 lds
v_mfma_f32_16x16x32_bf16 v[196:199], v[36:39], v[152:155], v[196:199]
v_mfma_f32_16x16x32_bf16 v[200:203], v[40:43], v[152:155], v[200:203]
v_mfma_f32_16x16x32_bf16 v[204:207], v[44:47], v[152:155], v[204:207]
s_add_u32 s98, s95, 0xffff1400
buffer_load_dwordx4 v[152:155], v64, s[48:51], s98 offen sc1
v_mfma_f32_16x16x32_bf16 v[208:211], v[32:35], v[156:159], v[208:211]
buffer_load_dwordx4 v70, s[44:47], s99 offen offset:1024 lds
v_mfma_f32_16x16x32_bf16 v[212:215], v[36:39], v[156:159], v[212:215]
v_mfma_f32_16x16x32_bf16 v[216:219], v[40:43], v[156:159], v[216:219]
v_mfma_f32_16x16x32_bf16 v[220:223], v[44:47], v[156:159], v[220:223]
buffer_load_dwordx4 v[156:159], v65, s[48:51], s98 offen sc1
v_mfma_f32_16x16x32_bf16 v[224:227], v[32:35], v[160:163], v[224:227]
buffer_load_dwordx4 v71, s[44:47], s99 offen offset:2048 lds
v_mfma_f32_16x16x32_bf16 v[228:231], v[36:39], v[160:163], v[228:231]
v_mfma_f32_16x16x32_bf16 v[232:235], v[40:43], v[160:163], v[232:235]
v_mfma_f32_16x16x32_bf16 v[236:239], v[44:47], v[160:163], v[236:239]
buffer_load_dwordx4 v[160:163], v66, s[48:51], s98 offen sc1
v_mfma_f32_16x16x32_bf16 v[240:243], v[32:35], v[164:167], v[240:243]
buffer_load_dwordx4 v72, s[44:47], s99 offen offset:3072 lds
v_mfma_f32_16x16x32_bf16 v[244:247], v[36:39], v[164:167], v[244:247]
v_mfma_f32_16x16x32_bf16 v[248:251], v[40:43], v[164:167], v[248:251]
v_mfma_f32_16x16x32_bf16 v[252:255], v[44:47], v[164:167], v[252:255]
buffer_load_dwordx4 v[164:167], v67, s[48:51], s98 offen sc1
v_mfma_f32_16x16x32_bf16 v[80:83], v[32:35], v[168:171], v[80:83]
v_mfma_f32_16x16x32_bf16 v[84:87], v[36:39], v[168:171], v[84:87]
v_mfma_f32_16x16x32_bf16 v[88:91], v[40:43], v[168:171], v[88:91]
v_mfma_f32_16x16x32_bf16 v[92:95], v[44:47], v[168:171], v[92:95]
buffer_load_dwordx4 v[168:171], v68, s[48:51], s98 offen sc1
s_waitcnt vmcnt(27)
s_waitcnt lgkmcnt(0)
ds_read_b64_tr_b16 v[32:33], v75 offset:4096
ds_read_b64_tr_b16 v[34:35], v75 offset:5120
ds_read_b64_tr_b16 v[36:37], v76 offset:4096
ds_read_b64_tr_b16 v[38:39], v76 offset:5120
ds_read_b64_tr_b16 v[40:41], v77 offset:4096
ds_read_b64_tr_b16 v[42:43], v77 offset:5120
ds_read_b64_tr_b16 v[44:45], v78 offset:4096
ds_read_b64_tr_b16 v[46:47], v78 offset:5120
buffer_load_dword v31, v30, s[84:87], 0 offen offset:2048 sc1
v_mfma_f32_16x16x32_bf16 v[192:195], v[48:51], v[172:175], v[192:195]
s_add_u32 m0, s97, 0
s_add_u32 s99, s96, 0xffe35000
buffer_load_dwordx4 v69, s[44:47], s99 offen offset:0 lds
v_mfma_f32_16x16x32_bf16 v[196:199], v[52:55], v[172:175], v[196:199]
v_mfma_f32_16x16x32_bf16 v[200:203], v[56:59], v[172:175], v[200:203]
v_mfma_f32_16x16x32_bf16 v[204:207], v[60:63], v[172:175], v[204:207]
s_add_u32 s98, s95, 0xffff3000
buffer_load_dwordx4 v[172:175], v64, s[48:51], s98 offen sc1
v_mfma_f32_16x16x32_bf16 v[208:211], v[48:51], v[176:179], v[208:211]
buffer_load_dwordx4 v70, s[44:47], s99 offen offset:1024 lds
v_mfma_f32_16x16x32_bf16 v[212:215], v[52:55], v[176:179], v[212:215]
v_mfma_f32_16x16x32_bf16 v[216:219], v[56:59], v[176:179], v[216:219]
v_mfma_f32_16x16x32_bf16 v[220:223], v[60:63], v[176:179], v[220:223]
buffer_load_dwordx4 v[176:179], v65, s[48:51], s98 offen sc1
v_mfma_f32_16x16x32_bf16 v[224:227], v[48:51], v[180:183], v[224:227]
buffer_load_dwordx4 v71, s[44:47], s99 offen offset:2048 lds
v_mfma_f32_16x16x32_bf16 v[228:231], v[52:55], v[180:183], v[228:231]
v_mfma_f32_16x16x32_bf16 v[232:235], v[56:59], v[180:183], v[232:235]
v_mfma_f32_16x16x32_bf16 v[236:239], v[60:63], v[180:183], v[236:239]
buffer_load_dwordx4 v[180:183], v66, s[48:51], s98 offen sc1
v_mfma_f32_16x16x32_bf16 v[240:243], v[48:51], v[184:187], v[240:243]
buffer_load_dwordx4 v72, s[44:47], s99 offen offset:3072 lds
v_mfma_f32_16x16x32_bf16 v[244:247], v[52:55], v[184:187], v[244:247]
v_mfma_f32_16x16x32_bf16 v[248:251], v[56:59], v[184:187], v[248:251]
v_mfma_f32_16x16x32_bf16 v[252:255], v[60:63], v[184:187], v[252:255]
buffer_load_dwordx4 v[184:187], v67, s[48:51], s98 offen sc1
v_mfma_f32_16x16x32_bf16 v[80:83], v[48:51], v[188:191], v[80:83]
v_mfma_f32_16x16x32_bf16 v[84:87], v[52:55], v[188:191], v[84:87]
v_mfma_f32_16x16x32_bf16 v[88:91], v[56:59], v[188:191], v[88:91]
v_mfma_f32_16x16x32_bf16 v[92:95], v[60:63], v[188:191], v[92:95]
buffer_load_dwordx4 v[188:191], v68, s[48:51], s98 offen sc1
s_waitcnt vmcnt(28)
s_waitcnt lgkmcnt(0)
ds_read_b64_tr_b16 v[48:49], v75 offset:8192
ds_read_b64_tr_b16 v[50:51], v75 offset:9216
ds_read_b64_tr_b16 v[52:53], v76 offset:8192
ds_read_b64_tr_b16 v[54:55], v76 offset:9216
ds_read_b64_tr_b16 v[56:57], v77 offset:8192
ds_read_b64_tr_b16 v[58:59], v77 offset:9216
ds_read_b64_tr_b16 v[60:61], v78 offset:8192
ds_read_b64_tr_b16 v[62:63], v78 offset:9216
v_mfma_f32_16x16x32_bf16 v[192:195], v[32:35], v[112:115], v[192:195]
s_add_u32 m0, s97, 4096
s_add_u32 s99, s96, 0xffe86000
buffer_load_dwordx4 v69, s[44:47], s99 offen offset:0 lds
v_mfma_f32_16x16x32_bf16 v[196:199], v[36:39], v[112:115], v[196:199]
v_mfma_f32_16x16x32_bf16 v[200:203], v[40:43], v[112:115], v[200:203]
v_mfma_f32_16x16x32_bf16 v[204:207], v[44:47], v[112:115], v[204:207]
s_add_u32 s98, s95, 0xffff3400
buffer_load_dwordx4 v[112:115], v64, s[48:51], s98 offen sc1
v_mfma_f32_16x16x32_bf16 v[208:211], v[32:35], v[116:119], v[208:211]
buffer_load_dwordx4 v70, s[44:47], s99 offen offset:1024 lds
v_mfma_f32_16x16x32_bf16 v[212:215], v[36:39], v[116:119], v[212:215]
v_mfma_f32_16x16x32_bf16 v[216:219], v[40:43], v[116:119], v[216:219]
v_mfma_f32_16x16x32_bf16 v[220:223], v[44:47], v[116:119], v[220:223]
buffer_load_dwordx4 v[116:119], v65, s[48:51], s98 offen sc1
v_mfma_f32_16x16x32_bf16 v[224:227], v[32:35], v[120:123], v[224:227]
buffer_load_dwordx4 v71, s[44:47], s99 offen offset:2048 lds
v_mfma_f32_16x16x32_bf16 v[228:231], v[36:39], v[120:123], v[228:231]
v_mfma_f32_16x16x32_bf16 v[232:235], v[40:43], v[120:123], v[232:235]
v_mfma_f32_16x16x32_bf16 v[236:239], v[44:47], v[120:123], v[236:239]
buffer_load_dwordx4 v[120:123], v66, s[48:51], s98 offen sc1
v_mfma_f32_16x16x32_bf16 v[240:243], v[32:35], v[124:127], v[240:243]
buffer_load_dwordx4 v72, s[44:47], s99 offen offset:3072 lds
v_mfma_f32_16x16x32_bf16 v[244:247], v[36:39], v[124:127], v[244:247]
v_mfma_f32_16x16x32_bf16 v[248:251], v[40:43], v[124:127], v[248:251]
v_mfma_f32_16x16x32_bf16 v[252:255], v[44:47], v[124:127], v[252:255]
buffer_load_dwordx4 v[124:127], v67, s[48:51], s98 offen sc1
v_mfma_f32_16x16x32_bf16 v[80:83], v[32:35], v[128:131], v[80:83]
v_mfma_f32_16x16x32_bf16 v[84:87], v[36:39], v[128:131], v[84:87]
v_mfma_f32_16x16x32_bf16 v[88:91], v[40:43], v[128:131], v[88:91]
v_mfma_f32_16x16x32_bf16 v[92:95], v[44:47], v[128:131], v[92:95]
buffer_load_dwordx4 v[128:131], v68, s[48:51], s98 offen sc1
s_waitcnt vmcnt(28)
s_waitcnt lgkmcnt(0)
ds_read_b64_tr_b16 v[32:33], v75 offset:12288
ds_read_b64_tr_b16 v[34:35], v75 offset:13312
ds_read_b64_tr_b16 v[36:37], v76 offset:12288
ds_read_b64_tr_b16 v[38:39], v76 offset:13312
ds_read_b64_tr_b16 v[40:41], v77 offset:12288
ds_read_b64_tr_b16 v[42:43], v77 offset:13312
ds_read_b64_tr_b16 v[44:45], v78 offset:12288
ds_read_b64_tr_b16 v[46:47], v78 offset:13312
v_mfma_f32_16x16x32_bf16 v[192:195], v[48:51], v[132:135], v[192:195]
s_add_u32 m0, s97, 8192
s_add_u32 s99, s96, 0xffe8f000
buffer_load_dwordx4 v69, s[44:47], s99 offen offset:0 lds
v_mfma_f32_16x16x32_bf16 v[196:199], v[52:55], v[132:135], v[196:199]
v_mfma_f32_16x16x32_bf16 v[200:203], v[56:59], v[132:135], v[200:203]
v_mfma_f32_16x16x32_bf16 v[204:207], v[60:63], v[132:135], v[204:207]
s_add_u32 s98, s95, 0xffff5800
buffer_load_dwordx4 v[132:135], v64, s[48:51], s98 offen sc1
v_mfma_f32_16x16x32_bf16 v[208:211], v[48:51], v[136:139], v[208:211]
buffer_load_dwordx4 v70, s[44:47], s99 offen offset:1024 lds
v_mfma_f32_16x16x32_bf16 v[212:215], v[52:55], v[136:139], v[212:215]
v_mfma_f32_16x16x32_bf16 v[216:219], v[56:59], v[136:139], v[216:219]
v_mfma_f32_16x16x32_bf16 v[220:223], v[60:63], v[136:139], v[220:223]
buffer_load_dwordx4 v[136:139], v65, s[48:51], s98 offen sc1
v_mfma_f32_16x16x32_bf16 v[224:227], v[48:51], v[140:143], v[224:227]
buffer_load_dwordx4 v71, s[44:47], s99 offen offset:2048 lds
v_mfma_f32_16x16x32_bf16 v[228:231], v[52:55], v[140:143], v[228:231]
v_mfma_f32_16x16x32_bf16 v[232:235], v[56:59], v[140:143], v[232:235]
v_mfma_f32_16x16x32_bf16 v[236:239], v[60:63], v[140:143], v[236:239]
buffer_load_dwordx4 v[140:143], v66, s[48:51], s98 offen sc1
v_mfma_f32_16x16x32_bf16 v[240:243], v[48:51], v[144:147], v[240:243]
buffer_load_dwordx4 v72, s[44:47], s99 offen offset:3072 lds
v_mfma_f32_16x16x32_bf16 v[244:247], v[52:55], v[144:147], v[244:247]
v_mfma_f32_16x16x32_bf16 v[248:251], v[56:59], v[144:147], v[248:251]
v_mfma_f32_16x16x32_bf16 v[252:255], v[60:63], v[144:147], v[252:255]
buffer_load_dwordx4 v[144:147], v67, s[48:51], s98 offen sc1
v_mfma_f32_16x16x32_bf16 v[80:83], v[48:51], v[148:151], v[80:83]
v_mfma_f32_16x16x32_bf16 v[84:87], v[52:55], v[148:151], v[84:87]
v_mfma_f32_16x16x32_bf16 v[88:91], v[56:59], v[148:151], v[88:91]
v_mfma_f32_16x16x32_bf16 v[92:95], v[60:63], v[148:151], v[92:95]
buffer_load_dwordx4 v[148:151], v68, s[48:51], s98 offen sc1
s_waitcnt vmcnt(28)
s_waitcnt lgkmcnt(0)
ds_read_b64_tr_b16 v[48:49], v75 offset:16384
ds_read_b64_tr_b16 v[50:51], v75 offset:17408
ds_read_b64_tr_b16 v[52:53], v76 offset:16384
ds_read_b64_tr_b16 v[54:55], v76 offset:17408
ds_read_b64_tr_b16 v[56:57], v77 offset:16384
ds_read_b64_tr_b16 v[58:59], v77 offset:17408
ds_read_b64_tr_b16 v[60:61], v78 offset:16384
ds_read_b64_tr_b16 v[62:63], v78 offset:17408
v_mfma_f32_16x16x32_bf16 v[192:195], v[32:35], v[152:155], v[192:195]
s_add_u32 m0, s97, 12288
s_add_u32 s99, s96, 0x24000
buffer_load_dwordx4 v69, s[44:47], s99 offen offset:0 lds
v_mfma_f32_16x16x32_bf16 v[196:199], v[36:39], v[152:155], v[196:199]
v_mfma_f32_16x16x32_bf16 v[200:203], v[40:43], v[152:155], v[200:203]
v_mfma_f32_16x16x32_bf16 v[204:207], v[44:47], v[152:155], v[204:207]
s_add_u32 s98, s95, 0xffff5c00
buffer_load_dwordx4 v[152:155], v64, s[48:51], s98 offen sc1
v_mfma_f32_16x16x32_bf16 v[208:211], v[32:35], v[156:159], v[208:211]
buffer_load_dwordx4 v70, s[44:47], s99 offen offset:1024 lds
v_mfma_f32_16x16x32_bf16 v[212:215], v[36:39], v[156:159], v[212:215]
v_mfma_f32_16x16x32_bf16 v[216:219], v[40:43], v[156:159], v[216:219]
v_mfma_f32_16x16x32_bf16 v[220:223], v[44:47], v[156:159], v[220:223]
buffer_load_dwordx4 v[156:159], v65, s[48:51], s98 offen sc1
v_mfma_f32_16x16x32_bf16 v[224:227], v[32:35], v[160:163], v[224:227]
buffer_load_dwordx4 v71, s[44:47], s99 offen offset:2048 lds
v_mfma_f32_16x16x32_bf16 v[228:231], v[36:39], v[160:163], v[228:231]
v_mfma_f32_16x16x32_bf16 v[232:235], v[40:43], v[160:163], v[232:235]
v_mfma_f32_16x16x32_bf16 v[236:239], v[44:47], v[160:163], v[236:239]
buffer_load_dwordx4 v[160:163], v66, s[48:51], s98 offen sc1
v_mfma_f32_16x16x32_bf16 v[240:243], v[32:35], v[164:167], v[240:243]
buffer_load_dwordx4 v72, s[44:47], s99 offen offset:3072 lds
v_mfma_f32_16x16x32_bf16 v[244:247], v[36:39], v[164:167], v[244:247]
v_mfma_f32_16x16x32_bf16 v[248:251], v[40:43], v[164:167], v[248:251]
v_mfma_f32_16x16x32_bf16 v[252:255], v[44:47], v[164:167], v[252:255]
buffer_load_dwordx4 v[164:167], v67, s[48:51], s98 offen sc1
v_mfma_f32_16x16x32_bf16 v[80:83], v[32:35], v[168:171], v[80:83]
v_mfma_f32_16x16x32_bf16 v[84:87], v[36:39], v[168:171], v[84:87]
v_mfma_f32_16x16x32_bf16 v[88:91], v[40:43], v[168:171], v[88:91]
v_mfma_f32_16x16x32_bf16 v[92:95], v[44:47], v[168:171], v[92:95]
buffer_load_dwordx4 v[168:171], v68, s[48:51], s98 offen sc1
s_waitcnt vmcnt(27)
v_cmp_ne_u32 vcc, s100, v31
s_nop 1
s_cbranch_vccz Lok22
s_mov_b32 s83, 20000
Llp23:
buffer_load_dword v31, v30, s[84:87], 0 offen offset:2048 sc1
s_sub_u32 s83, s83, 1
s_cbranch_scc1 Lok22
s_waitcnt vmcnt(0)
v_cmp_ne_u32 vcc, s100, v31
s_nop 1
s_cbranch_vccnz Llp23
Lok22:
s_waitcnt lgkmcnt(0)
ds_read_b64_tr_b16 v[32:33], v75 offset:0
ds_read_b64_tr_b16 v[34:35], v75 offset:1024
ds_read_b64_tr_b16 v[36:37], v76 offset:0
ds_read_b64_tr_b16 v[38:39], v76 offset:1024
ds_read_b64_tr_b16 v[40:41], v77 offset:0
ds_read_b64_tr_b16 v[42:43], v77 offset:1024
ds_read_b64_tr_b16 v[44:45], v78 offset:0
ds_read_b64_tr_b16 v[46:47], v78 offset:1024
v_mfma_f32_16x16x32_bf16 v[192:195], v[48:51], v[172:175], v[192:195]
s_add_u32 m0, s97, 16384
s_add_u32 s99, s96, 0x2d000
buffer_load_dwordx4 v69, s[44:47], s99 offen offset:0 lds
v_mfma_f32_16x16x32_bf16 v[196:199], v[52:55], v[172:175], v[196:199]
v_mfma_f32_16x16x32_bf16 v[200:203], v[56:59], v[172:175], v[200:203]
v_mfma_f32_16x16x32_bf16 v[204:207], v[60:63], v[172:175], v[204:207]
s_add_u32 s98, s95, 0x1000
buffer_load_dwordx4 v[172:175], v64, s[48:51], s98 offen sc1
v_mfma_f32_16x16x32_bf16 v[208:211], v[48:51], v[176:179], v[208:211]
buffer_load_dwordx4 v70, s[44:47], s99 offen offset:1024 lds
v_mfma_f32_16x16x32_bf16 v[212:215], v[52:55], v[176:179], v[212:215]
v_mfma_f32_16x16x32_bf16 v[216:219], v[56:59], v[176:179], v[216:219]
v_mfma_f32_16x16x32_bf16 v[220:223], v[60:63], v[176:179], v[220:223]
buffer_load_dwordx4 v[176:179], v65, s[48:51], s98 offen sc1
v_mfma_f32_16x16x32_bf16 v[224:227], v[48:51], v[180:183], v[224:227]
buffer_load_dwordx4 v71, s[44:47], s99 offen offset:2048 lds
v_mfma_f32_16x16x32_bf16 v[228:231], v[52:55], v[180:183], v[228:231]
v_mfma_f32_16x16x32_bf16 v[232:235], v[56:59], v[180:183], v[232:235]
v_mfma_f32_16x16x32_bf16 v[236:239], v[60:63], v[180:183], v[236:239]
buffer_load_dwordx4 v[180:183], v66, s[48:51], s98 offen sc1
v_mfma_f32_16x16x32_bf16 v[240:243], v[48:51], v[184:187], v[240:243]
buffer_load_dwordx4 v72, s[44:47], s99 offen offset:3072 lds
v_mfma_f32_16x16x32_bf16 v[244:247], v[52:55], v[184:187], v[244:247]
v_mfma_f32_16x16x32_bf16 v[248:251], v[56:59], v[184:187], v[248:251]
v_mfma_f32_16x16x32_bf16 v[252:255], v[60:63], v[184:187], v[252:255]
buffer_load_dwordx4 v[184:187], v67, s[48:51], s98 offen sc1
v_mfma_f32_16x16x32_bf16 v[80:83], v[48:51], v[188:191], v[80:83]
v_mfma_f32_16x16x32_bf16 v[84:87], v[52:55], v[188:191], v[84:87]
v_mfma_f32_16x16x32_bf16 v[88:91], v[56:59], v[188:191], v[88:91]
v_mfma_f32_16x16x32_bf16 v[92:95], v[60:63], v[188:191], v[92:95]
buffer_load_dwordx4 v[188:191], v68, s[48:51], s98 offen sc1
s_waitcnt vmcnt(27)
s_waitcnt lgkmcnt(0)
ds_read_b64_tr_b16 v[48:49], v75 offset:4096
ds_read_b64_tr_b16 v[50:51], v75 offset:5120
ds_read_b64_tr_b16 v[52:53], v76 offset:4096
ds_read_b64_tr_b16 v[54:55], v76 offset:5120
ds_read_b64_tr_b16 v[56:57], v77 offset:4096
ds_read_b64_tr_b16 v[58:59], v77 offset:5120
ds_read_b64_tr_b16 v[60:61], v78 offset:4096
ds_read_b64_tr_b16 v[62:63], v78 offset:5120
v_mfma_f32_16x16x32_bf16 v[192:195], v[32:35], v[112:115], v[192:195]
s_add_u32 m0, s97, 0
s_add_u32 s99, s96, 0x7e000
buffer_load_dwordx4 v69, s[44:47], s99 offen offset:0 lds
v_mfma_f32_16x16x32_bf16 v[196:199], v[36:39], v[112:115], v[196:199]
v_mfma_f32_16x16x32_bf16 v[200:203], v[40:43], v[112:115], v[200:203]
v_mfma_f32_16x16x32_bf16 v[204:207], v[44:47], v[112:115], v[204:207]
s_add_u32 s98, s95, 0x1400
buffer_load_dwordx4 v[112:115], v64, s[48:51], s98 offen sc1
v_mfma_f32_16x16x32_bf16 v[208:211], v[32:35], v[116:119], v[208:211]
buffer_load_dwordx4 v70, s[44:47], s99 offen offset:1024 lds
v_mfma_f32_16x16x32_bf16 v[212:215], v[36:39], v[116:119], v[212:215]
v_mfma_f32_16x16x32_bf16 v[216:219], v[40:43], v[116:119], v[216:219]
v_mfma_f32_16x16x32_bf16 v[220:223], v[44:47], v[116:119], v[220:223]
buffer_load_dwordx4 v[116:119], v65, s[48:51], s98 offen sc1
v_mfma_f32_16x16x32_bf16 v[224:227], v[32:35], v[120:123], v[224:227]
buffer_load_dwordx4 v71, s[44:47], s99 offen offset:2048 lds
v_mfma_f32_16x16x32_bf16 v[228:231], v[36:39], v[120:123], v[228:231]
v_mfma_f32_16x16x32_bf16 v[232:235], v[40:43], v[120:123], v[232:235]
v_mfma_f32_16x16x32_bf16 v[236:239], v[44:47], v[120:123], v[236:239]
buffer_load_dwordx4 v[120:123], v66, s[48:51], s98 offen sc1
v_mfma_f32_16x16x32_bf16 v[240:243], v[32:35], v[124:127], v[240:243]
buffer_load_dwordx4 v72, s[44:47], s99 offen offset:3072 lds
v_mfma_f32_16x16x32_bf16 v[244:247], v[36:39], v[124:127], v[244:247]
v_mfma_f32_16x16x32_bf16 v[248:251], v[40:43], v[124:127], v[248:251]
v_mfma_f32_16x16x32_bf16 v[252:255], v[44:47], v[124:127], v[252:255]
buffer_load_dwordx4 v[124:127], v67, s[48:51], s98 offen sc1
v_mfma_f32_16x16x32_bf16 v[80:83], v[32:35], v[128:131], v[80:83]
v_mfma_f32_16x16x32_bf16 v[84:87], v[36:39], v[128:131], v[84:87]
v_mfma_f32_16x16x32_bf16 v[88:91], v[40:43], v[128:131], v[88:91]
v_mfma_f32_16x16x32_bf16 v[92:95], v[44:47], v[128:131], v[92:95]
buffer_load_dwordx4 v[128:131], v68, s[48:51], s98 offen sc1
s_waitcnt vmcnt(27)
s_waitcnt lgkmcnt(0)
ds_read_b64_tr_b16 v[32:33], v75 offset:8192
ds_read_b64_tr_b16 v[34:35], v75 offset:9216
ds_read_b64_tr_b16 v[36:37], v76 offset:8192
ds_read_b64_tr_b16 v[38:39], v76 offset:9216
ds_read_b64_tr_b16 v[40:41], v77 offset:8192
ds_read_b64_tr_b16 v[42:43], v77 offset:9216
ds_read_b64_tr_b16 v[44:45], v78 offset:8192
ds_read_b64_tr_b16 v[46:47], v78 offset:9216
v_mfma_f32_16x16x32_bf16 v[192:195], v[48:51], v[132:135], v[192:195]
s_add_u32 m0, s97, 4096
s_add_u32 s99, s96, 0x87000
buffer_load_dwordx4 v69, s[44:47], s99 offen offset:0 lds
v_mfma_f32_16x16x32_bf16 v[196:199], v[52:55], v[132:135], v[196:199]
v_mfma_f32_16x16x32_bf16 v[200:203], v[56:59], v[132:135], v[200:203]
v_mfma_f32_16x16x32_bf16 v[204:207], v[60:63], v[132:135], v[204:207]
s_add_u32 s98, s95, 0x3800
buffer_load_dwordx4 v[132:135], v64, s[48:51], s98 offen sc1
v_mfma_f32_16x16x32_bf16 v[208:211], v[48:51], v[136:139], v[208:211]
buffer_load_dwordx4 v70, s[44:47], s99 offen offset:1024 lds
v_mfma_f32_16x16x32_bf16 v[212:215], v[52:55], v[136:139], v[212:215]
v_mfma_f32_16x16x32_bf16 v[216:219], v[56:59], v[136:139], v[216:219]
v_mfma_f32_16x16x32_bf16 v[220:223], v[60:63], v[136:139], v[220:223]
buffer_load_dwordx4 v[136:139], v65, s[48:51], s98 offen sc1
v_mfma_f32_16x16x32_bf16 v[224:227], v[48:51], v[140:143], v[224:227]
buffer_load_dwordx4 v71, s[44:47], s99 offen offset:2048 lds
v_mfma_f32_16x16x32_bf16 v[228:231], v[52:55], v[140:143], v[228:231]
v_mfma_f32_16x16x32_bf16 v[232:235], v[56:59], v[140:143], v[232:235]
v_mfma_f32_16x16x32_bf16 v[236:239], v[60:63], v[140:143], v[236:239]
buffer_load_dwordx4 v[140:143], v66, s[48:51], s98 offen sc1
v_mfma_f32_16x16x32_bf16 v[240:243], v[48:51], v[144:147], v[240:243]
buffer_load_dwordx4 v72, s[44:47], s99 offen offset:3072 lds
v_mfma_f32_16x16x32_bf16 v[244:247], v[52:55], v[144:147], v[244:247]
v_mfma_f32_16x16x32_bf16 v[248:251], v[56:59], v[144:147], v[248:251]
v_mfma_f32_16x16x32_bf16 v[252:255], v[60:63], v[144:147], v[252:255]
buffer_load_dwordx4 v[144:147], v67, s[48:51], s98 offen sc1
v_mfma_f32_16x16x32_bf16 v[80:83], v[48:51], v[148:151], v[80:83]
v_mfma_f32_16x16x32_bf16 v[84:87], v[52:55], v[148:151], v[84:87]
v_mfma_f32_16x16x32_bf16 v[88:91], v[56:59], v[148:151], v[88:91]
v_mfma_f32_16x16x32_bf16 v[92:95], v[60:63], v[148:151], v[92:95]
buffer_load_dwordx4 v[148:151], v68, s[48:51], s98 offen sc1
s_waitcnt vmcnt(27)
s_waitcnt lgkmcnt(0)
ds_read_b64_tr_b16 v[48:49], v75 offset:12288
ds_read_b64_tr_b16 v[50:51], v75 offset:13312
ds_read_b64_tr_b16 v[52:53], v76 offset:12288
ds_read_b64_tr_b16 v[54:55], v76 offset:13312
ds_read_b64_tr_b16 v[56:57], v77 offset:12288
ds_read_b64_tr_b16 v[58:59], v77 offset:13312
ds_read_b64_tr_b16 v[60:61], v78 offset:12288
ds_read_b64_tr_b16 v[62:63], v78 offset:13312
v_mfma_f32_16x16x32_bf16 v[192:195], v[32:35], v[152:155], v[192:195]
s_add_u32 m0, s97, 8192
s_add_u32 s99, s96, 0xc6000
buffer_load_dwordx4 v69, s[44:47], s99 offen offset:0 lds
v_mfma_f32_16x16x32_bf16 v[196:199], v[36:39], v[152:155], v[196:199]
v_mfma_f32_16x16x32_bf16 v[200:203], v[40:43], v[152:155], v[200:203]
v_mfma_f32_16x16x32_bf16 v[204:207], v[44:47], v[152:155], v[204:207]
s_add_u32 s98, s95, 0x3c00
buffer_load_dwordx4 v[152:155], v64, s[48:51], s98 offen sc1
v_mfma_f32_16x16x32_bf16 v[208:211], v[32:35], v[156:159], v[208:211]
buffer_load_dwordx4 v70, s[44:47], s99 offen offset:1024 lds
v_mfma_f32_16x16x32_bf16 v[212:215], v[36:39], v[156:159], v[212:215]
v_mfma_f32_16x16x32_bf16 v[216:219], v[40:43], v[156:159], v[216:219]
v_mfma_f32_16x16x32_bf16 v[220:223], v[44:47], v[156:159], v[220:223]
buffer_load_dwordx4 v[156:159], v65, s[48:51], s98 offen sc1
v_mfma_f32_16x16x32_bf16 v[224:227], v[32:35], v[160:163], v[224:227]
buffer_load_dwordx4 v71, s[44:47], s99 offen offset:2048 lds
v_mfma_f32_16x16x32_bf16 v[228:231], v[36:39], v[160:163], v[228:231]
v_mfma_f32_16x16x32_bf16 v[232:235], v[40:43], v[160:163], v[232:235]
v_mfma_f32_16x16x32_bf16 v[236:239], v[44:47], v[160:163], v[236:239]
buffer_load_dwordx4 v[160:163], v66, s[48:51], s98 offen sc1
v_mfma_f32_16x16x32_bf16 v[240:243], v[32:35], v[164:167], v[240:243]
buffer_load_dwordx4 v72, s[44:47], s99 offen offset:3072 lds
v_mfma_f32_16x16x32_bf16 v[244:247], v[36:39], v[164:167], v[244:247]
v_mfma_f32_16x16x32_bf16 v[248:251], v[40:43], v[164:167], v[248:251]
v_mfma_f32_16x16x32_bf16 v[252:255], v[44:47], v[164:167], v[252:255]
buffer_load_dwordx4 v[164:167], v67, s[48:51], s98 offen sc1
v_mfma_f32_16x16x32_bf16 v[80:83], v[32:35], v[168:171], v[80:83]
v_mfma_f32_16x16x32_bf16 v[84:87], v[36:39], v[168:171], v[84:87]
v_mfma_f32_16x16x32_bf16 v[88:91], v[40:43], v[168:171], v[88:91]
v_mfma_f32_16x16x32_bf16 v[92:95], v[44:47], v[168:171], v[92:95]
buffer_load_dwordx4 v[168:171], v68, s[48:51], s98 offen sc1
s_waitcnt vmcnt(27)
s_waitcnt lgkmcnt(0)
ds_read_b64_tr_b16 v[32:33], v75 offset:16384
ds_read_b64_tr_b16 v[34:35], v75 offset:17408
ds_read_b64_tr_b16 v[36:37], v76 offset:16384
ds_read_b64_tr_b16 v[38:39], v76 offset:17408
ds_read_b64_tr_b16 v[40:41], v77 offset:16384
ds_read_b64_tr_b16 v[42:43], v77 offset:17408
ds_read_b64_tr_b16 v[44:45], v78 offset:16384
ds_read_b64_tr_b16 v[46:47], v78 offset:17408
buffer_load_dword v31, v28, s[84:87], 0 offen offset:2048 sc1
v_mfma_f32_16x16x32_bf16 v[192:195], v[48:51], v[172:175], v[192:195]
s_add_u32 m0, s97, 12288
s_add_u32 s99, s96, 0xcf000
buffer_load_dwordx4 v69, s[44:47], s99 offen offset:0 lds
v_mfma_f32_16x16x32_bf16 v[196:199], v[52:55], v[172:175], v[196:199]
v_mfma_f32_16x16x32_bf16 v[200:203], v[56:59], v[172:175], v[200:203]
v_mfma_f32_16x16x32_bf16 v[204:207], v[60:63], v[172:175], v[204:207]
s_add_u32 s98, s95, 0x5800
buffer_load_dwordx4 v[172:175], v64, s[48:51], s98 offen sc1
v_mfma_f32_16x16x32_bf16 v[208:211], v[48:51], v[176:179], v[208:211]
buffer_load_dwordx4 v70, s[44:47], s99 offen offset:1024 lds
v_mfma_f32_16x16x32_bf16 v[212:215], v[52:55], v[176:179], v[212:215]
v_mfma_f32_16x16x32_bf16 v[216:219], v[56:59], v[176:179], v[216:219]
v_mfma_f32_16x16x32_bf16 v[220:223], v[60:63], v[176:179], v[220:223]
buffer_load_dwordx4 v[176:179], v65, s[48:51], s98 offen sc1
v_mfma_f32_16x16x32_bf16 v[224:227], v[48:51], v[180:183], v[224:227]
buffer_load_dwordx4 v71, s[44:47], s99 offen offset:2048 lds
v_mfma_f32_16x16x32_bf16 v[228:231], v[52:55], v[180:183], v[228:231]
v_mfma_f32_16x16x32_bf16 v[232:235], v[56:59], v[180:183], v[232:235]
v_mfma_f32_16x16x32_bf16 v[236:239], v[60:63], v[180:183], v[236:239]
buffer_load_dwordx4 v[180:183], v66, s[48:51], s98 offen sc1
v_mfma_f32_16x16x32_bf16 v[240:243], v[48:51], v[184:187], v[240:243]
buffer_load_dwordx4 v72, s[44:47], s99 offen offset:3072 lds
v_mfma_f32_16x16x32_bf16 v[244:247], v[52:55], v[184:187], v[244:247]
v_mfma_f32_16x16x32_bf16 v[248:251], v[56:59], v[184:187], v[248:251]
v_mfma_f32_16x16x32_bf16 v[252:255], v[60:63], v[184:187], v[252:255]
buffer_load_dwordx4 v[184:187], v67, s[48:51], s98 offen sc1
v_mfma_f32_16x16x32_bf16 v[80:83], v[48:51], v[188:191], v[80:83]
v_mfma_f32_16x16x32_bf16 v[84:87], v[52:55], v[188:191], v[84:87]
v_mfma_f32_16x16x32_bf16 v[88:91], v[56:59], v[188:191], v[88:91]
v_mfma_f32_16x16x32_bf16 v[92:95], v[60:63], v[188:191], v[92:95]
buffer_load_dwordx4 v[188:191], v68, s[48:51], s98 offen sc1
s_waitcnt vmcnt(28)
s_waitcnt lgkmcnt(0)
ds_read_b64_tr_b16 v[48:49], v75 offset:0
ds_read_b64_tr_b16 v[50:51], v75 offset:1024
ds_read_b64_tr_b16 v[52:53], v76 offset:0
ds_read_b64_tr_b16 v[54:55], v76 offset:1024
ds_read_b64_tr_b16 v[56:57], v77 offset:0
ds_read_b64_tr_b16 v[58:59], v77 offset:1024
ds_read_b64_tr_b16 v[60:61], v78 offset:0
ds_read_b64_tr_b16 v[62:63], v78 offset:1024
v_mfma_f32_16x16x32_bf16 v[192:195], v[32:35], v[112:115], v[192:195]
s_add_u32 m0, s97, 16384
s_add_u32 s99, s96, 0x120000
buffer_load_dwordx4 v69, s[44:47], s99 offen offset:0 lds
v_mfma_f32_16x16x32_bf16 v[196:199], v[36:39], v[112:115], v[196:199]
v_mfma_f32_16x16x32_bf16 v[200:203], v[40:43], v[112:115], v[200:203]
v_mfma_f32_16x16x32_bf16 v[204:207], v[44:47], v[112:115], v[204:207]
s_add_u32 s98, s95, 0x5c00
buffer_load_dwordx4 v[112:115], v64, s[48:51], s98 offen sc1
v_mfma_f32_16x16x32_bf16 v[208:211], v[32:35], v[116:119], v[208:211]
buffer_load_dwordx4 v70, s[44:47], s99 offen offset:1024 lds
v_mfma_f32_16x16x32_bf16 v[212:215], v[36:39], v[116:119], v[212:215]
v_mfma_f32_16x16x32_bf16 v[216:219], v[40:43], v[116:119], v[216:219]
v_mfma_f32_16x16x32_bf16 v[220:223], v[44:47], v[116:119], v[220:223]
buffer_load_dwordx4 v[116:119], v65, s[48:51], s98 offen sc1
v_mfma_f32_16x16x32_bf16 v[224:227], v[32:35], v[120:123], v[224:227]
buffer_load_dwordx4 v71, s[44:47], s99 offen offset:2048 lds
v_mfma_f32_16x16x32_bf16 v[228:231], v[36:39], v[120:123], v[228:231]
v_mfma_f32_16x16x32_bf16 v[232:235], v[40:43], v[120:123], v[232:235]
v_mfma_f32_16x16x32_bf16 v[236:239], v[44:47], v[120:123], v[236:239]
buffer_load_dwordx4 v[120:123], v66, s[48:51], s98 offen sc1
v_mfma_f32_16x16x32_bf16 v[240:243], v[32:35], v[124:127], v[240:243]
buffer_load_dwordx4 v72, s[44:47], s99 offen offset:3072 lds
v_mfma_f32_16x16x32_bf16 v[244:247], v[36:39], v[124:127], v[244:247]
v_mfma_f32_16x16x32_bf16 v[248:251], v[40:43], v[124:127], v[248:251]
v_mfma_f32_16x16x32_bf16 v[252:255], v[44:47], v[124:127], v[252:255]
buffer_load_dwordx4 v[124:127], v67, s[48:51], s98 offen sc1
v_mfma_f32_16x16x32_bf16 v[80:83], v[32:35], v[128:131], v[80:83]
v_mfma_f32_16x16x32_bf16 v[84:87], v[36:39], v[128:131], v[84:87]
v_mfma_f32_16x16x32_bf16 v[88:91], v[40:43], v[128:131], v[88:91]
v_mfma_f32_16x16x32_bf16 v[92:95], v[44:47], v[128:131], v[92:95]
buffer_load_dwordx4 v[128:131], v68, s[48:51], s98 offen sc1
s_waitcnt vmcnt(28)
s_waitcnt lgkmcnt(0)
ds_read_b64_tr_b16 v[32:33], v75 offset:4096
ds_read_b64_tr_b16 v[34:35], v75 offset:5120
ds_read_b64_tr_b16 v[36:37], v76 offset:4096
ds_read_b64_tr_b16 v[38:39], v76 offset:5120
ds_read_b64_tr_b16 v[40:41], v77 offset:4096
ds_read_b64_tr_b16 v[42:43], v77 offset:5120
ds_read_b64_tr_b16 v[44:45], v78 offset:4096
ds_read_b64_tr_b16 v[46:47], v78 offset:5120
v_mfma_f32_16x16x32_bf16 v[192:195], v[48:51], v[132:135], v[192:195]
s_add_u32 m0, s97, 0
s_add_u32 s99, s96, 0x129000
buffer_load_dwordx4 v69, s[44:47], s99 offen offset:0 lds
v_mfma_f32_16x16x32_bf16 v[196:199], v[52:55], v[132:135], v[196:199]
v_mfma_f32_16x16x32_bf16 v[200:203], v[56:59], v[132:135], v[200:203]
v_mfma_f32_16x16x32_bf16 v[204:207], v[60:63], v[132:135], v[204:207]
s_add_u32 s98, s95, 0x8000
buffer_load_dwordx4 v[132:135], v64, s[48:51], s98 offen sc1
v_mfma_f32_16x16x32_bf16 v[208:211], v[48:51], v[136:139], v[208:211]
buffer_load_dwordx4 v70, s[44:47], s99 offen offset:1024 lds
v_mfma_f32_16x16x32_bf16 v[212:215], v[52:55], v[136:139], v[212:215]
v_mfma_f32_16x16x32_bf16 v[216:219], v[56:59], v[136:139], v[216:219]
v_mfma_f32_16x16x32_bf16 v[220:223], v[60:63], v[136:139], v[220:223]
buffer_load_dwordx4 v[136:139], v65, s[48:51], s98 offen sc1
v_mfma_f32_16x16x32_bf16 v[224:227], v[48:51], v[140:143], v[224:227]
buffer_load_dwordx4 v71, s[44:47], s99 offen offset:2048 lds
v_mfma_f32_16x16x32_bf16 v[228:231], v[52:55], v[140:143], v[228:231]
v_mfma_f32_16x16x32_bf16 v[232:235], v[56:59], v[140:143], v[232:235]
v_mfma_f32_16x16x32_bf16 v[236:239], v[60:63], v[140:143], v[236:239]
buffer_load_dwordx4 v[140:143], v66, s[48:51], s98 offen sc1
v_mfma_f32_16x16x32_bf16 v[240:243], v[48:51], v[144:147], v[240:243]
buffer_load_dwordx4 v72, s[44:47], s99 offen offset:3072 lds
v_mfma_f32_16x16x32_bf16 v[244:247], v[52:55], v[144:147], v[244:247]
v_mfma_f32_16x16x32_bf16 v[248:251], v[56:59], v[144:147], v[248:251]
v_mfma_f32_16x16x32_bf16 v[252:255], v[60:63], v[144:147], v[252:255]
buffer_load_dwordx4 v[144:147], v67, s[48:51], s98 offen sc1
v_mfma_f32_16x16x32_bf16 v[80:83], v[48:51], v[148:151], v[80:83]
v_mfma_f32_16x16x32_bf16 v[84:87], v[52:55], v[148:151], v[84:87]
v_mfma_f32_16x16x32_bf16 v[88:91], v[56:59], v[148:151], v[88:91]
v_mfma_f32_16x16x32_bf16 v[92:95], v[60:63], v[148:151], v[92:95]
buffer_load_dwordx4 v[148:151], v68, s[48:51], s98 offen sc1
s_waitcnt vmcnt(28)
s_waitcnt lgkmcnt(0)
ds_read_b64_tr_b16 v[48:49], v75 offset:8192
ds_read_b64_tr_b16 v[50:51], v75 offset:9216
ds_read_b64_tr_b16 v[52:53], v76 offset:8192
ds_read_b64_tr_b16 v[54:55], v76 offset:9216
ds_read_b64_tr_b16 v[56:57], v77 offset:8192
ds_read_b64_tr_b16 v[58:59], v77 offset:9216
ds_read_b64_tr_b16 v[60:61], v78 offset:8192
ds_read_b64_tr_b16 v[62:63], v78 offset:9216
v_mfma_f32_16x16x32_bf16 v[192:195], v[32:35], v[152:155], v[192:195]
s_add_u32 m0, s97, 4096
s_add_u32 s99, s96, 0x36000
buffer_load_dwordx4 v69, s[44:47], s99 offen offset:0 lds
v_mfma_f32_16x16x32_bf16 v[196:199], v[36:39], v[152:155], v[196:199]
v_mfma_f32_16x16x32_bf16 v[200:203], v[40:43], v[152:155], v[200:203]
v_mfma_f32_16x16x32_bf16 v[204:207], v[44:47], v[152:155], v[204:207]
s_add_u32 s98, s95, 0x8400
buffer_load_dwordx4 v[152:155], v64, s[48:51], s98 offen sc1
v_mfma_f32_16x16x32_bf16 v[208:211], v[32:35], v[156:159], v[208:211]
buffer_load_dwordx4 v70, s[44:47], s99 offen offset:1024 lds
v_mfma_f32_16x16x32_bf16 v[212:215], v[36:39], v[156:159], v[212:215]
v_mfma_f32_16x16x32_bf16 v[216:219], v[40:43], v[156:159], v[216:219]
v_mfma_f32_16x16x32_bf16 v[220:223], v[44:47], v[156:159], v[220:223]
buffer_load_dwordx4 v[156:159], v65, s[48:51], s98 offen sc1
v_mfma_f32_16x16x32_bf16 v[224:227], v[32:35], v[160:163], v[224:227]
buffer_load_dwordx4 v71, s[44:47], s99 offen offset:2048 lds
v_mfma_f32_16x16x32_bf16 v[228:231], v[36:39], v[160:163], v[228:231]
v_mfma_f32_16x16x32_bf16 v[232:235], v[40:43], v[160:163], v[232:235]
v_mfma_f32_16x16x32_bf16 v[236:239], v[44:47], v[160:163], v[236:239]
buffer_load_dwordx4 v[160:163], v66, s[48:51], s98 offen sc1
v_mfma_f32_16x16x32_bf16 v[240:243], v[32:35], v[164:167], v[240:243]
buffer_load_dwordx4 v72, s[44:47], s99 offen offset:3072 lds
v_mfma_f32_16x16x32_bf16 v[244:247], v[36:39], v[164:167], v[244:247]
v_mfma_f32_16x16x32_bf16 v[248:251], v[40:43], v[164:167], v[248:251]
v_mfma_f32_16x16x32_bf16 v[252:255], v[44:47], v[164:167], v[252:255]
buffer_load_dwordx4 v[164:167], v67, s[48:51], s98 offen sc1
v_mfma_f32_16x16x32_bf16 v[80:83], v[32:35], v[168:171], v[80:83]
v_mfma_f32_16x16x32_bf16 v[84:87], v[36:39], v[168:171], v[84:87]
v_mfma_f32_16x16x32_bf16 v[88:91], v[40:43], v[168:171], v[88:91]
v_mfma_f32_16x16x32_bf16 v[92:95], v[44:47], v[168:171], v[92:95]
buffer_load_dwordx4 v[168:171], v68, s[48:51], s98 offen sc1
s_waitcnt vmcnt(27)
v_cmp_ne_u32 vcc, s100, v31
s_nop 1
s_cbranch_vccz Lok24
s_mov_b32 s83, 20000
Llp25:
buffer_load_dword v31, v28, s[84:87], 0 offen offset:2048 sc1
s_sub_u32 s83, s83, 1
s_cbranch_scc1 Lok24
s_waitcnt vmcnt(0)
v_cmp_ne_u32 vcc, s100, v31
s_nop 1
s_cbranch_vccnz Llp25
Lok24:
s_waitcnt lgkmcnt(0)
ds_read_b64_tr_b16 v[32:33], v75 offset:12288
ds_read_b64_tr_b16 v[34:35], v75 offset:13312
ds_read_b64_tr_b16 v[36:37], v76 offset:12288
ds_read_b64_tr_b16 v[38:39], v76 offset:13312
ds_read_b64_tr_b16 v[40:41], v77 offset:12288
ds_read_b64_tr_b16 v[42:43], v77 offset:13312
ds_read_b64_tr_b16 v[44:45], v78 offset:12288
ds_read_b64_tr_b16 v[46:47], v78 offset:13312
v_mfma_f32_16x16x32_bf16 v[192:195], v[48:51], v[172:175], v[192:195]
s_add_u32 m0, s97, 8192
s_add_u32 s99, s96, 0x3f000
buffer_load_dwordx4 v69, s[44:47], s99 offen offset:0 lds
v_mfma_f32_16x16x32_bf16 v[196:199], v[52:55], v[172:175], v[196:199]
v_mfma_f32_16x16x32_bf16 v[200:203], v[56:59], v[172:175], v[200:203]
v_mfma_f32_16x16x32_bf16 v[204:207], v[60:63], v[172:175], v[204:207]
s_add_u32 s98, s95, 0x1800
buffer_load_dwordx4 v[172:175], v64, s[48:51], s98 offen sc1
v_mfma_f32_16x16x32_bf16 v[208:211], v[48:51], v[176:179], v[208:211]
buffer_load_dwordx4 v70, s[44:47], s99 offen offset:1024 lds
v_mfma_f32_16x16x32_bf16 v[212:215], v[52:55], v[176:179], v[212:215]
v_mfma_f32_16x16x32_bf16 v[216:219], v[56:59], v[176:179], v[216:219]
v_mfma_f32_16x16x32_bf16 v[220:223], v[60:63], v[176:179], v[220:223]
buffer_load_dwordx4 v[176:179], v65, s[48:51], s98 offen sc1
v_mfma_f32_16x16x32_bf16 v[224:227], v[48:51], v[180:183], v[224:227]
buffer_load_dwordx4 v71, s[44:47], s99 offen offset:2048 lds
v_mfma_f32_16x16x32_bf16 v[228:231], v[52:55], v[180:183], v[228:231]
v_mfma_f32_16x16x32_bf16 v[232:235], v[56:59], v[180:183], v[232:235]
v_mfma_f32_16x16x32_bf16 v[236:239], v[60:63], v[180:183], v[236:239]
buffer_load_dwordx4 v[180:183], v66, s[48:51], s98 offen sc1
v_mfma_f32_16x16x32_bf16 v[240:243], v[48:51], v[184:187], v[240:243]
buffer_load_dwordx4 v72, s[44:47], s99 offen offset:3072 lds
v_mfma_f32_16x16x32_bf16 v[244:247], v[52:55], v[184:187], v[244:247]
v_mfma_f32_16x16x32_bf16 v[248:251], v[56:59], v[184:187], v[248:251]
v_mfma_f32_16x16x32_bf16 v[252:255], v[60:63], v[184:187], v[252:255]
buffer_load_dwordx4 v[184:187], v67, s[48:51], s98 offen sc1
v_mfma_f32_16x16x32_bf16 v[80:83], v[48:51], v[188:191], v[80:83]
v_mfma_f32_16x16x32_bf16 v[84:87], v[52:55], v[188:191], v[84:87]
v_mfma_f32_16x16x32_bf16 v[88:91], v[56:59], v[188:191], v[88:91]
v_mfma_f32_16x16x32_bf16 v[92:95], v[60:63], v[188:191], v[92:95]
buffer_load_dwordx4 v[188:191], v68, s[48:51], s98 offen sc1
s_waitcnt vmcnt(27)
s_waitcnt lgkmcnt(0)
ds_read_b64_tr_b16 v[48:49], v75 offset:16384
ds_read_b64_tr_b16 v[50:51], v75 offset:17408
ds_read_b64_tr_b16 v[52:53], v76 offset:16384
ds_read_b64_tr_b16 v[54:55], v76 offset:17408
ds_read_b64_tr_b16 v[56:57], v77 offset:16384
ds_read_b64_tr_b16 v[58:59], v77 offset:17408
ds_read_b64_tr_b16 v[60:61], v78 offset:16384
ds_read_b64_tr_b16 v[62:63], v78 offset:17408
v_mfma_f32_16x16x32_bf16 v[192:195], v[32:35], v[112:115], v[192:195]
s_add_u32 m0, s97, 12288
s_add_u32 s99, s96, 0x90000
buffer_load_dwordx4 v69, s[44:47], s99 offen offset:0 lds
v_mfma_f32_16x16x32_bf16 v[196:199], v[36:39], v[112:115], v[196:199]
v_mfma_f32_16x16x32_bf16 v[200:203], v[40:43], v[112:115], v[200:203]
v_mfma_f32_16x16x32_bf16 v[204:207], v[44:47], v[112:115], v[204:207]
s_add_u32 s98, s95, 0x1c00
buffer_load_dwordx4 v[112:115], v64, s[48:51], s98 offen sc1
v_mfma_f32_16x16x32_bf16 v[208:211], v[32:35], v[116:119], v[208:211]
buffer_load_dwordx4 v70, s[44:47], s99 offen offset:1024 lds
v_mfma_f32_16x16x32_bf16 v[212:215], v[36:39], v[116:119], v[212:215]
v_mfma_f32_16x16x32_bf16 v[216:219], v[40:43], v[116:119], v[216:219]
v_mfma_f32_16x16x32_bf16 v[220:223], v[44:47], v[116:119], v[220:223]
buffer_load_dwordx4 v[116:119], v65, s[48:51], s98 offen sc1
v_mfma_f32_16x16x32_bf16 v[224:227], v[32:35], v[120:123], v[224:227]
buffer_load_dwordx4 v71, s[44:47], s99 offen offset:2048 lds
v_mfma_f32_16x16x32_bf16 v[228:231], v[36:39], v[120:123], v[228:231]
v_mfma_f32_16x16x32_bf16 v[232:235], v[40:43], v[120:123], v[232:235]
v_mfma_f32_16x16x32_bf16 v[236:239], v[44:47], v[120:123], v[236:239]
buffer_load_dwordx4 v[120:123], v66, s[48:51], s98 offen sc1
v_mfma_f32_16x16x32_bf16 v[240:243], v[32:35], v[124:127], v[240:243]
buffer_load_dwordx4 v72, s[44:47], s99 offen offset:3072 lds
v_mfma_f32_16x16x32_bf16 v[244:247], v[36:39], v[124:127], v[244:247]
v_mfma_f32_16x16x32_bf16 v[248:251], v[40:43], v[124:127], v[248:251]
v_mfma_f32_16x16x32_bf16 v[252:255], v[44:47], v[124:127], v[252:255]
buffer_load_dwordx4 v[124:127], v67, s[48:51], s98 offen sc1
v_mfma_f32_16x16x32_bf16 v[80:83], v[32:35], v[128:131], v[80:83]
v_mfma_f32_16x16x32_bf16 v[84:87], v[36:39], v[128:131], v[84:87]
v_mfma_f32_16x16x32_bf16 v[88:91], v[40:43], v[128:131], v[88:91]
v_mfma_f32_16x16x32_bf16 v[92:95], v[44:47], v[128:131], v[92:95]
buffer_load_dwordx4 v[128:131], v68, s[48:51], s98 offen sc1
s_waitcnt vmcnt(27)
s_waitcnt lgkmcnt(0)
ds_read_b64_tr_b16 v[32:33], v75 offset:0
ds_read_b64_tr_b16 v[34:35], v75 offset:1024
ds_read_b64_tr_b16 v[36:37], v76 offset:0
ds_read_b64_tr_b16 v[38:39], v76 offset:1024
ds_read_b64_tr_b16 v[40:41], v77 offset:0
ds_read_b64_tr_b16 v[42:43], v77 offset:1024
ds_read_b64_tr_b16 v[44:45], v78 offset:0
ds_read_b64_tr_b16 v[46:47], v78 offset:1024
v_mfma_f32_16x16x32_bf16 v[192:195], v[48:51], v[132:135], v[192:195]
s_add_u32 m0, s97, 16384
s_add_u32 s99, s96, 0x99000
buffer_load_dwordx4 v69, s[44:47], s99 offen offset:0 lds
v_mfma_f32_16x16x32_bf16 v[196:199], v[52:55], v[132:135], v[196:199]
v_mfma_f32_16x16x32_bf16 v[200:203], v[56:59], v[132:135], v[200:203]
v_mfma_f32_16x16x32_bf16 v[204:207], v[60:63], v[132:135], v[204:207]
s_add_u32 s98, s95, 0x4000
buffer_load_dwordx4 v[132:135], v64, s[48:51], s98 offen sc1
v_mfma_f32_16x16x32_bf16 v[208:211], v[48:51], v[136:139], v[208:211]
buffer_load_dwordx4 v70, s[44:47], s99 offen offset:1024 lds
v_mfma_f32_16x16x32_bf16 v[212:215], v[52:55], v[136:139], v[212:215]
v_mfma_f32_16x16x32_bf16 v[216:219], v[56:59], v[136:139], v[216:219]
v_mfma_f32_16x16x32_bf16 v[220:223], v[60:63], v[136:139], v[220:223]
buffer_load_dwordx4 v[136:139], v65, s[48:51], s98 offen sc1
v_mfma_f32_16x16x32_bf16 v[224:227], v[48:51], v[140:143], v[224:227]
buffer_load_dwordx4 v71, s[44:47], s99 offen offset:2048 lds
v_mfma_f32_16x16x32_bf16 v[228:231], v[52:55], v[140:143], v[228:231]
v_mfma_f32_16x16x32_bf16 v[232:235], v[56:59], v[140:143], v[232:235]
v_mfma_f32_16x16x32_bf16 v[236:239], v[60:63], v[140:143], v[236:239]
buffer_load_dwordx4 v[140:143], v66, s[48:51], s98 offen sc1
v_mfma_f32_16x16x32_bf16 v[240:243], v[48:51], v[144:147], v[240:243]
buffer_load_dwordx4 v72, s[44:47], s99 offen offset:3072 lds
v_mfma_f32_16x16x32_bf16 v[244:247], v[52:55], v[144:147], v[244:247]
v_mfma_f32_16x16x32_bf16 v[248:251], v[56:59], v[144:147], v[248:251]
v_mfma_f32_16x16x32_bf16 v[252:255], v[60:63], v[144:147], v[252:255]
buffer_load_dwordx4 v[144:147], v67, s[48:51], s98 offen sc1
v_mfma_f32_16x16x32_bf16 v[80:83], v[48:51], v[148:151], v[80:83]
v_mfma_f32_16x16x32_bf16 v[84:87], v[52:55], v[148:151], v[84:87]
v_mfma_f32_16x16x32_bf16 v[88:91], v[56:59], v[148:151], v[88:91]
v_mfma_f32_16x16x32_bf16 v[92:95], v[60:63], v[148:151], v[92:95]
buffer_load_dwordx4 v[148:151], v68, s[48:51], s98 offen sc1
s_waitcnt vmcnt(27)
s_waitcnt lgkmcnt(0)
ds_read_b64_tr_b16 v[48:49], v75 offset:4096
ds_read_b64_tr_b16 v[50:51], v75 offset:5120
ds_read_b64_tr_b16 v[52:53], v76 offset:4096
ds_read_b64_tr_b16 v[54:55], v76 offset:5120
ds_read_b64_tr_b16 v[56:57], v77 offset:4096
ds_read_b64_tr_b16 v[58:59], v77 offset:5120
ds_read_b64_tr_b16 v[60:61], v78 offset:4096
ds_read_b64_tr_b16 v[62:63], v78 offset:5120
v_mfma_f32_16x16x32_bf16 v[192:195], v[32:35], v[152:155], v[192:195]
s_add_u32 m0, s97, 0
s_add_u32 s99, s96, 0xd8000
buffer_load_dwordx4 v69, s[44:47], s99 offen offset:0 lds
v_mfma_f32_16x16x32_bf16 v[196:199], v[36:39], v[152:155], v[196:199]
v_mfma_f32_16x16x32_bf16 v[200:203], v[40:43], v[152:155], v[200:203]
v_mfma_f32_16x16x32_bf16 v[204:207], v[44:47], v[152:155], v[204:207]
s_add_u32 s98, s95, 0x4400
buffer_load_dwordx4 v[152:155], v64, s[48:51], s98 offen sc1
v_mfma_f32_16x16x32_bf16 v[208:211], v[32:35], v[156:159], v[208:211]
buffer_load_dwordx4 v70, s[44:47], s99 offen offset:1024 lds
v_mfma_f32_16x16x32_bf16 v[212:215], v[36:39], v[156:159], v[212:215]
v_mfma_f32_16x16x32_bf16 v[216:219], v[40:43], v[156:159], v[216:219]
v_mfma_f32_16x16x32_bf16 v[220:223], v[44:47], v[156:159], v[220:223]
buffer_load_dwordx4 v[156:159], v65, s[48:51], s98 offen sc1
v_mfma_f32_16x16x32_bf16 v[224:227], v[32:35], v[160:163], v[224:227]
buffer_load_dwordx4 v71, s[44:47], s99 offen offset:2048 lds
v_mfma_f32_16x16x32_bf16 v[228:231], v[36:39], v[160:163], v[228:231]
v_mfma_f32_16x16x32_bf16 v[232:235], v[40:43], v[160:163], v[232:235]
v_mfma_f32_16x16x32_bf16 v[236:239], v[44:47], v[160:163], v[236:239]
buffer_load_dwordx4 v[160:163], v66, s[48:51], s98 offen sc1
v_mfma_f32_16x16x32_bf16 v[240:243], v[32:35], v[164:167], v[240:243]
buffer_load_dwordx4 v72, s[44:47], s99 offen offset:3072 lds
v_mfma_f32_16x16x32_bf16 v[244:247], v[36:39], v[164:167], v[244:247]
v_mfma_f32_16x16x32_bf16 v[248:251], v[40:43], v[164:167], v[248:251]
v_mfma_f32_16x16x32_bf16 v[252:255], v[44:47], v[164:167], v[252:255]
buffer_load_dwordx4 v[164:167], v67, s[48:51], s98 offen sc1
v_mfma_f32_16x16x32_bf16 v[80:83], v[32:35], v[168:171], v[80:83]
v_mfma_f32_16x16x32_bf16 v[84:87], v[36:39], v[168:171], v[84:87]
v_mfma_f32_16x16x32_bf16 v[88:91], v[40:43], v[168:171], v[88:91]
v_mfma_f32_16x16x32_bf16 v[92:95], v[44:47], v[168:171], v[92:95]
buffer_load_dwordx4 v[168:171], v68, s[48:51], s98 offen sc1
s_waitcnt vmcnt(27)
s_waitcnt lgkmcnt(0)
ds_read_b64_tr_b16 v[32:33], v75 offset:8192
ds_read_b64_tr_b16 v[34:35], v75 offset:9216
ds_read_b64_tr_b16 v[36:37], v76 offset:8192
ds_read_b64_tr_b16 v[38:39], v76 offset:9216
ds_read_b64_tr_b16 v[40:41], v77 offset:8192
ds_read_b64_tr_b16 v[42:43], v77 offset:9216
ds_read_b64_tr_b16 v[44:45], v78 offset:8192
ds_read_b64_tr_b16 v[46:47], v78 offset:9216
v_mfma_f32_16x16x32_bf16 v[192:195], v[48:51], v[172:175], v[192:195]
s_add_u32 m0, s97, 4096
s_add_u32 s99, s96, 0xe1000
buffer_load_dwordx4 v69, s[44:47], s99 offen offset:0 lds
v_mfma_f32_16x16x32_bf16 v[196:199], v[52:55], v[172:175], v[196:199]
v_mfma_f32_16x16x32_bf16 v[200:203], v[56:59], v[172:175], v[200:203]
v_mfma_f32_16x16x32_bf16 v[204:207], v[60:63], v[172:175], v[204:207]
s_add_u32 s98, s95, 0x6000
buffer_load_dwordx4 v[172:175], v64, s[48:51], s98 offen sc1
v_mfma_f32_16x16x32_bf16 v[208:211], v[48:51], v[176:179], v[208:211]
buffer_load_dwordx4 v70, s[44:47], s99 offen offset:1024 lds
v_mfma_f32_16x16x32_bf16 v[212:215], v[52:55], v[176:179], v[212:215]
v_mfma_f32_16x16x32_bf16 v[216:219], v[56:59], v[176:179], v[216:219]
v_mfma_f32_16x16x32_bf16 v[220:223], v[60:63], v[176:179], v[220:223]
buffer_load_dwordx4 v[176:179], v65, s[48:51], s98 offen sc1
v_mfma_f32_16x16x32_bf16 v[224:227], v[48:51], v[180:183], v[224:227]
buffer_load_dwordx4 v71, s[44:47], s99 offen offset:2048 lds
v_mfma_f32_16x16x32_bf16 v[228:231], v[52:55], v[180:183], v[228:231]
v_mfma_f32_16x16x32_bf16 v[232:235], v[56:59], v[180:183], v[232:235]
v_mfma_f32_16x16x32_bf16 v[236:239], v[60:63], v[180:183], v[236:239]
buffer_load_dwordx4 v[180:183], v66, s[48:51], s98 offen sc1
v_mfma_f32_16x16x32_bf16 v[240:243], v[48:51], v[184:187], v[240:243]
buffer_load_dwordx4 v72, s[44:47], s99 offen offset:3072 lds
v_mfma_f32_16x16x32_bf16 v[244:247], v[52:55], v[184:187], v[244:247]
v_mfma_f32_16x16x32_bf16 v[248:251], v[56:59], v[184:187], v[248:251]
v_mfma_f32_16x16x32_bf16 v[252:255], v[60:63], v[184:187], v[252:255]
buffer_load_dwordx4 v[184:187], v67, s[48:51], s98 offen sc1
v_mfma_f32_16x16x32_bf16 v[80:83], v[48:51], v[188:191], v[80:83]
v_mfma_f32_16x16x32_bf16 v[84:87], v[52:55], v[188:191], v[84:87]
v_mfma_f32_16x16x32_bf16 v[88:91], v[56:59], v[188:191], v[88:91]
v_mfma_f32_16x16x32_bf16 v[92:95], v[60:63], v[188:191], v[92:95]
buffer_load_dwordx4 v[188:191], v68, s[48:51], s98 offen sc1
s_waitcnt vmcnt(27)
s_waitcnt lgkmcnt(0)
ds_read_b64_tr_b16 v[48:49], v75 offset:12288
ds_read_b64_tr_b16 v[50:51], v75 offset:13312
ds_read_b64_tr_b16 v[52:53], v76 offset:12288
ds_read_b64_tr_b16 v[54:55], v76 offset:13312
ds_read_b64_tr_b16 v[56:57], v77 offset:12288
ds_read_b64_tr_b16 v[58:59], v77 offset:13312
ds_read_b64_tr_b16 v[60:61], v78 offset:12288
ds_read_b64_tr_b16 v[62:63], v78 offset:13312
v_mfma_f32_16x16x32_bf16 v[192:195], v[32:35], v[112:115], v[192:195]
s_add_u32 m0, s97, 8192
s_add_u32 s99, s96, 0x132000
buffer_load_dwordx4 v69, s[44:47], s99 offen offset:0 lds
v_mfma_f32_16x16x32_bf16 v[196:199], v[36:39], v[112:115], v[196:199]
v_mfma_f32_16x16x32_bf16 v[200:203], v[40:43], v[112:115], v[200:203]
v_mfma_f32_16x16x32_bf16 v[204:207], v[44:47], v[112:115], v[204:207]
s_add_u32 s98, s95, 0x6400
buffer_load_dwordx4 v[112:115], v64, s[48:51], s98 offen sc1
v_mfma_f32_16x16x32_bf16 v[208:211], v[32:35], v[116:119], v[208:211]
buffer_load_dwordx4 v70, s[44:47], s99 offen offset:1024 lds
v_mfma_f32_16x16x32_bf16 v[212:215], v[36:39], v[116:119], v[212:215]
v_mfma_f32_16x16x32_bf16 v[216:219], v[40:43], v[116:119], v[216:219]
v_mfma_f32_16x16x32_bf16 v[220:223], v[44:47], v[116:119], v[220:223]
buffer_load_dwordx4 v[116:119], v65, s[48:51], s98 offen sc1
v_mfma_f32_16x16x32_bf16 v[224:227], v[32:35], v[120:123], v[224:227]
buffer_load_dwordx4 v71, s[44:47], s99 offen offset:2048 lds
v_mfma_f32_16x16x32_bf16 v[228:231], v[36:39], v[120:123], v[228:231]
v_mfma_f32_16x16x32_bf16 v[232:235], v[40:43], v[120:123], v[232:235]
v_mfma_f32_16x16x32_bf16 v[236:239], v[44:47], v[120:123], v[236:239]
buffer_load_dwordx4 v[120:123], v66, s[48:51], s98 offen sc1
v_mfma_f32_16x16x32_bf16 v[240:243], v[32:35], v[124:127], v[240:243]
buffer_load_dwordx4 v72, s[44:47], s99 offen offset:3072 lds
v_mfma_f32_16x16x32_bf16 v[244:247], v[36:39], v[124:127], v[244:247]
v_mfma_f32_16x16x32_bf16 v[248:251], v[40:43], v[124:127], v[248:251]
v_mfma_f32_16x16x32_bf16 v[252:255], v[44:47], v[124:127], v[252:255]
buffer_load_dwordx4 v[124:127], v67, s[48:51], s98 offen sc1
v_mfma_f32_16x16x32_bf16 v[80:83], v[32:35], v[128:131], v[80:83]
v_mfma_f32_16x16x32_bf16 v[84:87], v[36:39], v[128:131], v[84:87]
v_mfma_f32_16x16x32_bf16 v[88:91], v[40:43], v[128:131], v[88:91]
v_mfma_f32_16x16x32_bf16 v[92:95], v[44:47], v[128:131], v[92:95]
buffer_load_dwordx4 v[128:131], v68, s[48:51], s98 offen sc1
s_waitcnt vmcnt(27)
s_waitcnt lgkmcnt(0)
ds_read_b64_tr_b16 v[32:33], v75 offset:16384
ds_read_b64_tr_b16 v[34:35], v75 offset:17408
ds_read_b64_tr_b16 v[36:37], v76 offset:16384
ds_read_b64_tr_b16 v[38:39], v76 offset:17408
ds_read_b64_tr_b16 v[40:41], v77 offset:16384
ds_read_b64_tr_b16 v[42:43], v77 offset:17408
ds_read_b64_tr_b16 v[44:45], v78 offset:16384
ds_read_b64_tr_b16 v[46:47], v78 offset:17408
v_mfma_f32_16x16x32_bf16 v[192:195], v[48:51], v[132:135], v[192:195]
s_add_u32 m0, s97, 12288
s_add_u32 s99, s96, 0x13b000
buffer_load_dwordx4 v69, s[44:47], s99 offen offset:0 lds
v_mfma_f32_16x16x32_bf16 v[196:199], v[52:55], v[132:135], v[196:199]
v_mfma_f32_16x16x32_bf16 v[200:203], v[56:59], v[132:135], v[200:203]
v_mfma_f32_16x16x32_bf16 v[204:207], v[60:63], v[132:135], v[204:207]
s_add_u32 s98, s95, 0x8800
buffer_load_dwordx4 v[132:135], v64, s[48:51], s98 offen sc1
v_mfma_f32_16x16x32_bf16 v[208:211], v[48:51], v[136:139], v[208:211]
buffer_load_dwordx4 v70, s[44:47], s99 offen offset:1024 lds
v_mfma_f32_16x16x32_bf16 v[212:215], v[52:55], v[136:139], v[212:215]
v_mfma_f32_16x16x32_bf16 v[216:219], v[56:59], v[136:139], v[216:219]
v_mfma_f32_16x16x32_bf16 v[220:223], v[60:63], v[136:139], v[220:223]
buffer_load_dwordx4 v[136:139], v65, s[48:51], s98 offen sc1
v_mfma_f32_16x16x32_bf16 v[224:227], v[48:51], v[140:143], v[224:227]
buffer_load_dwordx4 v71, s[44:47], s99 offen offset:2048 lds
v_mfma_f32_16x16x32_bf16 v[228:231], v[52:55], v[140:143], v[228:231]
v_mfma_f32_16x16x32_bf16 v[232:235], v[56:59], v[140:143], v[232:235]
v_mfma_f32_16x16x32_bf16 v[236:239], v[60:63], v[140:143], v[236:239]
buffer_load_dwordx4 v[140:143], v66, s[48:51], s98 offen sc1
v_mfma_f32_16x16x32_bf16 v[240:243], v[48:51], v[144:147], v[240:243]
buffer_load_dwordx4 v72, s[44:47], s99 offen offset:3072 lds
v_mfma_f32_16x16x32_bf16 v[244:247], v[52:55], v[144:147], v[244:247]
v_mfma_f32_16x16x32_bf16 v[248:251], v[56:59], v[144:147], v[248:251]
v_mfma_f32_16x16x32_bf16 v[252:255], v[60:63], v[144:147], v[252:255]
buffer_load_dwordx4 v[144:147], v67, s[48:51], s98 offen sc1
v_mfma_f32_16x16x32_bf16 v[80:83], v[48:51], v[148:151], v[80:83]
v_mfma_f32_16x16x32_bf16 v[84:87], v[52:55], v[148:151], v[84:87]
v_mfma_f32_16x16x32_bf16 v[88:91], v[56:59], v[148:151], v[88:91]
v_mfma_f32_16x16x32_bf16 v[92:95], v[60:63], v[148:151], v[92:95]
buffer_load_dwordx4 v[148:151], v68, s[48:51], s98 offen sc1
s_waitcnt vmcnt(27)
s_waitcnt lgkmcnt(0)
ds_read_b64_tr_b16 v[48:49], v75 offset:0
ds_read_b64_tr_b16 v[50:51], v75 offset:1024
ds_read_b64_tr_b16 v[52:53], v76 offset:0
ds_read_b64_tr_b16 v[54:55], v76 offset:1024
ds_read_b64_tr_b16 v[56:57], v77 offset:0
ds_read_b64_tr_b16 v[58:59], v77 offset:1024
ds_read_b64_tr_b16 v[60:61], v78 offset:0
ds_read_b64_tr_b16 v[62:63], v78 offset:1024
v_mfma_f32_16x16x32_bf16 v[192:195], v[32:35], v[152:155], v[192:195]
s_add_u32 m0, s97, 16384
s_add_u32 s99, s96, 0x48000
buffer_load_dwordx4 v69, s[44:47], s99 offen offset:0 lds
v_mfma_f32_16x16x32_bf16 v[196:199], v[36:39], v[152:155], v[196:199]
v_mfma_f32_16x16x32_bf16 v[200:203], v[40:43], v[152:155], v[200:203]
v_mfma_f32_16x16x32_bf16 v[204:207], v[44:47], v[152:155], v[204:207]
s_add_u32 s98, s95, 0x8c00
buffer_load_dwordx4 v[152:155], v64, s[48:51], s98 offen sc1
v_mfma_f32_16x16x32_bf16 v[208:211], v[32:35], v[156:159], v[208:211]
buffer_load_dwordx4 v70, s[44:47], s99 offen offset:1024 lds
v_mfma_f32_16x16x32_bf16 v[212:215], v[36:39], v[156:159], v[212:215]
v_mfma_f32_16x16x32_bf16 v[216:219], v[40:43], v[156:159], v[216:219]
v_mfma_f32_16x16x32_bf16 v[220:223], v[44:47], v[156:159], v[220:223]
buffer_load_dwordx4 v[156:159], v65, s[48:51], s98 offen sc1
v_mfma_f32_16x16x32_bf16 v[224:227], v[32:35], v[160:163], v[224:227]
buffer_load_dwordx4 v71, s[44:47], s99 offen offset:2048 lds
v_mfma_f32_16x16x32_bf16 v[228:231], v[36:39], v[160:163], v[228:231]
v_mfma_f32_16x16x32_bf16 v[232:235], v[40:43], v[160:163], v[232:235]
v_mfma_f32_16x16x32_bf16 v[236:239], v[44:47], v[160:163], v[236:239]
buffer_load_dwordx4 v[160:163], v66, s[48:51], s98 offen sc1
v_mfma_f32_16x16x32_bf16 v[240:243], v[32:35], v[164:167], v[240:243]
buffer_load_dwordx4 v72, s[44:47], s99 offen offset:3072 lds
v_mfma_f32_16x16x32_bf16 v[244:247], v[36:39], v[164:167], v[244:247]
v_mfma_f32_16x16x32_bf16 v[248:251], v[40:43], v[164:167], v[248:251]
v_mfma_f32_16x16x32_bf16 v[252:255], v[44:47], v[164:167], v[252:255]
buffer_load_dwordx4 v[164:167], v67, s[48:51], s98 offen sc1
v_mfma_f32_16x16x32_bf16 v[80:83], v[32:35], v[168:171], v[80:83]
v_mfma_f32_16x16x32_bf16 v[84:87], v[36:39], v[168:171], v[84:87]
v_mfma_f32_16x16x32_bf16 v[88:91], v[40:43], v[168:171], v[88:91]
v_mfma_f32_16x16x32_bf16 v[92:95], v[44:47], v[168:171], v[92:95]
buffer_load_dwordx4 v[168:171], v68, s[48:51], s98 offen sc1
s_waitcnt vmcnt(27)
s_waitcnt lgkmcnt(0)
ds_read_b64_tr_b16 v[32:33], v75 offset:4096
ds_read_b64_tr_b16 v[34:35], v75 offset:5120
ds_read_b64_tr_b16 v[36:37], v76 offset:4096
ds_read_b64_tr_b16 v[38:39], v76 offset:5120
ds_read_b64_tr_b16 v[40:41], v77 offset:4096
ds_read_b64_tr_b16 v[42:43], v77 offset:5120
ds_read_b64_tr_b16 v[44:45], v78 offset:4096
ds_read_b64_tr_b16 v[46:47], v78 offset:5120
v_mfma_f32_16x16x32_bf16 v[192:195], v[48:51], v[172:175], v[192:195]
s_add_u32 m0, s97, 0
s_add_u32 s99, s96, 0x51000
buffer_load_dwordx4 v69, s[44:47], s99 offen offset:0 lds
v_mfma_f32_16x16x32_bf16 v[196:199], v[52:55], v[172:175], v[196:199]
v_mfma_f32_16x16x32_bf16 v[200:203], v[56:59], v[172:175], v[200:203]
v_mfma_f32_16x16x32_bf16 v[204:207], v[60:63], v[172:175], v[204:207]
s_add_u32 s98, s95, 0x2000
buffer_load_dwordx4 v[172:175], v64, s[48:51], s98 offen sc1
v_mfma_f32_16x16x32_bf16 v[208:211], v[48:51], v[176:179], v[208:211]
buffer_load_dwordx4 v70, s[44:47], s99 offen offset:1024 lds
v_mfma_f32_16x16x32_bf16 v[212:215], v[52:55], v[176:179], v[212:215]
v_mfma_f32_16x16x32_bf16 v[216:219], v[56:59], v[176:179], v[216:219]
v_mfma_f32_16x16x32_bf16 v[220:223], v[60:63], v[176:179], v[220:223]
buffer_load_dwordx4 v[176:179], v65, s[48:51], s98 offen sc1
v_mfma_f32_16x16x32_bf16 v[224:227], v[48:51], v[180:183], v[224:227]
buffer_load_dwordx4 v71, s[44:47], s99 offen offset:2048 lds
v_mfma_f32_16x16x32_bf16 v[228:231], v[52:55], v[180:183], v[228:231]
v_mfma_f32_16x16x32_bf16 v[232:235], v[56:59], v[180:183], v[232:235]
v_mfma_f32_16x16x32_bf16 v[236:239], v[60:63], v[180:183], v[236:239]
buffer_load_dwordx4 v[180:183], v66, s[48:51], s98 offen sc1
v_mfma_f32_16x16x32_bf16 v[240:243], v[48:51], v[184:187], v[240:243]
buffer_load_dwordx4 v72, s[44:47], s99 offen offset:3072 lds
v_mfma_f32_16x16x32_bf16 v[244:247], v[52:55], v[184:187], v[244:247]
v_mfma_f32_16x16x32_bf16 v[248:251], v[56:59], v[184:187], v[248:251]
v_mfma_f32_16x16x32_bf16 v[252:255], v[60:63], v[184:187], v[252:255]
buffer_load_dwordx4 v[184:187], v67, s[48:51], s98 offen sc1
v_mfma_f32_16x16x32_bf16 v[80:83], v[48:51], v[188:191], v[80:83]
v_mfma_f32_16x16x32_bf16 v[84:87], v[52:55], v[188:191], v[84:87]
v_mfma_f32_16x16x32_bf16 v[88:91], v[56:59], v[188:191], v[88:91]
v_mfma_f32_16x16x32_bf16 v[92:95], v[60:63], v[188:191], v[92:95]
buffer_load_dwordx4 v[188:191], v68, s[48:51], s98 offen sc1
s_waitcnt vmcnt(27)
s_waitcnt lgkmcnt(0)
ds_read_b64_tr_b16 v[48:49], v75 offset:8192
ds_read_b64_tr_b16 v[50:51], v75 offset:9216
ds_read_b64_tr_b16 v[52:53], v76 offset:8192
ds_read_b64_tr_b16 v[54:55], v76 offset:9216
ds_read_b64_tr_b16 v[56:57], v77 offset:8192
ds_read_b64_tr_b16 v[58:59], v77 offset:9216
ds_read_b64_tr_b16 v[60:61], v78 offset:8192
ds_read_b64_tr_b16 v[62:63], v78 offset:9216
v_mfma_f32_16x16x32_bf16 v[192:195], v[32:35], v[112:115], v[192:195]
s_add_u32 m0, s97, 4096
s_add_u32 s99, s96, 0xea000
buffer_load_dwordx4 v69, s[44:47], s99 offen offset:0 lds
v_mfma_f32_16x16x32_bf16 v[196:199], v[36:39], v[112:115], v[196:199]
v_mfma_f32_16x16x32_bf16 v[200:203], v[40:43], v[112:115], v[200:203]
v_mfma_f32_16x16x32_bf16 v[204:207], v[44:47], v[112:115], v[204:207]
s_add_u32 s98, s95, 0x2400
buffer_load_dwordx4 v[112:115], v64, s[48:51], s98 offen sc1
v_mfma_f32_16x16x32_bf16 v[208:211], v[32:35], v[116:119], v[208:211]
buffer_load_dwordx4 v70, s[44:47], s99 offen offset:1024 lds
v_mfma_f32_16x16x32_bf16 v[212:215], v[36:39], v[116:119], v[212:215]
v_mfma_f32_16x16x32_bf16 v[216:219], v[40:43], v[116:119], v[216:219]
v_mfma_f32_16x16x32_bf16 v[220:223], v[44:47], v[116:119], v[220:223]
buffer_load_dwordx4 v[116:119], v65, s[48:51], s98 offen sc1
v_mfma_f32_16x16x32_bf16 v[224:227], v[32:35], v[120:123], v[224:227]
buffer_load_dwordx4 v71, s[44:47], s99 offen offset:2048 lds
v_mfma_f32_16x16x32_bf16 v[228:231], v[36:39], v[120:123], v[228:231]
v_mfma_f32_16x16x32_bf16 v[232:235], v[40:43], v[120:123], v[232:235]
v_mfma_f32_16x16x32_bf16 v[236:239], v[44:47], v[120:123], v[236:239]
buffer_load_dwordx4 v[120:123], v66, s[48:51], s98 offen sc1
v_mfma_f32_16x16x32_bf16 v[240:243], v[32:35], v[124:127], v[240:243]
buffer_load_dwordx4 v72, s[44:47], s99 offen offset:3072 lds
v_mfma_f32_16x16x32_bf16 v[244:247], v[36:39], v[124:127], v[244:247]
v_mfma_f32_16x16x32_bf16 v[248:251], v[40:43], v[124:127], v[248:251]
v_mfma_f32_16x16x32_bf16 v[252:255], v[44:47], v[124:127], v[252:255]
buffer_load_dwordx4 v[124:127], v67, s[48:51], s98 offen sc1
v_mfma_f32_16x16x32_bf16 v[80:83], v[32:35], v[128:131], v[80:83]
v_mfma_f32_16x16x32_bf16 v[84:87], v[36:39], v[128:131], v[84:87]
v_mfma_f32_16x16x32_bf16 v[88:91], v[40:43], v[128:131], v[88:91]
v_mfma_f32_16x16x32_bf16 v[92:95], v[44:47], v[128:131], v[92:95]
buffer_load_dwordx4 v[128:131], v68, s[48:51], s98 offen sc1
s_waitcnt vmcnt(27)
s_waitcnt lgkmcnt(0)
ds_read_b64_tr_b16 v[32:33], v75 offset:12288
ds_read_b64_tr_b16 v[34:35], v75 offset:13312
ds_read_b64_tr_b16 v[36:37], v76 offset:12288
ds_read_b64_tr_b16 v[38:39], v76 offset:13312
ds_read_b64_tr_b16 v[40:41], v77 offset:12288
ds_read_b64_tr_b16 v[42:43], v77 offset:13312
ds_read_b64_tr_b16 v[44:45], v78 offset:12288
ds_read_b64_tr_b16 v[46:47], v78 offset:13312
v_mfma_f32_16x16x32_bf16 v[192:195], v[48:51], v[132:135], v[192:195]
s_add_u32 m0, s97, 8192
s_add_u32 s99, s96, 0xf3000
buffer_load_dwordx4 v69, s[44:47], s99 offen offset:0 lds
v_mfma_f32_16x16x32_bf16 v[196:199], v[52:55], v[132:135], v[196:199]
v_mfma_f32_16x16x32_bf16 v[200:203], v[56:59], v[132:135], v[200:203]
v_mfma_f32_16x16x32_bf16 v[204:207], v[60:63], v[132:135], v[204:207]
s_add_u32 s98, s95, 0x6800
buffer_load_dwordx4 v[132:135], v64, s[48:51], s98 offen sc1
v_mfma_f32_16x16x32_bf16 v[208:211], v[48:51], v[136:139], v[208:211]
buffer_load_dwordx4 v70, s[44:47], s99 offen offset:1024 lds
v_mfma_f32_16x16x32_bf16 v[212:215], v[52:55], v[136:139], v[212:215]
v_mfma_f32_16x16x32_bf16 v[216:219], v[56:59], v[136:139], v[216:219]
v_mfma_f32_16x16x32_bf16 v[220:223], v[60:63], v[136:139], v[220:223]
buffer_load_dwordx4 v[136:139], v65, s[48:51], s98 offen sc1
v_mfma_f32_16x16x32_bf16 v[224:227], v[48:51], v[140:143], v[224:227]
buffer_load_dwordx4 v71, s[44:47], s99 offen offset:2048 lds
v_mfma_f32_16x16x32_bf16 v[228:231], v[52:55], v[140:143], v[228:231]
v_mfma_f32_16x16x32_bf16 v[232:235], v[56:59], v[140:143], v[232:235]
v_mfma_f32_16x16x32_bf16 v[236:239], v[60:63], v[140:143], v[236:239]
buffer_load_dwordx4 v[140:143], v66, s[48:51], s98 offen sc1
v_mfma_f32_16x16x32_bf16 v[240:243], v[48:51], v[144:147], v[240:243]
buffer_load_dwordx4 v72, s[44:47], s99 offen offset:3072 lds
v_mfma_f32_16x16x32_bf16 v[244:247], v[52:55], v[144:147], v[244:247]
v_mfma_f32_16x16x32_bf16 v[248:251], v[56:59], v[144:147], v[248:251]
v_mfma_f32_16x16x32_bf16 v[252:255], v[60:63], v[144:147], v[252:255]
buffer_load_dwordx4 v[144:147], v67, s[48:51], s98 offen sc1
v_mfma_f32_16x16x32_bf16 v[80:83], v[48:51], v[148:151], v[80:83]
v_mfma_f32_16x16x32_bf16 v[84:87], v[52:55], v[148:151], v[84:87]
v_mfma_f32_16x16x32_bf16 v[88:91], v[56:59], v[148:151], v[88:91]
v_mfma_f32_16x16x32_bf16 v[92:95], v[60:63], v[148:151], v[92:95]
buffer_load_dwordx4 v[148:151], v68, s[48:51], s98 offen sc1
s_waitcnt vmcnt(27)
s_waitcnt lgkmcnt(0)
ds_read_b64_tr_b16 v[48:49], v75 offset:16384
ds_read_b64_tr_b16 v[50:51], v75 offset:17408
ds_read_b64_tr_b16 v[52:53], v76 offset:16384
ds_read_b64_tr_b16 v[54:55], v76 offset:17408
ds_read_b64_tr_b16 v[56:57], v77 offset:16384
ds_read_b64_tr_b16 v[58:59], v77 offset:17408
ds_read_b64_tr_b16 v[60:61], v78 offset:16384
ds_read_b64_tr_b16 v[62:63], v78 offset:17408
buffer_load_dword v31, v13, s[84:87], 0 offen offset:0 sc1
v_mfma_f32_16x16x32_bf16 v[192:195], v[32:35], v[152:155], v[192:195]
v_mfma_f32_16x16x32_bf16 v[196:199], v[36:39], v[152:155], v[196:199]
v_mfma_f32_16x16x32_bf16 v[200:203], v[40:43], v[152:155], v[200:203]
v_mfma_f32_16x16x32_bf16 v[204:207], v[44:47], v[152:155], v[204:207]
s_add_u32 s98, s95, 0x6c00
buffer_load_dwordx4 v[152:155], v64, s[48:51], s98 offen sc1
v_mfma_f32_16x16x32_bf16 v[208:211], v[32:35], v[156:159], v[208:211]
v_mfma_f32_16x16x32_bf16 v[212:215], v[36:39], v[156:159], v[212:215]
v_mfma_f32_16x16x32_bf16 v[216:219], v[40:43], v[156:159], v[216:219]
v_mfma_f32_16x16x32_bf16 v[220:223], v[44:47], v[156:159], v[220:223]
buffer_load_dwordx4 v[156:159], v65, s[48:51], s98 offen sc1
v_mfma_f32_16x16x32_bf16 v[224:227], v[32:35], v[160:163], v[224:227]
v_mfma_f32_16x16x32_bf16 v[228:231], v[36:39], v[160:163], v[228:231]
v_mfma_f32_16x16x32_bf16 v[232:235], v[40:43], v[160:163], v[232:235]
v_mfma_f32_16x16x32_bf16 v[236:239], v[44:47], v[160:163], v[236:239]
buffer_load_dwordx4 v[160:163], v66, s[48:51], s98 offen sc1
v_mfma_f32_16x16x32_bf16 v[240:243], v[32:35], v[164:167], v[240:243]
v_mfma_f32_16x16x32_bf16 v[244:247], v[36:39], v[164:167], v[244:247]
v_mfma_f32_16x16x32_bf16 v[248:251], v[40:43], v[164:167], v[248:251]
v_mfma_f32_16x16x32_bf16 v[252:255], v[44:47], v[164:167], v[252:255]
buffer_load_dwordx4 v[164:167], v67, s[48:51], s98 offen sc1
v_mfma_f32_16x16x32_bf16 v[80:83], v[32:35], v[168:171], v[80:83]
v_mfma_f32_16x16x32_bf16 v[84:87], v[36:39], v[168:171], v[84:87]
v_mfma_f32_16x16x32_bf16 v[88:91], v[40:43], v[168:171], v[88:91]
v_mfma_f32_16x16x32_bf16 v[92:95], v[44:47], v[168:171], v[92:95]
buffer_load_dwordx4 v[168:171], v68, s[48:51], s98 offen sc1
s_waitcnt vmcnt(24)
s_waitcnt lgkmcnt(0)
ds_read_b64_tr_b16 v[32:33], v75 offset:0
ds_read_b64_tr_b16 v[34:35], v75 offset:1024
ds_read_b64_tr_b16 v[36:37], v76 offset:0
ds_read_b64_tr_b16 v[38:39], v76 offset:1024
ds_read_b64_tr_b16 v[40:41], v77 offset:0
ds_read_b64_tr_b16 v[42:43], v77 offset:1024
ds_read_b64_tr_b16 v[44:45], v78 offset:0
ds_read_b64_tr_b16 v[46:47], v78 offset:1024
v_mfma_f32_16x16x32_bf16 v[192:195], v[48:51], v[172:175], v[192:195]
v_mfma_f32_16x16x32_bf16 v[196:199], v[52:55], v[172:175], v[196:199]
v_mfma_f32_16x16x32_bf16 v[200:203], v[56:59], v[172:175], v[200:203]
v_mfma_f32_16x16x32_bf16 v[204:207], v[60:63], v[172:175], v[204:207]
v_mfma_f32_16x16x32_bf16 v[208:211], v[48:51], v[176:179], v[208:211]
v_mfma_f32_16x16x32_bf16 v[212:215], v[52:55], v[176:179], v[212:215]
v_mfma_f32_16x16x32_bf16 v[216:219], v[56:59], v[176:179], v[216:219]
v_mfma_f32_16x16x32_bf16 v[220:223], v[60:63], v[176:179], v[220:223]
v_mfma_f32_16x16x32_bf16 v[224:227], v[48:51], v[180:183], v[224:227]
v_mfma_f32_16x16x32_bf16 v[228:231], v[52:55], v[180:183], v[228:231]
v_mfma_f32_16x16x32_bf16 v[232:235], v[56:59], v[180:183], v[232:235]
v_mfma_f32_16x16x32_bf16 v[236:239], v[60:63], v[180:183], v[236:239]
v_mfma_f32_16x16x32_bf16 v[240:243], v[48:51], v[184:187], v[240:243]
v_mfma_f32_16x16x32_bf16 v[244:247], v[52:55], v[184:187], v[244:247]
v_mfma_f32_16x16x32_bf16 v[248:251], v[56:59], v[184:187], v[248:251]
v_mfma_f32_16x16x32_bf16 v[252:255], v[60:63], v[184:187], v[252:255]
v_mfma_f32_16x16x32_bf16 v[80:83], v[48:51], v[188:191], v[80:83]
v_mfma_f32_16x16x32_bf16 v[84:87], v[52:55], v[188:191], v[84:87]
v_mfma_f32_16x16x32_bf16 v[88:91], v[56:59], v[188:191], v[88:91]
v_mfma_f32_16x16x32_bf16 v[92:95], v[60:63], v[188:191], v[92:95]
s_waitcnt vmcnt(15)
s_waitcnt vmcnt(5)
v_cmp_ne_u32 vcc, s100, v31
s_nop 1
s_cbranch_vccz Lok26
s_mov_b32 s83, 20000
Llp27:
buffer_load_dword v31, v13, s[84:87], 0 offen offset:0 sc1
s_sub_u32 s83, s83, 1
s_cbranch_scc1 Lok26
s_waitcnt vmcnt(0)
v_cmp_ne_u32 vcc, s100, v31
s_nop 1
s_cbranch_vccnz Llp27
Lok26:
buffer_load_dwordx4 v[172:175], v98, s[68:71], 0 offen sc1
buffer_load_dwordx4 v[176:179], v99, s[68:71], 0 offen sc1
buffer_load_dwordx4 v[180:183], v100, s[68:71], 0 offen sc1
buffer_load_dword v105, v101, s[72:75], 0 offen offset:256 sc1
buffer_load_dword v104, v101, s[72:75], 0 offen offset:192 sc1
buffer_load_dword v103, v101, s[72:75], 0 offen offset:128 sc1
buffer_load_dword v102, v101, s[72:75], 0 offen offset:64 sc1
buffer_load_dword v101, v101, s[72:75], 0 offen offset:0 sc1
s_waitcnt lgkmcnt(0)
ds_read_b64_tr_b16 v[48:49], v75 offset:4096
ds_read_b64_tr_b16 v[50:51], v75 offset:5120
ds_read_b64_tr_b16 v[52:53], v76 offset:4096
ds_read_b64_tr_b16 v[54:55], v76 offset:5120
ds_read_b64_tr_b16 v[56:57], v77 offset:4096
ds_read_b64_tr_b16 v[58:59], v77 offset:5120
ds_read_b64_tr_b16 v[60:61], v78 offset:4096
ds_read_b64_tr_b16 v[62:63], v78 offset:5120
v_mfma_f32_16x16x32_bf16 v[192:195], v[32:35], v[112:115], v[192:195]
v_mfma_f32_16x16x32_bf16 v[196:199], v[36:39], v[112:115], v[196:199]
v_mfma_f32_16x16x32_bf16 v[200:203], v[40:43], v[112:115], v[200:203]
v_mfma_f32_16x16x32_bf16 v[204:207], v[44:47], v[112:115], v[204:207]
v_mfma_f32_16x16x32_bf16 v[208:211], v[32:35], v[116:119], v[208:211]
v_mfma_f32_16x16x32_bf16 v[212:215], v[36:39], v[116:119], v[212:215]
v_mfma_f32_16x16x32_bf16 v[216:219], v[40:43], v[116:119], v[216:219]
v_mfma_f32_16x16x32_bf16 v[220:223], v[44:47], v[116:119], v[220:223]
v_mfma_f32_16x16x32_bf16 v[224:227], v[32:35], v[120:123], v[224:227]
v_mfma_f32_16x16x32_bf16 v[228:231], v[36:39], v[120:123], v[228:231]
v_mfma_f32_16x16x32_bf16 v[232:235], v[40:43], v[120:123], v[232:235]
v_mfma_f32_16x16x32_bf16 v[236:239], v[44:47], v[120:123], v[236:239]
v_mfma_f32_16x16x32_bf16 v[240:243], v[32:35], v[124:127], v[240:243]
v_mfma_f32_16x16x32_bf16 v[244:247], v[36:39], v[124:127], v[244:247]
v_mfma_f32_16x16x32_bf16 v[248:251], v[40:43], v[124:127], v[248:251]
v_mfma_f32_16x16x32_bf16 v[252:255], v[44:47], v[124:127], v[252:255]
v_mfma_f32_16x16x32_bf16 v[80:83], v[32:35], v[128:131], v[80:83]
v_mfma_f32_16x16x32_bf16 v[84:87], v[36:39], v[128:131], v[84:87]
v_mfma_f32_16x16x32_bf16 v[88:91], v[40:43], v[128:131], v[88:91]
v_mfma_f32_16x16x32_bf16 v[92:95], v[44:47], v[128:131], v[92:95]
s_waitcnt lgkmcnt(0)
ds_read_b64_tr_b16 v[32:33], v75 offset:8192
ds_read_b64_tr_b16 v[34:35], v75 offset:9216
ds_read_b64_tr_b16 v[36:37], v76 offset:8192
ds_read_b64_tr_b16 v[38:39], v76 offset:9216
ds_read_b64_tr_b16 v[40:41], v77 offset:8192
ds_read_b64_tr_b16 v[42:43], v77 offset:9216
ds_read_b64_tr_b16 v[44:45], v78 offset:8192
ds_read_b64_tr_b16 v[46:47], v78 offset:9216
v_mfma_f32_16x16x32_bf16 v[192:195], v[48:51], v[132:135], v[192:195]
v_mfma_f32_16x16x32_bf16 v[196:199], v[52:55], v[132:135], v[196:199]
v_mfma_f32_16x16x32_bf16 v[200:203], v[56:59], v[132:135], v[200:203]
v_mfma_f32_16x16x32_bf16 v[204:207], v[60:63], v[132:135], v[204:207]
v_mfma_f32_16x16x32_bf16 v[208:211], v[48:51], v[136:139], v[208:211]
v_mfma_f32_16x16x32_bf16 v[212:215], v[52:55], v[136:139], v[212:215]
v_mfma_f32_16x16x32_bf16 v[216:219], v[56:59], v[136:139], v[216:219]
v_mfma_f32_16x16x32_bf16 v[220:223], v[60:63], v[136:139], v[220:223]
v_mfma_f32_16x16x32_bf16 v[224:227], v[48:51], v[140:143], v[224:227]
v_mfma_f32_16x16x32_bf16 v[228:231], v[52:55], v[140:143], v[228:231]
v_mfma_f32_16x16x32_bf16 v[232:235], v[56:59], v[140:143], v[232:235]
v_mfma_f32_16x16x32_bf16 v[236:239], v[60:63], v[140:143], v[236:239]
v_mfma_f32_16x16x32_bf16 v[240:243], v[48:51], v[144:147], v[240:243]
v_mfma_f32_16x16x32_bf16 v[244:247], v[52:55], v[144:147], v[244:247]
v_mfma_f32_16x16x32_bf16 v[248:251], v[56:59], v[144:147], v[248:251]
v_mfma_f32_16x16x32_bf16 v[252:255], v[60:63], v[144:147], v[252:255]
v_mfma_f32_16x16x32_bf16 v[80:83], v[48:51], v[148:151], v[80:83]
v_mfma_f32_16x16x32_bf16 v[84:87], v[52:55], v[148:151], v[84:87]
v_mfma_f32_16x16x32_bf16 v[88:91], v[56:59], v[148:151], v[88:91]
v_mfma_f32_16x16x32_bf16 v[92:95], v[60:63], v[148:151], v[92:95]
s_waitcnt vmcnt(8)
s_waitcnt lgkmcnt(0)
v_mfma_f32_16x16x32_bf16 v[192:195], v[32:35], v[152:155], v[192:195]
v_mfma_f32_16x16x32_bf16 v[196:199], v[36:39], v[152:155], v[196:199]
v_mfma_f32_16x16x32_bf16 v[200:203], v[40:43], v[152:155], v[200:203]
v_mfma_f32_16x16x32_bf16 v[204:207], v[44:47], v[152:155], v[204:207]
v_mfma_f32_16x16x32_bf16 v[208:211], v[32:35], v[156:159], v[208:211]
v_mfma_f32_16x16x32_bf16 v[212:215], v[36:39], v[156:159], v[212:215]
v_mfma_f32_16x16x32_bf16 v[216:219], v[40:43], v[156:159], v[216:219]
v_mfma_f32_16x16x32_bf16 v[220:223], v[44:47], v[156:159], v[220:223]
v_mfma_f32_16x16x32_bf16 v[224:227], v[32:35], v[160:163], v[224:227]
v_mfma_f32_16x16x32_bf16 v[228:231], v[36:39], v[160:163], v[228:231]
v_mfma_f32_16x16x32_bf16 v[232:235], v[40:43], v[160:163], v[232:235]
v_mfma_f32_16x16x32_bf16 v[236:239], v[44:47], v[160:163], v[236:239]
v_mfma_f32_16x16x32_bf16 v[240:243], v[32:35], v[164:167], v[240:243]
v_mfma_f32_16x16x32_bf16 v[244:247], v[36:39], v[164:167], v[244:247]
v_mfma_f32_16x16x32_bf16 v[248:251], v[40:43], v[164:167], v[248:251]
v_mfma_f32_16x16x32_bf16 v[252:255], v[44:47], v[164:167], v[252:255]
v_mfma_f32_16x16x32_bf16 v[80:83], v[32:35], v[168:171], v[80:83]
v_mfma_f32_16x16x32_bf16 v[84:87], v[36:39], v[168:171], v[84:87]
v_mfma_f32_16x16x32_bf16 v[88:91], v[40:43], v[168:171], v[88:91]
v_mfma_f32_16x16x32_bf16 v[92:95], v[44:47], v[168:171], v[92:95]
s_waitcnt vmcnt(0)
ds_write_b128 v79, v[172:175] offset:12288
ds_write_b128 v79, v[176:179] offset:13312
ds_write_b128 v79, v[180:183] offset:14336
s_waitcnt lgkmcnt(0)
ds_read_b64_tr_b16 v[2:3], v97 offset:12288
ds_read_b64_tr_b16 v[4:5], v97 offset:12320
ds_read_b64_tr_b16 v[6:7], v97 offset:12352
ds_read_b64_tr_b16 v[8:9], v97 offset:12384
ds_read_b64_tr_b16 v[10:11], v97 offset:12416
s_waitcnt lgkmcnt(0)
Lbtail:
s_cmp_lg_u32 s94, 0
s_cbranch_scc1 Lw28
ds_write_b128 v79, v[196:199] offset:5120
ds_write_b128 v79, v[212:215] offset:6144
ds_write_b128 v79, v[228:231] offset:7168
ds_write_b128 v79, v[244:247] offset:8192
ds_write_b128 v79, v[84:87] offset:9216
ds_write_b128 v79, v[200:203] offset:10240
ds_write_b128 v79, v[216:219] offset:11264
ds_write_b128 v79, v[232:235] offset:12288
ds_write_b128 v79, v[248:251] offset:13312
ds_write_b128 v79, v[88:91] offset:14336
ds_write_b128 v79, v[204:207] offset:15360
ds_write_b128 v79, v[220:223] offset:16384
ds_write_b128 v79, v[236:239] offset:17408
ds_write_b128 v79, v[252:255] offset:18432
ds_write_b128 v79, v[92:95] offset:19456
Lw28:
s_cmp_lg_u32 s94, 1
s_cbranch_scc1 Lw29
ds_write_b128 v79, v[192:195] offset:0
ds_write_b128 v79, v[208:211] offset:1024
ds_write_b128 v79, v[224:227] offset:2048
ds_write_b128 v79, v[240:243] offset:3072
ds_write_b128 v79, v[80:83] offset:4096
ds_write_b128 v79, v[200:203] offset:10240
ds_write_b128 v79, v[216:219] offset:11264
ds_write_b128 v79, v[232:235] offset:12288
ds_write_b128 v79, v[248:251] offset:13312
ds_write_b128 v79, v[88:91] offset:14336
ds_write_b128 v79, v[204:207] offset:15360
ds_write_b128 v79, v[220:223] offset:16384
ds_write_b128 v79, v[236:239] offset:17408
ds_write_b128 v79, v[252:255] offset:18432
ds_write_b128 v79, v[92:95] offset:19456
v_mov_b32 v192, v196
v_mov_b32 v193, v197
v_mov_b32 v194, v198
v_mov_b32 v195, v199
v_mov_b32 v208, v212
v_mov_b32 v209, v213
v_mov_b32 v210, v214
v_mov_b32 v211, v215
v_mov_b32 v224, v228
v_mov_b32 v225, v229
v_mov_b32 v226, v230
v_mov_b32 v227, v231
v_mov_b32 v240, v244
v_mov_b32 v241, v245
v_mov_b32 v242, v246
v_mov_b32 v243, v247
v_mov_b32 v80, v84
v_mov_b32 v81, v85
v_mov_b32 v82, v86
v_mov_b32 v83, v87
Lw29:
s_cmp_lg_u32 s94, 2
s_cbranch_scc1 Lw30
ds_write_b128 v79, v[192:195] offset:0
ds_write_b128 v79, v[208:211] offset:1024
ds_write_b128 v79, v[224:227] offset:2048
ds_write_b128 v79, v[240:243] offset:3072
ds_write_b128 v79, v[80:83] offset:4096
ds_write_b128 v79, v[196:199] offset:5120
ds_write_b128 v79, v[212:215] offset:6144
ds_write_b128 v79, v[228:231] offset:7168
ds_write_b128 v79, v[244:247] offset:8192
ds_write_b128 v79, v[84:87] offset:9216
ds_write_b128 v79, v[204:207] offset:15360
ds_write_b128 v79, v[220:223] offset:16384
ds_write_b128 v79, v[236:239] offset:17408
ds_write_b128 v79, v[252:255] offset:18432
ds_write_b128 v79, v[92:95] offset:19456
v_mov_b32 v192, v200
v_mov_b32 v193, v201
v_mov_b32 v194, v202
v_mov_b32 v195, v203
v_mov_b32 v208, v216
v_mov_b32 v209, v217
v_mov_b32 v210, v218
v_mov_b32 v211, v219
v_mov_b32 v224, v232
v_mov_b32 v225, v233
v_mov_b32 v226, v234
v_mov_b32 v227, v235
v_mov_b32 v240, v248
v_mov_b32 v241, v249
v_mov_b32 v242, v250
v_mov_b32 v243, v251
v_mov_b32 v80, v88
v_mov_b32 v81, v89
v_mov_b32 v82, v90
v_mov_b32 v83, v91
Lw30:
s_cmp_lg_u32 s94, 3
s_cbranch_scc1 Lw31
ds_write_b128 v79, v[192:195] offset:0
ds_write_b128 v79, v[208:211] offset:1024
ds_write_b128 v79, v[224:227] offset:2048
ds_write_b128 v79, v[240:243] offset:3072
ds_write_b128 v79, v[80:83] offset:4096
ds_write_b128 v79, v[196:199] offset:5120
ds_write_b128 v79, v[212:215] offset:6144
ds_write_b128 v79, v[228:231] offset:7168
ds_write_b128 v79, v[244:247] offset:8192
ds_write_b128 v79, v[84:87] offset:9216
ds_write_b128 v79, v[200:203] offset:10240
ds_write_b128 v79, v[216:219] offset:11264
ds_write_b128 v79, v[232:235] offset:12288
ds_write_b128 v79, v[248:251] offset:13312
ds_write_b128 v79, v[88:91] offset:14336
v_mov_b32 v192, v204
v_mov_b32 v193, v205
v_mov_b32 v194, v206
v_mov_b32 v195, v207
v_mov_b32 v208, v220
v_mov_b32 v209, v221
v_mov_b32 v210, v222
v_mov_b32 v211, v223
v_mov_b32 v224, v236
v_mov_b32 v225, v237
v_mov_b32 v226, v238
v_mov_b32 v227, v239
v_mov_b32 v240, v252
v_mov_b32 v241, v253
v_mov_b32 v242, v254
v_mov_b32 v243, v255
v_mov_b32 v80, v92
v_mov_b32 v81, v93
v_mov_b32 v82, v94
v_mov_b32 v83, v95
Lw31:
s_mul_i32 s60, s94, 5120
s_add_u32 s60, s60, 81920
v_lshl_add_u32 v1, v0, 4, s60
s_waitcnt lgkmcnt(0)
s_barrier
s_add_u32 s60, s94, 1
s_and_b32 s60, s60, 3
s_mul_i32 s60, s60, 20480
v_add_u32 v12, s60, v1
ds_read_b128 v[112:115], v12 offset:0
ds_read_b128 v[116:119], v12 offset:1024
ds_read_b128 v[120:123], v12 offset:2048
ds_read_b128 v[124:127], v12 offset:3072
ds_read_b128 v[128:131], v12 offset:4096
s_add_u32 s60, s94, 2
s_and_b32 s60, s60, 3
s_mul_i32 s60, s60, 20480
v_add_u32 v12, s60, v1
ds_read_b128 v[132:135], v12 offset:0
ds_read_b128 v[136:139], v12 offset:1024
ds_read_b128 v[140:143], v12 offset:2048
ds_read_b128 v[144:147], v12 offset:3072
ds_read_b128 v[148:151], v12 offset:4096
s_add_u32 s60, s94, 3
s_and_b32 s60, s60, 3
s_mul_i32 s60, s60, 20480
v_add_u32 v12, s60, v1
ds_read_b128 v[152:155], v12 offset:0
ds_read_b128 v[156:159], v12 offset:1024
ds_read_b128 v[160:163], v12 offset:2048
ds_read_b128 v[164:167], v12 offset:3072
ds_read_b128 v[168:171], v12 offset:4096
s_waitcnt lgkmcnt(10)
v_pk_add_f32 v[192:193], v[192:193], v[112:113]
v_pk_add_f32 v[194:195], v[194:195], v[114:115]
v_pk_add_f32 v[208:209], v[208:209], v[116:117]
v_pk_add_f32 v[210:211], v[210:211], v[118:119]
v_pk_add_f32 v[224:225], v[224:225], v[120:121]
v_pk_add_f32 v[226:227], v[226:227], v[122:123]
v_pk_add_f32 v[240:241], v[240:241], v[124:125]
v_pk_add_f32 v[242:243], v[242:243], v[126:127]
v_pk_add_f32 v[80:81], v[80:81], v[128:129]
v_pk_add_f32 v[82:83], v[82:83], v[130:131]
s_waitcnt lgkmcnt(5)
v_pk_add_f32 v[192:193], v[192:193], v[132:133]
v_pk_add_f32 v[194:195], v[194:195], v[134:135]
v_pk_add_f32 v[208:209], v[208:209], v[136:137]
v_pk_add_f32 v[210:211], v[210:211], v[138:139]
v_pk_add_f32 v[224:225], v[224:225], v[140:141]
v_pk_add_f32 v[226:227], v[226:227], v[142:143]
v_pk_add_f32 v[240:241], v[240:241], v[144:145]
v_pk_add_f32 v[242:243], v[242:243], v[146:147]
v_pk_add_f32 v[80:81], v[80:81], v[148:149]
v_pk_add_f32 v[82:83], v[82:83], v[150:151]
s_waitcnt lgkmcnt(0)
v_pk_add_f32 v[192:193], v[192:193], v[152:153]
v_pk_add_f32 v[194:195], v[194:195], v[154:155]
v_pk_add_f32 v[208:209], v[208:209], v[156:157]
v_pk_add_f32 v[210:211], v[210:211], v[158:159]
v_pk_add_f32 v[224:225], v[224:225], v[160:161]
v_pk_add_f32 v[226:227], v[226:227], v[162:163]
v_pk_add_f32 v[240:241], v[240:241], v[164:165]
v_pk_add_f32 v[242:243], v[242:243], v[166:167]
v_pk_add_f32 v[80:81], v[80:81], v[168:169]
v_pk_add_f32 v[82:83], v[82:83], v[170:171]
v_lshlrev_b32 v196, 16, v2
v_and_b32 v197, 0xffff0000, v2
v_lshlrev_b32 v198, 16, v3
v_and_b32 v199, 0xffff0000, v3
v_sub_f32 v196, v196, v192
v_sub_f32 v197, v197, v193
v_sub_f32 v198, v198, v194
v_sub_f32 v199, v199, v195
v_fmac_f32 v192, v101, v196
v_fmac_f32 v193, v101, v197
v_fmac_f32 v194, v101, v198
v_fmac_f32 v195, v101, v199
v_cvt_pk_bf16_f32 v192, v192, v193
v_cvt_pk_bf16_f32 v193, v194, v195
s_mov_b32 s60, 0
buffer_store_dwordx2 v[192:193], v96, s[40:43], s60 offen nt
v_lshlrev_b32 v212, 16, v4
v_and_b32 v213, 0xffff0000, v4
v_lshlrev_b32 v214, 16, v5
v_and_b32 v215, 0xffff0000, v5
v_sub_f32 v212, v212, v208
v_sub_f32 v213, v213, v209
v_sub_f32 v214, v214, v210
v_sub_f32 v215, v215, v211
v_fmac_f32 v208, v102, v212
v_fmac_f32 v209, v102, v213
v_fmac_f32 v210, v102, v214
v_fmac_f32 v211, v102, v215
v_cvt_pk_bf16_f32 v208, v208, v209
v_cvt_pk_bf16_f32 v209, v210, v211
s_mov_b32 s60, 18432
buffer_store_dwordx2 v[208:209], v96, s[40:43], s60 offen nt
v_lshlrev_b32 v228, 16, v6
v_and_b32 v229, 0xffff0000, v6
v_lshlrev_b32 v230, 16, v7
v_and_b32 v231, 0xffff0000, v7
v_sub_f32 v228, v228, v224
v_sub_f32 v229, v229, v225
v_sub_f32 v230, v230, v226
v_sub_f32 v231, v231, v227
v_fmac_f32 v224, v103, v228
v_fmac_f32 v225, v103, v229
v_fmac_f32 v226, v103, v230
v_fmac_f32 v227, v103, v231
v_cvt_pk_bf16_f32 v224, v224, v225
v_cvt_pk_bf16_f32 v225, v226, v227
s_mov_b32 s60, 36864
buffer_store_dwordx2 v[224:225], v96, s[40:43], s60 offen nt
v_lshlrev_b32 v244, 16, v8
v_and_b32 v245, 0xffff0000, v8
v_lshlrev_b32 v246, 16, v9
v_and_b32 v247, 0xffff0000, v9
v_sub_f32 v244, v244, v240
v_sub_f32 v245, v245, v241
v_sub_f32 v246, v246, v242
v_sub_f32 v247, v247, v243
v_fmac_f32 v240, v104, v244
v_fmac_f32 v241, v104, v245
v_fmac_f32 v242, v104, v246
v_fmac_f32 v243, v104, v247
v_cvt_pk_bf16_f32 v240, v240, v241
v_cvt_pk_bf16_f32 v241, v242, v243
s_mov_b32 s60, 55296
buffer_store_dwordx2 v[240:241], v96, s[40:43], s60 offen nt
v_lshlrev_b32 v84, 16, v10
v_and_b32 v85, 0xffff0000, v10
v_lshlrev_b32 v86, 16, v11
v_and_b32 v87, 0xffff0000, v11
v_sub_f32 v84, v84, v80
v_sub_f32 v85, v85, v81
v_sub_f32 v86, v86, v82
v_sub_f32 v87, v87, v83
v_fmac_f32 v80, v105, v84
v_fmac_f32 v81, v105, v85
v_fmac_f32 v82, v105, v86
v_fmac_f32 v83, v105, v87
v_cvt_pk_bf16_f32 v80, v80, v81
v_cvt_pk_bf16_f32 v81, v82, v83
s_mov_b32 s60, 73728
buffer_store_dwordx2 v[80:81], v96, s[40:43], s60 offen nt
s_endpgm
Lbshort:
s_waitcnt vmcnt(33)
s_waitcnt vmcnt(28)
s_waitcnt lgkmcnt(0)
ds_read_b64_tr_b16 v[48:49], v75 offset:4096
ds_read_b64_tr_b16 v[50:51], v75 offset:5120
ds_read_b64_tr_b16 v[52:53], v76 offset:4096
ds_read_b64_tr_b16 v[54:55], v76 offset:5120
ds_read_b64_tr_b16 v[56:57], v77 offset:4096
ds_read_b64_tr_b16 v[58:59], v77 offset:5120
ds_read_b64_tr_b16 v[60:61], v78 offset:4096
ds_read_b64_tr_b16 v[62:63], v78 offset:5120
v_mfma_f32_16x16x32_bf16 v[192:195], v[32:35], v[112:115], 0
s_add_u32 m0, s97, 0
s_add_u32 s99, s96, 0xab000
buffer_load_dwordx4 v69, s[44:47], s99 offen offset:0 lds
v_mfma_f32_16x16x32_bf16 v[196:199], v[36:39], v[112:115], 0
v_mfma_f32_16x16x32_bf16 v[200:203], v[40:43], v[112:115], 0
v_mfma_f32_16x16x32_bf16 v[204:207], v[44:47], v[112:115], 0
s_add_u32 s98, s95, 0x4800
buffer_load_dwordx4 v[112:115], v64, s[48:51], s98 offen sc1
v_mfma_f32_16x16x32_bf16 v[208:211], v[32:35], v[116:119], 0
buffer_load_dwordx4 v70, s[44:47], s99 offen offset:1024 lds
v_mfma_f32_16x16x32_bf16 v[212:215], v[36:39], v[116:119], 0
v_mfma_f32_16x16x32_bf16 v[216:219], v[40:43], v[116:119], 0
v_mfma_f32_16x16x32_bf16 v[220:223], v[44:47], v[116:119], 0
buffer_load_dwordx4 v[116:119], v65, s[48:51], s98 offen sc1
v_mfma_f32_16x16x32_bf16 v[224:227], v[32:35], v[120:123], 0
buffer_load_dwordx4 v71, s[44:47], s99 offen offset:2048 lds
v_mfma_f32_16x16x32_bf16 v[228:231], v[36:39], v[120:123], 0
v_mfma_f32_16x16x32_bf16 v[232:235], v[40:43], v[120:123], 0
v_mfma_f32_16x16x32_bf16 v[236:239], v[44:47], v[120:123], 0
buffer_load_dwordx4 v[120:123], v66, s[48:51], s98 offen sc1
v_mfma_f32_16x16x32_bf16 v[240:243], v[32:35], v[124:127], 0
buffer_load_dwordx4 v72, s[44:47], s99 offen offset:3072 lds
v_mfma_f32_16x16x32_bf16 v[244:247], v[36:39], v[124:127], 0
v_mfma_f32_16x16x32_bf16 v[248:251], v[40:43], v[124:127], 0
v_mfma_f32_16x16x32_bf16 v[252:255], v[44:47], v[124:127], 0
buffer_load_dwordx4 v[124:127], v67, s[48:51], s98 offen sc1
v_mfma_f32_16x16x32_bf16 v[80:83], v[32:35], v[128:131], 0
v_mfma_f32_16x16x32_bf16 v[84:87], v[36:39], v[128:131], 0
v_mfma_f32_16x16x32_bf16 v[88:91], v[40:43], v[128:131], 0
v_mfma_f32_16x16x32_bf16 v[92:95], v[44:47], v[128:131], 0
buffer_load_dwordx4 v[128:131], v68, s[48:51], s98 offen sc1
s_waitcnt vmcnt(32)
s_waitcnt vmcnt(28)
s_waitcnt lgkmcnt(0)
ds_read_b64_tr_b16 v[32:33], v75 offset:8192
ds_read_b64_tr_b16 v[34:35], v75 offset:9216
ds_read_b64_tr_b16 v[36:37], v76 offset:8192
ds_read_b64_tr_b16 v[38:39], v76 offset:9216
ds_read_b64_tr_b16 v[40:41], v77 offset:8192
ds_read_b64_tr_b16 v[42:43], v77 offset:9216
ds_read_b64_tr_b16 v[44:45], v78 offset:8192
ds_read_b64_tr_b16 v[46:47], v78 offset:9216
buffer_load_dword v31, v30, s[84:87], 0 offen offset:2048 sc1
v_mfma_f32_16x16x32_bf16 v[192:195], v[48:51], v[132:135], v[192:195]
s_add_u32 m0, s97, 4096
s_add_u32 s99, s96, 0xfc000
buffer_load_dwordx4 v69, s[44:47], s99 offen offset:0 lds
v_mfma_f32_16x16x32_bf16 v[196:199], v[52:55], v[132:135], v[196:199]
v_mfma_f32_16x16x32_bf16 v[200:203], v[56:59], v[132:135], v[200:203]
v_mfma_f32_16x16x32_bf16 v[204:207], v[60:63], v[132:135], v[204:207]
s_add_u32 s98, s95, 0x4c00
buffer_load_dwordx4 v[132:135], v64, s[48:51], s98 offen sc1
v_mfma_f32_16x16x32_bf16 v[208:211], v[48:51], v[136:139], v[208:211]
buffer_load_dwordx4 v70, s[44:47], s99 offen offset:1024 lds
v_mfma_f32_16x16x32_bf16 v[212:215], v[52:55], v[136:139], v[212:215]
v_mfma_f32_16x16x32_bf16 v[216:219], v[56:59], v[136:139], v[216:219]
v_mfma_f32_16x16x32_bf16 v[220:223], v[60:63], v[136:139], v[220:223]
buffer_load_dwordx4 v[136:139], v65, s[48:51], s98 offen sc1
v_mfma_f32_16x16x32_bf16 v[224:227], v[48:51], v[140:143], v[224:227]
buffer_load_dwordx4 v71, s[44:47], s99 offen offset:2048 lds
v_mfma_f32_16x16x32_bf16 v[228:231], v[52:55], v[140:143], v[228:231]
v_mfma_f32_16x16x32_bf16 v[232:235], v[56:59], v[140:143], v[232:235]
v_mfma_f32_16x16x32_bf16 v[236:239], v[60:63], v[140:143], v[236:239]
buffer_load_dwordx4 v[140:143], v66, s[48:51], s98 offen sc1
v_mfma_f32_16x16x32_bf16 v[240:243], v[48:51], v[144:147], v[240:243]
buffer_load_dwordx4 v72, s[44:47], s99 offen offset:3072 lds
v_mfma_f32_16x16x32_bf16 v[244:247], v[52:55], v[144:147], v[244:247]
v_mfma_f32_16x16x32_bf16 v[248:251], v[56:59], v[144:147], v[248:251]
v_mfma_f32_16x16x32_bf16 v[252:255], v[60:63], v[144:147], v[252:255]
buffer_load_dwordx4 v[144:147], v67, s[48:51], s98 offen sc1
v_mfma_f32_16x16x32_bf16 v[80:83], v[48:51], v[148:151], v[80:83]
v_mfma_f32_16x16x32_bf16 v[84:87], v[52:55], v[148:151], v[84:87]
v_mfma_f32_16x16x32_bf16 v[88:91], v[56:59], v[148:151], v[88:91]
v_mfma_f32_16x16x32_bf16 v[92:95], v[60:63], v[148:151], v[92:95]
buffer_load_dwordx4 v[148:151], v68, s[48:51], s98 offen sc1
s_lshl_b32 s60, s93, 6
s_lshl_b32 s61, s94, 4
s_add_u32 s60, s60, s61
s_lshl_b32 s61, s60, 12
s_mul_i32 s62, s92, 160
s_add_u32 s61, s61, s62
v_add_u32 v1, 0, v0
v_mul_u32_u24 v12, 6554, v1
v_lshrrev_b32 v12, 16, v12
v_mul_u32_u24 v98, 3936, v12
v_lshl_add_u32 v98, v1, 4, v98
v_add_u32 v98, s61, v98
v_add_u32 v1, 64, v0
v_mul_u32_u24 v12, 6554, v1
v_lshrrev_b32 v12, 16, v12
v_mul_u32_u24 v99, 3936, v12
v_lshl_add_u32 v99, v1, 4, v99
v_add_u32 v99, s61, v99
v_add_u32 v1, 128, v0
v_mul_u32_u24 v12, 6554, v1
v_lshrrev_b32 v12, 16, v12
v_mul_u32_u24 v100, 3936, v12
v_lshl_add_u32 v100, v1, 4, v100
v_add_u32 v100, s61, v100
v_cmp_gt_u32 vcc, 32, v0
v_mov_b32 v1, 0x40000000
s_nop 0
v_cndmask_b32 v100, v1, v100, vcc
v_lshrrev_b32 v1, 2, v0
v_mul_u32_u24 v1, 160, v1
v_and_b32 v12, 3, v0
v_lshl_add_u32 v1, v12, 3, v1
v_add_u32 v97, s97, v1
s_mul_i32 s62, s92, 80
v_and_b32 v1, 15, v0
v_add_u32 v1, s62, v1
v_lshlrev_b32 v101, 2, v1
v_mul_u32_u24 v1, 1152, v1
v_lshrrev_b32 v12, 4, v0
v_lshl_add_u32 v1, v12, 3, v1
s_lshl_b32 s60, s60, 1
v_add_u32 v96, s60, v1
v_lshl_add_u32 v79, v0, 4, s97
s_lshl_b32 s60, s93, 8
s_add_u32 s60, s60, 6144
v_and_b32 v13, 63, v0
v_lshl_add_u32 v13, v13, 2, s60
v_add_u32 v28, 2048, v30
s_waitcnt vmcnt(33)
s_waitcnt vmcnt(29)
s_waitcnt lgkmcnt(0)
ds_read_b64_tr_b16 v[48:49], v75 offset:12288
ds_read_b64_tr_b16 v[50:51], v75 offset:13312
ds_read_b64_tr_b16 v[52:53], v76 offset:12288
ds_read_b64_tr_b16 v[54:55], v76 offset:13312
ds_read_b64_tr_b16 v[56:57], v77 offset:12288
ds_read_b64_tr_b16 v[58:59], v77 offset:13312
ds_read_b64_tr_b16 v[60:61], v78 offset:12288
ds_read_b64_tr_b16 v[62:63], v78 offset:13312
v_mfma_f32_16x16x32_bf16 v[192:195], v[32:35], v[152:155], v[192:195]
s_add_u32 m0, s97, 8192
s_add_u32 s99, s96, 0x105000
buffer_load_dwordx4 v69, s[44:47], s99 offen offset:0 lds
v_mfma_f32_16x16x32_bf16 v[196:199], v[36:39], v[152:155], v[196:199]
v_mfma_f32_16x16x32_bf16 v[200:203], v[40:43], v[152:155], v[200:203]
v_mfma_f32_16x16x32_bf16 v[204:207], v[44:47], v[152:155], v[204:207]
s_add_u32 s98, s95, 0x7000
buffer_load_dwordx4 v[152:155], v64, s[48:51], s98 offen sc1
v_mfma_f32_16x16x32_bf16 v[208:211], v[32:35], v[156:159], v[208:211]
buffer_load_dwordx4 v70, s[44:47], s99 offen offset:1024 lds
v_mfma_f32_16x16x32_bf16 v[212:215], v[36:39], v[156:159], v[212:215]
v_mfma_f32_16x16x32_bf16 v[216:219], v[40:43], v[156:159], v[216:219]
v_mfma_f32_16x16x32_bf16 v[220:223], v[44:47], v[156:159], v[220:223]
buffer_load_dwordx4 v[156:159], v65, s[48:51], s98 offen sc1
v_mfma_f32_16x16x32_bf16 v[224:227], v[32:35], v[160:163], v[224:227]
buffer_load_dwordx4 v71, s[44:47], s99 offen offset:2048 lds
v_mfma_f32_16x16x32_bf16 v[228:231], v[36:39], v[160:163], v[228:231]
v_mfma_f32_16x16x32_bf16 v[232:235], v[40:43], v[160:163], v[232:235]
v_mfma_f32_16x16x32_bf16 v[236:239], v[44:47], v[160:163], v[236:239]
buffer_load_dwordx4 v[160:163], v66, s[48:51], s98 offen sc1
v_mfma_f32_16x16x32_bf16 v[240:243], v[32:35], v[164:167], v[240:243]
buffer_load_dwordx4 v72, s[44:47], s99 offen offset:3072 lds
v_mfma_f32_16x16x32_bf16 v[244:247], v[36:39], v[164:167], v[244:247]
v_mfma_f32_16x16x32_bf16 v[248:251], v[40:43], v[164:167], v[248:251]
v_mfma_f32_16x16x32_bf16 v[252:255], v[44:47], v[164:167], v[252:255]
buffer_load_dwordx4 v[164:167], v67, s[48:51], s98 offen sc1
v_mfma_f32_16x16x32_bf16 v[80:83], v[32:35], v[168:171], v[80:83]
v_mfma_f32_16x16x32_bf16 v[84:87], v[36:39], v[168:171], v[84:87]
v_mfma_f32_16x16x32_bf16 v[88:91], v[40:43], v[168:171], v[88:91]
v_mfma_f32_16x16x32_bf16 v[92:95], v[44:47], v[168:171], v[92:95]
buffer_load_dwordx4 v[168:171], v68, s[48:51], s98 offen sc1
s_waitcnt vmcnt(32)
s_waitcnt vmcnt(28)
s_waitcnt lgkmcnt(0)
ds_read_b64_tr_b16 v[32:33], v75 offset:16384
ds_read_b64_tr_b16 v[34:35], v75 offset:17408
ds_read_b64_tr_b16 v[36:37], v76 offset:16384
ds_read_b64_tr_b16 v[38:39], v76 offset:17408
ds_read_b64_tr_b16 v[40:41], v77 offset:16384
ds_read_b64_tr_b16 v[42:43], v77 offset:17408
ds_read_b64_tr_b16 v[44:45], v78 offset:16384
ds_read_b64_tr_b16 v[46:47], v78 offset:17408
v_mfma_f32_16x16x32_bf16 v[192:195], v[48:51], v[172:175], v[192:195]
s_add_u32 m0, s97, 12288
s_add_u32 s99, s96, 0x12000
buffer_load_dwordx4 v69, s[44:47], s99 offen offset:0 lds
v_mfma_f32_16x16x32_bf16 v[196:199], v[52:55], v[172:175], v[196:199]
v_mfma_f32_16x16x32_bf16 v[200:203], v[56:59], v[172:175], v[200:203]
v_mfma_f32_16x16x32_bf16 v[204:207], v[60:63], v[172:175], v[204:207]
s_add_u32 s98, s95, 0x7400
buffer_load_dwordx4 v[172:175], v64, s[48:51], s98 offen sc1
v_mfma_f32_16x16x32_bf16 v[208:211], v[48:51], v[176:179], v[208:211]
buffer_load_dwordx4 v70, s[44:47], s99 offen offset:1024 lds
v_mfma_f32_16x16x32_bf16 v[212:215], v[52:55], v[176:179], v[212:215]
v_mfma_f32_16x16x32_bf16 v[216:219], v[56:59], v[176:179], v[216:219]
v_mfma_f32_16x16x32_bf16 v[220:223], v[60:63], v[176:179], v[220:223]
buffer_load_dwordx4 v[176:179], v65, s[48:51], s98 offen sc1
v_mfma_f32_16x16x32_bf16 v[224:227], v[48:51], v[180:183], v[224:227]
buffer_load_dwordx4 v71, s[44:47], s99 offen offset:2048 lds
v_mfma_f32_16x16x32_bf16 v[228:231], v[52:55], v[180:183], v[228:231]
v_mfma_f32_16x16x32_bf16 v[232:235], v[56:59], v[180:183], v[232:235]
v_mfma_f32_16x16x32_bf16 v[236:239], v[60:63], v[180:183], v[236:239]
buffer_load_dwordx4 v[180:183], v66, s[48:51], s98 offen sc1
v_mfma_f32_16x16x32_bf16 v[240:243], v[48:51], v[184:187], v[240:243]
buffer_load_dwordx4 v72, s[44:47], s99 offen offset:3072 lds
v_mfma_f32_16x16x32_bf16 v[244:247], v[52:55], v[184:187], v[244:247]
v_mfma_f32_16x16x32_bf16 v[248:251], v[56:59], v[184:187], v[248:251]
v_mfma_f32_16x16x32_bf16 v[252:255], v[60:63], v[184:187], v[252:255]
buffer_load_dwordx4 v[184:187], v67, s[48:51], s98 offen sc1
v_mfma_f32_16x16x32_bf16 v[80:83], v[48:51], v[188:191], v[80:83]
v_mfma_f32_16x16x32_bf16 v[84:87], v[52:55], v[188:191], v[84:87]
v_mfma_f32_16x16x32_bf16 v[88:91], v[56:59], v[188:191], v[88:91]
v_mfma_f32_16x16x32_bf16 v[92:95], v[60:63], v[188:191], v[92:95]
buffer_load_dwordx4 v[188:191], v68, s[48:51], s98 offen sc1
s_waitcnt vmcnt(28)
s_lshl_b32 s60, s52, 7
s_lshl_b32 s61, s53, 2
s_add_u32 s60, s60, s61
s_add_u32 s60, s60, 4096
s_mov_b64 exec, 1
v_mov_b32 v14, 72768
v_mov_b32 v15, 1
ds_add_rtn_u32 v14, v14, v15
s_waitcnt lgkmcnt(0)
v_cmp_ne_u32 vcc, 7, v14
v_mov_b32 v14, s60
v_mov_b32 v15, s100
s_cbranch_vccnz Lsk14
buffer_store_dword v15, v14, s[84:87], 0 offen sc1
Lsk14:
s_mov_b64 exec, -1
ds_read_b64_tr_b16 v[48:49], v75 offset:0
ds_read_b64_tr_b16 v[50:51], v75 offset:1024
ds_read_b64_tr_b16 v[52:53], v76 offset:0
ds_read_b64_tr_b16 v[54:55], v76 offset:1024
ds_read_b64_tr_b16 v[56:57], v77 offset:0
ds_read_b64_tr_b16 v[58:59], v77 offset:1024
ds_read_b64_tr_b16 v[60:61], v78 offset:0
ds_read_b64_tr_b16 v[62:63], v78 offset:1024
v_mfma_f32_16x16x32_bf16 v[192:195], v[32:35], v[112:115], v[192:195]
s_add_u32 m0, s97, 16384
s_add_u32 s99, s96, 0x24000
buffer_load_dwordx4 v69, s[44:47], s99 offen offset:0 lds
v_mfma_f32_16x16x32_bf16 v[196:199], v[36:39], v[112:115], v[196:199]
v_mfma_f32_16x16x32_bf16 v[200:203], v[40:43], v[112:115], v[200:203]
v_mfma_f32_16x16x32_bf16 v[204:207], v[44:47], v[112:115], v[204:207]
s_add_u32 s98, s95, 0x800
buffer_load_dwordx4 v[112:115], v64, s[48:51], s98 offen sc1
v_mfma_f32_16x16x32_bf16 v[208:211], v[32:35], v[116:119], v[208:211]
buffer_load_dwordx4 v70, s[44:47], s99 offen offset:1024 lds
v_mfma_f32_16x16x32_bf16 v[212:215], v[36:39], v[116:119], v[212:215]
v_mfma_f32_16x16x32_bf16 v[216:219], v[40:43], v[116:119], v[216:219]
v_mfma_f32_16x16x32_bf16 v[220:223], v[44:47], v[116:119], v[220:223]
buffer_load_dwordx4 v[116:119], v65, s[48:51], s98 offen sc1
v_mfma_f32_16x16x32_bf16 v[224:227], v[32:35], v[120:123], v[224:227]
buffer_load_dwordx4 v71, s[44:47], s99 offen offset:2048 lds
v_mfma_f32_16x16x32_bf16 v[228:231], v[36:39], v[120:123], v[228:231]
v_mfma_f32_16x16x32_bf16 v[232:235], v[40:43], v[120:123], v[232:235]
v_mfma_f32_16x16x32_bf16 v[236:239], v[44:47], v[120:123], v[236:239]
buffer_load_dwordx4 v[120:123], v66, s[48:51], s98 offen sc1
v_mfma_f32_16x16x32_bf16 v[240:243], v[32:35], v[124:127], v[240:243]
buffer_load_dwordx4 v72, s[44:47], s99 offen offset:3072 lds
v_mfma_f32_16x16x32_bf16 v[244:247], v[36:39], v[124:127], v[244:247]
v_mfma_f32_16x16x32_bf16 v[248:251], v[40:43], v[124:127], v[248:251]
v_mfma_f32_16x16x32_bf16 v[252:255], v[44:47], v[124:127], v[252:255]
buffer_load_dwordx4 v[124:127], v67, s[48:51], s98 offen sc1
v_mfma_f32_16x16x32_bf16 v[80:83], v[32:35], v[128:131], v[80:83]
v_mfma_f32_16x16x32_bf16 v[84:87], v[36:39], v[128:131], v[84:87]
v_mfma_f32_16x16x32_bf16 v[88:91], v[40:43], v[128:131], v[88:91]
v_mfma_f32_16x16x32_bf16 v[92:95], v[44:47], v[128:131], v[92:95]
buffer_load_dwordx4 v[128:131], v68, s[48:51], s98 offen sc1
s_waitcnt vmcnt(27)
v_cmp_ne_u32 vcc, s100, v31
s_nop 1
s_cbranch_vccz Lok15
s_mov_b32 s83, 20000
Llp16:
buffer_load_dword v31, v30, s[84:87], 0 offen offset:2048 sc1
s_sub_u32 s83, s83, 1
s_cbranch_scc1 Lok15
s_waitcnt vmcnt(0)
v_cmp_ne_u32 vcc, s100, v31
s_nop 1
s_cbranch_vccnz Llp16
Lok15:
s_waitcnt lgkmcnt(0)
ds_read_b64_tr_b16 v[32:33], v75 offset:4096
ds_read_b64_tr_b16 v[34:35], v75 offset:5120
ds_read_b64_tr_b16 v[36:37], v76 offset:4096
ds_read_b64_tr_b16 v[38:39], v76 offset:5120
ds_read_b64_tr_b16 v[40:41], v77 offset:4096
ds_read_b64_tr_b16 v[42:43], v77 offset:5120
ds_read_b64_tr_b16 v[44:45], v78 offset:4096
ds_read_b64_tr_b16 v[46:47], v78 offset:5120
v_mfma_f32_16x16x32_bf16 v[192:195], v[48:51], v[132:135], v[192:195]
s_add_u32 m0, s97, 0
s_add_u32 s99, s96, 0x2d000
buffer_load_dwordx4 v69, s[44:47], s99 offen offset:0 lds
v_mfma_f32_16x16x32_bf16 v[196:199], v[52:55], v[132:135], v[196:199]
v_mfma_f32_16x16x32_bf16 v[200:203], v[56:59], v[132:135], v[200:203]
v_mfma_f32_16x16x32_bf16 v[204:207], v[60:63], v[132:135], v[204:207]
s_add_u32 s98, s95, 0x1000
buffer_load_dwordx4 v[132:135], v64, s[48:51], s98 offen sc1
v_mfma_f32_16x16x32_bf16 v[208:211], v[48:51], v[136:139], v[208:211]
buffer_load_dwordx4 v70, s[44:47], s99 offen offset:1024 lds
v_mfma_f32_16x16x32_bf16 v[212:215], v[52:55], v[136:139], v[212:215]
v_mfma_f32_16x16x32_bf16 v[216:219], v[56:59], v[136:139], v[216:219]
v_mfma_f32_16x16x32_bf16 v[220:223], v[60:63], v[136:139], v[220:223]
buffer_load_dwordx4 v[136:139], v65, s[48:51], s98 offen sc1
v_mfma_f32_16x16x32_bf16 v[224:227], v[48:51], v[140:143], v[224:227]
buffer_load_dwordx4 v71, s[44:47], s99 offen offset:2048 lds
v_mfma_f32_16x16x32_bf16 v[228:231], v[52:55], v[140:143], v[228:231]
v_mfma_f32_16x16x32_bf16 v[232:235], v[56:59], v[140:143], v[232:235]
v_mfma_f32_16x16x32_bf16 v[236:239], v[60:63], v[140:143], v[236:239]
buffer_load_dwordx4 v[140:143], v66, s[48:51], s98 offen sc1
v_mfma_f32_16x16x32_bf16 v[240:243], v[48:51], v[144:147], v[240:243]
buffer_load_dwordx4 v72, s[44:47], s99 offen offset:3072 lds
v_mfma_f32_16x16x32_bf16 v[244:247], v[52:55], v[144:147], v[244:247]
v_mfma_f32_16x16x32_bf16 v[248:251], v[56:59], v[144:147], v[248:251]
v_mfma_f32_16x16x32_bf16 v[252:255], v[60:63], v[144:147], v[252:255]
buffer_load_dwordx4 v[144:147], v67, s[48:51], s98 offen sc1
v_mfma_f32_16x16x32_bf16 v[80:83], v[48:51], v[148:151], v[80:83]
v_mfma_f32_16x16x32_bf16 v[84:87], v[52:55], v[148:151], v[84:87]
v_mfma_f32_16x16x32_bf16 v[88:91], v[56:59], v[148:151], v[88:91]
v_mfma_f32_16x16x32_bf16 v[92:95], v[60:63], v[148:151], v[92:95]
buffer_load_dwordx4 v[148:151], v68, s[48:51], s98 offen sc1
s_waitcnt vmcnt(27)
s_waitcnt lgkmcnt(0)
ds_read_b64_tr_b16 v[48:49], v75 offset:8192
ds_read_b64_tr_b16 v[50:51], v75 offset:9216
ds_read_b64_tr_b16 v[52:53], v76 offset:8192
ds_read_b64_tr_b16 v[54:55], v76 offset:9216
ds_read_b64_tr_b16 v[56:57], v77 offset:8192
ds_read_b64_tr_b16 v[58:59], v77 offset:9216
ds_read_b64_tr_b16 v[60:61], v78 offset:8192
ds_read_b64_tr_b16 v[62:63], v78 offset:9216
v_mfma_f32_16x16x32_bf16 v[192:195], v[32:35], v[152:155], v[192:195]
s_add_u32 m0, s97, 4096
s_add_u32 s99, s96, 0x7e000
buffer_load_dwordx4 v69, s[44:47], s99 offen offset:0 lds
v_mfma_f32_16x16x32_bf16 v[196:199], v[36:39], v[152:155], v[196:199]
v_mfma_f32_16x16x32_bf16 v[200:203], v[40:43], v[152:155], v[200:203]
v_mfma_f32_16x16x32_bf16 v[204:207], v[44:47], v[152:155], v[204:207]
s_add_u32 s98, s95, 0x1400
buffer_load_dwordx4 v[152:155], v64, s[48:51], s98 offen sc1
v_mfma_f32_16x16x32_bf16 v[208:211], v[32:35], v[156:159], v[208:211]
buffer_load_dwordx4 v70, s[44:47], s99 offen offset:1024 lds
v_mfma_f32_16x16x32_bf16 v[212:215], v[36:39], v[156:159], v[212:215]
v_mfma_f32_16x16x32_bf16 v[216:219], v[40:43], v[156:159], v[216:219]
v_mfma_f32_16x16x32_bf16 v[220:223], v[44:47], v[156:159], v[220:223]
buffer_load_dwordx4 v[156:159], v65, s[48:51], s98 offen sc1
v_mfma_f32_16x16x32_bf16 v[224:227], v[32:35], v[160:163], v[224:227]
buffer_load_dwordx4 v71, s[44:47], s99 offen offset:2048 lds
v_mfma_f32_16x16x32_bf16 v[228:231], v[36:39], v[160:163], v[228:231]
v_mfma_f32_16x16x32_bf16 v[232:235], v[40:43], v[160:163], v[232:235]
v_mfma_f32_16x16x32_bf16 v[236:239], v[44:47], v[160:163], v[236:239]
buffer_load_dwordx4 v[160:163], v66, s[48:51], s98 offen sc1
v_mfma_f32_16x16x32_bf16 v[240:243], v[32:35], v[164:167], v[240:243]
buffer_load_dwordx4 v72, s[44:47], s99 offen offset:3072 lds
v_mfma_f32_16x16x32_bf16 v[244:247], v[36:39], v[164:167], v[244:247]
v_mfma_f32_16x16x32_bf16 v[248:251], v[40:43], v[164:167], v[248:251]
v_mfma_f32_16x16x32_bf16 v[252:255], v[44:47], v[164:167], v[252:255]
buffer_load_dwordx4 v[164:167], v67, s[48:51], s98 offen sc1
v_mfma_f32_16x16x32_bf16 v[80:83], v[32:35], v[168:171], v[80:83]
v_mfma_f32_16x16x32_bf16 v[84:87], v[36:39], v[168:171], v[84:87]
v_mfma_f32_16x16x32_bf16 v[88:91], v[40:43], v[168:171], v[88:91]
v_mfma_f32_16x16x32_bf16 v[92:95], v[44:47], v[168:171], v[92:95]
buffer_load_dwordx4 v[168:171], v68, s[48:51], s98 offen sc1
s_waitcnt vmcnt(27)
s_waitcnt lgkmcnt(0)
ds_read_b64_tr_b16 v[32:33], v75 offset:12288
ds_read_b64_tr_b16 v[34:35], v75 offset:13312
ds_read_b64_tr_b16 v[36:37], v76 offset:12288
ds_read_b64_tr_b16 v[38:39], v76 offset:13312
ds_read_b64_tr_b16 v[40:41], v77 offset:12288
ds_read_b64_tr_b16 v[42:43], v77 offset:13312
ds_read_b64_tr_b16 v[44:45], v78 offset:12288
ds_read_b64_tr_b16 v[46:47], v78 offset:13312
v_mfma_f32_16x16x32_bf16 v[192:195], v[48:51], v[172:175], v[192:195]
s_add_u32 m0, s97, 8192
s_add_u32 s99, s96, 0x87000
buffer_load_dwordx4 v69, s[44:47], s99 offen offset:0 lds
v_mfma_f32_16x16x32_bf16 v[196:199], v[52:55], v[172:175], v[196:199]
v_mfma_f32_16x16x32_bf16 v[200:203], v[56:59], v[172:175], v[200:203]
v_mfma_f32_16x16x32_bf16 v[204:207], v[60:63], v[172:175], v[204:207]
s_add_u32 s98, s95, 0x3800
buffer_load_dwordx4 v[172:175], v64, s[48:51], s98 offen sc1
v_mfma_f32_16x16x32_bf16 v[208:211], v[48:51], v[176:179], v[208:211]
buffer_load_dwordx4 v70, s[44:47], s99 offen offset:1024 lds
v_mfma_f32_16x16x32_bf16 v[212:215], v[52:55], v[176:179], v[212:215]
v_mfma_f32_16x16x32_bf16 v[216:219], v[56:59], v[176:179], v[216:219]
v_mfma_f32_16x16x32_bf16 v[220:223], v[60:63], v[176:179], v[220:223]
buffer_load_dwordx4 v[176:179], v65, s[48:51], s98 offen sc1
v_mfma_f32_16x16x32_bf16 v[224:227], v[48:51], v[180:183], v[224:227]
buffer_load_dwordx4 v71, s[44:47], s99 offen offset:2048 lds
v_mfma_f32_16x16x32_bf16 v[228:231], v[52:55], v[180:183], v[228:231]
v_mfma_f32_16x16x32_bf16 v[232:235], v[56:59], v[180:183], v[232:235]
v_mfma_f32_16x16x32_bf16 v[236:239], v[60:63], v[180:183], v[236:239]
buffer_load_dwordx4 v[180:183], v66, s[48:51], s98 offen sc1
v_mfma_f32_16x16x32_bf16 v[240:243], v[48:51], v[184:187], v[240:243]
buffer_load_dwordx4 v72, s[44:47], s99 offen offset:3072 lds
v_mfma_f32_16x16x32_bf16 v[244:247], v[52:55], v[184:187], v[244:247]
v_mfma_f32_16x16x32_bf16 v[248:251], v[56:59], v[184:187], v[248:251]
v_mfma_f32_16x16x32_bf16 v[252:255], v[60:63], v[184:187], v[252:255]
buffer_load_dwordx4 v[184:187], v67, s[48:51], s98 offen sc1
v_mfma_f32_16x16x32_bf16 v[80:83], v[48:51], v[188:191], v[80:83]
v_mfma_f32_16x16x32_bf16 v[84:87], v[52:55], v[188:191], v[84:87]
v_mfma_f32_16x16x32_bf16 v[88:91], v[56:59], v[188:191], v[88:91]
v_mfma_f32_16x16x32_bf16 v[92:95], v[60:63], v[188:191], v[92:95]
buffer_load_dwordx4 v[188:191], v68, s[48:51], s98 offen sc1
s_waitcnt vmcnt(27)
s_waitcnt lgkmcnt(0)
ds_read_b64_tr_b16 v[48:49], v75 offset:16384
ds_read_b64_tr_b16 v[50:51], v75 offset:17408
ds_read_b64_tr_b16 v[52:53], v76 offset:16384
ds_read_b64_tr_b16 v[54:55], v76 offset:17408
ds_read_b64_tr_b16 v[56:57], v77 offset:16384
ds_read_b64_tr_b16 v[58:59], v77 offset:17408
ds_read_b64_tr_b16 v[60:61], v78 offset:16384
ds_read_b64_tr_b16 v[62:63], v78 offset:17408
v_mfma_f32_16x16x32_bf16 v[192:195], v[32:35], v[112:115], v[192:195]
s_add_u32 m0, s97, 12288
s_add_u32 s99, s96, 0xc6000
buffer_load_dwordx4 v69, s[44:47], s99 offen offset:0 lds
v_mfma_f32_16x16x32_bf16 v[196:199], v[36:39], v[112:115], v[196:199]
v_mfma_f32_16x16x32_bf16 v[200:203], v[40:43], v[112:115], v[200:203]
v_mfma_f32_16x16x32_bf16 v[204:207], v[44:47], v[112:115], v[204:207]
s_add_u32 s98, s95, 0x3c00
buffer_load_dwordx4 v[112:115], v64, s[48:51], s98 offen sc1
v_mfma_f32_16x16x32_bf16 v[208:211], v[32:35], v[116:119], v[208:211]
buffer_load_dwordx4 v70, s[44:47], s99 offen offset:1024 lds
v_mfma_f32_16x16x32_bf16 v[212:215], v[36:39], v[116:119], v[212:215]
v_mfma_f32_16x16x32_bf16 v[216:219], v[40:43], v[116:119], v[216:219]
v_mfma_f32_16x16x32_bf16 v[220:223], v[44:47], v[116:119], v[220:223]
buffer_load_dwordx4 v[116:119], v65, s[48:51], s98 offen sc1
v_mfma_f32_16x16x32_bf16 v[224:227], v[32:35], v[120:123], v[224:227]
buffer_load_dwordx4 v71, s[44:47], s99 offen offset:2048 lds
v_mfma_f32_16x16x32_bf16 v[228:231], v[36:39], v[120:123], v[228:231]
v_mfma_f32_16x16x32_bf16 v[232:235], v[40:43], v[120:123], v[232:235]
v_mfma_f32_16x16x32_bf16 v[236:239], v[44:47], v[120:123], v[236:239]
buffer_load_dwordx4 v[120:123], v66, s[48:51], s98 offen sc1
v_mfma_f32_16x16x32_bf16 v[240:243], v[32:35], v[124:127], v[240:243]
buffer_load_dwordx4 v72, s[44:47], s99 offen offset:3072 lds
v_mfma_f32_16x16x32_bf16 v[244:247], v[36:39], v[124:127], v[244:247]
v_mfma_f32_16x16x32_bf16 v[248:251], v[40:43], v[124:127], v[248:251]
v_mfma_f32_16x16x32_bf16 v[252:255], v[44:47], v[124:127], v[252:255]
buffer_load_dwordx4 v[124:127], v67, s[48:51], s98 offen sc1
v_mfma_f32_16x16x32_bf16 v[80:83], v[32:35], v[128:131], v[80:83]
v_mfma_f32_16x16x32_bf16 v[84:87], v[36:39], v[128:131], v[84:87]
v_mfma_f32_16x16x32_bf16 v[88:91], v[40:43], v[128:131], v[88:91]
v_mfma_f32_16x16x32_bf16 v[92:95], v[44:47], v[128:131], v[92:95]
buffer_load_dwordx4 v[128:131], v68, s[48:51], s98 offen sc1
s_waitcnt vmcnt(27)
s_waitcnt lgkmcnt(0)
ds_read_b64_tr_b16 v[32:33], v75 offset:0
ds_read_b64_tr_b16 v[34:35], v75 offset:1024
ds_read_b64_tr_b16 v[36:37], v76 offset:0
ds_read_b64_tr_b16 v[38:39], v76 offset:1024
ds_read_b64_tr_b16 v[40:41], v77 offset:0
ds_read_b64_tr_b16 v[42:43], v77 offset:1024
ds_read_b64_tr_b16 v[44:45], v78 offset:0
ds_read_b64_tr_b16 v[46:47], v78 offset:1024
buffer_load_dword v31, v28, s[84:87], 0 offen offset:2048 sc1
v_mfma_f32_16x16x32_bf16 v[192:195], v[48:51], v[132:135], v[192:195]
s_add_u32 m0, s97, 16384
s_add_u32 s99, s96, 0xcf000
buffer_load_dwordx4 v69, s[44:47], s99 offen offset:0 lds
v_mfma_f32_16x16x32_bf16 v[196:199], v[52:55], v[132:135], v[196:199]
v_mfma_f32_16x16x32_bf16 v[200:203], v[56:59], v[132:135], v[200:203]
v_mfma_f32_16x16x32_bf16 v[204:207], v[60:63], v[132:135], v[204:207]
s_add_u32 s98, s95, 0x5800
buffer_load_dwordx4 v[132:135], v64, s[48:51], s98 offen sc1
v_mfma_f32_16x16x32_bf16 v[208:211], v[48:51], v[136:139], v[208:211]
buffer_load_dwordx4 v70, s[44:47], s99 offen offset:1024 lds
v_mfma_f32_16x16x32_bf16 v[212:215], v[52:55], v[136:139], v[212:215]
v_mfma_f32_16x16x32_bf16 v[216:219], v[56:59], v[136:139], v[216:219]
v_mfma_f32_16x16x32_bf16 v[220:223], v[60:63], v[136:139], v[220:223]
buffer_load_dwordx4 v[136:139], v65, s[48:51], s98 offen sc1
v_mfma_f32_16x16x32_bf16 v[224:227], v[48:51], v[140:143], v[224:227]
buffer_load_dwordx4 v71, s[44:47], s99 offen offset:2048 lds
v_mfma_f32_16x16x32_bf16 v[228:231], v[52:55], v[140:143], v[228:231]
v_mfma_f32_16x16x32_bf16 v[232:235], v[56:59], v[140:143], v[232:235]
v_mfma_f32_16x16x32_bf16 v[236:239], v[60:63], v[140:143], v[236:239]
buffer_load_dwordx4 v[140:143], v66, s[48:51], s98 offen sc1
v_mfma_f32_16x16x32_bf16 v[240:243], v[48:51], v[144:147], v[240:243]
buffer_load_dwordx4 v72, s[44:47], s99 offen offset:3072 lds
v_mfma_f32_16x16x32_bf16 v[244:247], v[52:55], v[144:147], v[244:247]
v_mfma_f32_16x16x32_bf16 v[248:251], v[56:59], v[144:147], v[248:251]
v_mfma_f32_16x16x32_bf16 v[252:255], v[60:63], v[144:147], v[252:255]
buffer_load_dwordx4 v[144:147], v67, s[48:51], s98 offen sc1
v_mfma_f32_16x16x32_bf16 v[80:83], v[48:51], v[148:151], v[80:83]
v_mfma_f32_16x16x32_bf16 v[84:87], v[52:55], v[148:151], v[84:87]
v_mfma_f32_16x16x32_bf16 v[88:91], v[56:59], v[148:151], v[88:91]
v_mfma_f32_16x16x32_bf16 v[92:95], v[60:63], v[148:151], v[92:95]
buffer_load_dwordx4 v[148:151], v68, s[48:51], s98 offen sc1
s_waitcnt vmcnt(28)
s_waitcnt lgkmcnt(0)
ds_read_b64_tr_b16 v[48:49], v75 offset:4096
ds_read_b64_tr_b16 v[50:51], v75 offset:5120
ds_read_b64_tr_b16 v[52:53], v76 offset:4096
ds_read_b64_tr_b16 v[54:55], v76 offset:5120
ds_read_b64_tr_b16 v[56:57], v77 offset:4096
ds_read_b64_tr_b16 v[58:59], v77 offset:5120
ds_read_b64_tr_b16 v[60:61], v78 offset:4096
ds_read_b64_tr_b16 v[62:63], v78 offset:5120
v_mfma_f32_16x16x32_bf16 v[192:195], v[32:35], v[152:155], v[192:195]
s_add_u32 m0, s97, 0
s_add_u32 s99, s96, 0x120000
buffer_load_dwordx4 v69, s[44:47], s99 offen offset:0 lds
v_mfma_f32_16x16x32_bf16 v[196:199], v[36:39], v[152:155], v[196:199]
v_mfma_f32_16x16x32_bf16 v[200:203], v[40:43], v[152:155], v[200:203]
v_mfma_f32_16x16x32_bf16 v[204:207], v[44:47], v[152:155], v[204:207]
s_add_u32 s98, s95, 0x5c00
buffer_load_dwordx4 v[152:155], v64, s[48:51], s98 offen sc1
v_mfma_f32_16x16x32_bf16 v[208:211], v[32:35], v[156:159], v[208:211]
buffer_load_dwordx4 v70, s[44:47], s99 offen offset:1024 lds
v_mfma_f32_16x16x32_bf16 v[212:215], v[36:39], v[156:159], v[212:215]
v_mfma_f32_16x16x32_bf16 v[216:219], v[40:43], v[156:159], v[216:219]
v_mfma_f32_16x16x32_bf16 v[220:223], v[44:47], v[156:159], v[220:223]
buffer_load_dwordx4 v[156:159], v65, s[48:51], s98 offen sc1
v_mfma_f32_16x16x32_bf16 v[224:227], v[32:35], v[160:163], v[224:227]
buffer_load_dwordx4 v71, s[44:47], s99 offen offset:2048 lds
v_mfma_f32_16x16x32_bf16 v[228:231], v[36:39], v[160:163], v[228:231]
v_mfma_f32_16x16x32_bf16 v[232:235], v[40:43], v[160:163], v[232:235]
v_mfma_f32_16x16x32_bf16 v[236:239], v[44:47], v[160:163], v[236:239]
buffer_load_dwordx4 v[160:163], v66, s[48:51], s98 offen sc1
v_mfma_f32_16x16x32_bf16 v[240:243], v[32:35], v[164:167], v[240:243]
buffer_load_dwordx4 v72, s[44:47], s99 offen offset:3072 lds
v_mfma_f32_16x16x32_bf16 v[244:247], v[36:39], v[164:167], v[244:247]
v_mfma_f32_16x16x32_bf16 v[248:251], v[40:43], v[164:167], v[248:251]
v_mfma_f32_16x16x32_bf16 v[252:255], v[44:47], v[164:167], v[252:255]
buffer_load_dwordx4 v[164:167], v67, s[48:51], s98 offen sc1
v_mfma_f32_16x16x32_bf16 v[80:83], v[32:35], v[168:171], v[80:83]
v_mfma_f32_16x16x32_bf16 v[84:87], v[36:39], v[168:171], v[84:87]
v_mfma_f32_16x16x32_bf16 v[88:91], v[40:43], v[168:171], v[88:91]
v_mfma_f32_16x16x32_bf16 v[92:95], v[44:47], v[168:171], v[92:95]
buffer_load_dwordx4 v[168:171], v68, s[48:51], s98 offen sc1
s_waitcnt vmcnt(28)
s_waitcnt lgkmcnt(0)
ds_read_b64_tr_b16 v[32:33], v75 offset:8192
ds_read_b64_tr_b16 v[34:35], v75 offset:9216
ds_read_b64_tr_b16 v[36:37], v76 offset:8192
ds_read_b64_tr_b16 v[38:39], v76 offset:9216
ds_read_b64_tr_b16 v[40:41], v77 offset:8192
ds_read_b64_tr_b16 v[42:43], v77 offset:9216
ds_read_b64_tr_b16 v[44:45], v78 offset:8192
ds_read_b64_tr_b16 v[46:47], v78 offset:9216
v_mfma_f32_16x16x32_bf16 v[192:195], v[48:51], v[172:175], v[192:195]
s_add_u32 m0, s97, 4096
s_add_u32 s99, s96, 0x129000
buffer_load_dwordx4 v69, s[44:47], s99 offen offset:0 lds
v_mfma_f32_16x16x32_bf16 v[196:199], v[52:55], v[172:175], v[196:199]
v_mfma_f32_16x16x32_bf16 v[200:203], v[56:59], v[172:175], v[200:203]
v_mfma_f32_16x16x32_bf16 v[204:207], v[60:63], v[172:175], v[204:207]
s_add_u32 s98, s95, 0x8000
buffer_load_dwordx4 v[172:175], v64, s[48:51], s98 offen sc1
v_mfma_f32_16x16x32_bf16 v[208:211], v[48:51], v[176:179], v[208:211]
buffer_load_dwordx4 v70, s[44:47], s99 offen offset:1024 lds
v_mfma_f32_16x16x32_bf16 v[212:215], v[52:55], v[176:179], v[212:215]
v_mfma_f32_16x16x32_bf16 v[216:219], v[56:59], v[176:179], v[216:219]
v_mfma_f32_16x16x32_bf16 v[220:223], v[60:63], v[176:179], v[220:223]
buffer_load_dwordx4 v[176:179], v65, s[48:51], s98 offen sc1
v_mfma_f32_16x16x32_bf16 v[224:227], v[48:51], v[180:183], v[224:227]
buffer_load_dwordx4 v71, s[44:47], s99 offen offset:2048 lds
v_mfma_f32_16x16x32_bf16 v[228:231], v[52:55], v[180:183], v[228:231]
v_mfma_f32_16x16x32_bf16 v[232:235], v[56:59], v[180:183], v[232:235]
v_mfma_f32_16x16x32_bf16 v[236:239], v[60:63], v[180:183], v[236:239]
buffer_load_dwordx4 v[180:183], v66, s[48:51], s98 offen sc1
v_mfma_f32_16x16x32_bf16 v[240:243], v[48:51], v[184:187], v[240:243]
buffer_load_dwordx4 v72, s[44:47], s99 offen offset:3072 lds
v_mfma_f32_16x16x32_bf16 v[244:247], v[52:55], v[184:187], v[244:247]
v_mfma_f32_16x16x32_bf16 v[248:251], v[56:59], v[184:187], v[248:251]
v_mfma_f32_16x16x32_bf16 v[252:255], v[60:63], v[184:187], v[252:255]
buffer_load_dwordx4 v[184:187], v67, s[48:51], s98 offen sc1
v_mfma_f32_16x16x32_bf16 v[80:83], v[48:51], v[188:191], v[80:83]
v_mfma_f32_16x16x32_bf16 v[84:87], v[52:55], v[188:191], v[84:87]
v_mfma_f32_16x16x32_bf16 v[88:91], v[56:59], v[188:191], v[88:91]
v_mfma_f32_16x16x32_bf16 v[92:95], v[60:63], v[188:191], v[92:95]
buffer_load_dwordx4 v[188:191], v68, s[48:51], s98 offen sc1
s_waitcnt vmcnt(28)
s_waitcnt lgkmcnt(0)
ds_read_b64_tr_b16 v[48:49], v75 offset:12288
ds_read_b64_tr_b16 v[50:51], v75 offset:13312
ds_read_b64_tr_b16 v[52:53], v76 offset:12288
ds_read_b64_tr_b16 v[54:55], v76 offset:13312
ds_read_b64_tr_b16 v[56:57], v77 offset:12288
ds_read_b64_tr_b16 v[58:59], v77 offset:13312
ds_read_b64_tr_b16 v[60:61], v78 offset:12288
ds_read_b64_tr_b16 v[62:63], v78 offset:13312
v_mfma_f32_16x16x32_bf16 v[192:195], v[32:35], v[112:115], v[192:195]
s_add_u32 m0, s97, 8192
s_add_u32 s99, s96, 0x36000
buffer_load_dwordx4 v69, s[44:47], s99 offen offset:0 lds
v_mfma_f32_16x16x32_bf16 v[196:199], v[36:39], v[112:115], v[196:199]
v_mfma_f32_16x16x32_bf16 v[200:203], v[40:43], v[112:115], v[200:203]
v_mfma_f32_16x16x32_bf16 v[204:207], v[44:47], v[112:115], v[204:207]
s_add_u32 s98, s95, 0x8400
buffer_load_dwordx4 v[112:115], v64, s[48:51], s98 offen sc1
v_mfma_f32_16x16x32_bf16 v[208:211], v[32:35], v[116:119], v[208:211]
buffer_load_dwordx4 v70, s[44:47], s99 offen offset:1024 lds
v_mfma_f32_16x16x32_bf16 v[212:215], v[36:39], v[116:119], v[212:215]
v_mfma_f32_16x16x32_bf16 v[216:219], v[40:43], v[116:119], v[216:219]
v_mfma_f32_16x16x32_bf16 v[220:223], v[44:47], v[116:119], v[220:223]
buffer_load_dwordx4 v[116:119], v65, s[48:51], s98 offen sc1
v_mfma_f32_16x16x32_bf16 v[224:227], v[32:35], v[120:123], v[224:227]
buffer_load_dwordx4 v71, s[44:47], s99 offen offset:2048 lds
v_mfma_f32_16x16x32_bf16 v[228:231], v[36:39], v[120:123], v[228:231]
v_mfma_f32_16x16x32_bf16 v[232:235], v[40:43], v[120:123], v[232:235]
v_mfma_f32_16x16x32_bf16 v[236:239], v[44:47], v[120:123], v[236:239]
buffer_load_dwordx4 v[120:123], v66, s[48:51], s98 offen sc1
v_mfma_f32_16x16x32_bf16 v[240:243], v[32:35], v[124:127], v[240:243]
buffer_load_dwordx4 v72, s[44:47], s99 offen offset:3072 lds
v_mfma_f32_16x16x32_bf16 v[244:247], v[36:39], v[124:127], v[244:247]
v_mfma_f32_16x16x32_bf16 v[248:251], v[40:43], v[124:127], v[248:251]
v_mfma_f32_16x16x32_bf16 v[252:255], v[44:47], v[124:127], v[252:255]
buffer_load_dwordx4 v[124:127], v67, s[48:51], s98 offen sc1
v_mfma_f32_16x16x32_bf16 v[80:83], v[32:35], v[128:131], v[80:83]
v_mfma_f32_16x16x32_bf16 v[84:87], v[36:39], v[128:131], v[84:87]
v_mfma_f32_16x16x32_bf16 v[88:91], v[40:43], v[128:131], v[88:91]
v_mfma_f32_16x16x32_bf16 v[92:95], v[44:47], v[128:131], v[92:95]
buffer_load_dwordx4 v[128:131], v68, s[48:51], s98 offen sc1
s_waitcnt vmcnt(27)
v_cmp_ne_u32 vcc, s100, v31
s_nop 1
s_cbranch_vccz Lok17
s_mov_b32 s83, 20000
Llp18:
buffer_load_dword v31, v28, s[84:87], 0 offen offset:2048 sc1
s_sub_u32 s83, s83, 1
s_cbranch_scc1 Lok17
s_waitcnt vmcnt(0)
v_cmp_ne_u32 vcc, s100, v31
s_nop 1
s_cbranch_vccnz Llp18
Lok17:
s_waitcnt lgkmcnt(0)
ds_read_b64_tr_b16 v[32:33], v75 offset:16384
ds_read_b64_tr_b16 v[34:35], v75 offset:17408
ds_read_b64_tr_b16 v[36:37], v76 offset:16384
ds_read_b64_tr_b16 v[38:39], v76 offset:17408
ds_read_b64_tr_b16 v[40:41], v77 offset:16384
ds_read_b64_tr_b16 v[42:43], v77 offset:17408
ds_read_b64_tr_b16 v[44:45], v78 offset:16384
ds_read_b64_tr_b16 v[46:47], v78 offset:17408
v_mfma_f32_16x16x32_bf16 v[192:195], v[48:51], v[132:135], v[192:195]
s_add_u32 m0, s97, 12288
s_add_u32 s99, s96, 0x3f000
buffer_load_dwordx4 v69, s[44:47], s99 offen offset:0 lds
v_mfma_f32_16x16x32_bf16 v[196:199], v[52:55], v[132:135], v[196:199]
v_mfma_f32_16x16x32_bf16 v[200:203], v[56:59], v[132:135], v[200:203]
v_mfma_f32_16x16x32_bf16 v[204:207], v[60:63], v[132:135], v[204:207]
s_add_u32 s98, s95, 0x1800
buffer_load_dwordx4 v[132:135], v64, s[48:51], s98 offen sc1
v_mfma_f32_16x16x32_bf16 v[208:211], v[48:51], v[136:139], v[208:211]
buffer_load_dwordx4 v70, s[44:47], s99 offen offset:1024 lds
v_mfma_f32_16x16x32_bf16 v[212:215], v[52:55], v[136:139], v[212:215]
v_mfma_f32_16x16x32_bf16 v[216:219], v[56:59], v[136:139], v[216:219]
v_mfma_f32_16x16x32_bf16 v[220:223], v[60:63], v[136:139], v[220:223]
buffer_load_dwordx4 v[136:139], v65, s[48:51], s98 offen sc1
v_mfma_f32_16x16x32_bf16 v[224:227], v[48:51], v[140:143], v[224:227]
buffer_load_dwordx4 v71, s[44:47], s99 offen offset:2048 lds
v_mfma_f32_16x16x32_bf16 v[228:231], v[52:55], v[140:143], v[228:231]
v_mfma_f32_16x16x32_bf16 v[232:235], v[56:59], v[140:143], v[232:235]
v_mfma_f32_16x16x32_bf16 v[236:239], v[60:63], v[140:143], v[236:239]
buffer_load_dwordx4 v[140:143], v66, s[48:51], s98 offen sc1
v_mfma_f32_16x16x32_bf16 v[240:243], v[48:51], v[144:147], v[240:243]
buffer_load_dwordx4 v72, s[44:47], s99 offen offset:3072 lds
v_mfma_f32_16x16x32_bf16 v[244:247], v[52:55], v[144:147], v[244:247]
v_mfma_f32_16x16x32_bf16 v[248:251], v[56:59], v[144:147], v[248:251]
v_mfma_f32_16x16x32_bf16 v[252:255], v[60:63], v[144:147], v[252:255]
buffer_load_dwordx4 v[144:147], v67, s[48:51], s98 offen sc1
v_mfma_f32_16x16x32_bf16 v[80:83], v[48:51], v[148:151], v[80:83]
v_mfma_f32_16x16x32_bf16 v[84:87], v[52:55], v[148:151], v[84:87]
v_mfma_f32_16x16x32_bf16 v[88:91], v[56:59], v[148:151], v[88:91]
v_mfma_f32_16x16x32_bf16 v[92:95], v[60:63], v[148:151], v[92:95]
buffer_load_dwordx4 v[148:151], v68, s[48:51], s98 offen sc1
s_waitcnt vmcnt(27)
s_waitcnt lgkmcnt(0)
ds_read_b64_tr_b16 v[48:49], v75 offset:0
ds_read_b64_tr_b16 v[50:51], v75 offset:1024
ds_read_b64_tr_b16 v[52:53], v76 offset:0
ds_read_b64_tr_b16 v[54:55], v76 offset:1024
ds_read_b64_tr_b16 v[56:57], v77 offset:0
ds_read_b64_tr_b16 v[58:59], v77 offset:1024
ds_read_b64_tr_b16 v[60:61], v78 offset:0
ds_read_b64_tr_b16 v[62:63], v78 offset:1024
v_mfma_f32_16x16x32_bf16 v[192:195], v[32:35], v[152:155], v[192:195]
s_add_u32 m0, s97, 16384
s_add_u32 s99, s96, 0x90000
buffer_load_dwordx4 v69, s[44:47], s99 offen offset:0 lds
v_mfma_f32_16x16x32_bf16 v[196:199], v[36:39], v[152:155], v[196:199]
v_mfma_f32_16x16x32_bf16 v[200:203], v[40:43], v[152:155], v[200:203]
v_mfma_f32_16x16x32_bf16 v[204:207], v[44:47], v[152:155], v[204:207]
s_add_u32 s98, s95, 0x1c00
buffer_load_dwordx4 v[152:155], v64, s[48:51], s98 offen sc1
v_mfma_f32_16x16x32_bf16 v[208:211], v[32:35], v[156:159], v[208:211]
buffer_load_dwordx4 v70, s[44:47], s99 offen offset:1024 lds
v_mfma_f32_16x16x32_bf16 v[212:215], v[36:39], v[156:159], v[212:215]
v_mfma_f32_16x16x32_bf16 v[216:219], v[40:43], v[156:159], v[216:219]
v_mfma_f32_16x16x32_bf16 v[220:223], v[44:47], v[156:159], v[220:223]
buffer_load_dwordx4 v[156:159], v65, s[48:51], s98 offen sc1
v_mfma_f32_16x16x32_bf16 v[224:227], v[32:35], v[160:163], v[224:227]
buffer_load_dwordx4 v71, s[44:47], s99 offen offset:2048 lds
v_mfma_f32_16x16x32_bf16 v[228:231], v[36:39], v[160:163], v[228:231]
v_mfma_f32_16x16x32_bf16 v[232:235], v[40:43], v[160:163], v[232:235]
v_mfma_f32_16x16x32_bf16 v[236:239], v[44:47], v[160:163], v[236:239]
buffer_load_dwordx4 v[160:163], v66, s[48:51], s98 offen sc1
v_mfma_f32_16x16x32_bf16 v[240:243], v[32:35], v[164:167], v[240:243]
buffer_load_dwordx4 v72, s[44:47], s99 offen offset:3072 lds
v_mfma_f32_16x16x32_bf16 v[244:247], v[36:39], v[164:167], v[244:247]
v_mfma_f32_16x16x32_bf16 v[248:251], v[40:43], v[164:167], v[248:251]
v_mfma_f32_16x16x32_bf16 v[252:255], v[44:47], v[164:167], v[252:255]
buffer_load_dwordx4 v[164:167], v67, s[48:51], s98 offen sc1
v_mfma_f32_16x16x32_bf16 v[80:83], v[32:35], v[168:171], v[80:83]
v_mfma_f32_16x16x32_bf16 v[84:87], v[36:39], v[168:171], v[84:87]
v_mfma_f32_16x16x32_bf16 v[88:91], v[40:43], v[168:171], v[88:91]
v_mfma_f32_16x16x32_bf16 v[92:95], v[44:47], v[168:171], v[92:95]
buffer_load_dwordx4 v[168:171], v68, s[48:51], s98 offen sc1
s_waitcnt vmcnt(27)
s_waitcnt lgkmcnt(0)
ds_read_b64_tr_b16 v[32:33], v75 offset:4096
ds_read_b64_tr_b16 v[34:35], v75 offset:5120
ds_read_b64_tr_b16 v[36:37], v76 offset:4096
ds_read_b64_tr_b16 v[38:39], v76 offset:5120
ds_read_b64_tr_b16 v[40:41], v77 offset:4096
ds_read_b64_tr_b16 v[42:43], v77 offset:5120
ds_read_b64_tr_b16 v[44:45], v78 offset:4096
ds_read_b64_tr_b16 v[46:47], v78 offset:5120
v_mfma_f32_16x16x32_bf16 v[192:195], v[48:51], v[172:175], v[192:195]
s_add_u32 m0, s97, 0
s_add_u32 s99, s96, 0x99000
buffer_load_dwordx4 v69, s[44:47], s99 offen offset:0 lds
v_mfma_f32_16x16x32_bf16 v[196:199], v[52:55], v[172:175], v[196:199]
v_mfma_f32_16x16x32_bf16 v[200:203], v[56:59], v[172:175], v[200:203]
v_mfma_f32_16x16x32_bf16 v[204:207], v[60:63], v[172:175], v[204:207]
s_add_u32 s98, s95, 0x4000
buffer_load_dwordx4 v[172:175], v64, s[48:51], s98 offen sc1
v_mfma_f32_16x16x32_bf16 v[208:211], v[48:51], v[176:179], v[208:211]
buffer_load_dwordx4 v70, s[44:47], s99 offen offset:1024 lds
v_mfma_f32_16x16x32_bf16 v[212:215], v[52:55], v[176:179], v[212:215]
v_mfma_f32_16x16x32_bf16 v[216:219], v[56:59], v[176:179], v[216:219]
v_mfma_f32_16x16x32_bf16 v[220:223], v[60:63], v[176:179], v[220:223]
buffer_load_dwordx4 v[176:179], v65, s[48:51], s98 offen sc1
v_mfma_f32_16x16x32_bf16 v[224:227], v[48:51], v[180:183], v[224:227]
buffer_load_dwordx4 v71, s[44:47], s99 offen offset:2048 lds
v_mfma_f32_16x16x32_bf16 v[228:231], v[52:55], v[180:183], v[228:231]
v_mfma_f32_16x16x32_bf16 v[232:235], v[56:59], v[180:183], v[232:235]
v_mfma_f32_16x16x32_bf16 v[236:239], v[60:63], v[180:183], v[236:239]
buffer_load_dwordx4 v[180:183], v66, s[48:51], s98 offen sc1
v_mfma_f32_16x16x32_bf16 v[240:243], v[48:51], v[184:187], v[240:243]
buffer_load_dwordx4 v72, s[44:47], s99 offen offset:3072 lds
v_mfma_f32_16x16x32_bf16 v[244:247], v[52:55], v[184:187], v[244:247]
v_mfma_f32_16x16x32_bf16 v[248:251], v[56:59], v[184:187], v[248:251]
v_mfma_f32_16x16x32_bf16 v[252:255], v[60:63], v[184:187], v[252:255]
buffer_load_dwordx4 v[184:187], v67, s[48:51], s98 offen sc1
v_mfma_f32_16x16x32_bf16 v[80:83], v[48:51], v[188:191], v[80:83]
v_mfma_f32_16x16x32_bf16 v[84:87], v[52:55], v[188:191], v[84:87]
v_mfma_f32_16x16x32_bf16 v[88:91], v[56:59], v[188:191], v[88:91]
v_mfma_f32_16x16x32_bf16 v[92:95], v[60:63], v[188:191], v[92:95]
buffer_load_dwordx4 v[188:191], v68, s[48:51], s98 offen sc1
s_waitcnt vmcnt(27)
s_waitcnt lgkmcnt(0)
ds_read_b64_tr_b16 v[48:49], v75 offset:8192
ds_read_b64_tr_b16 v[50:51], v75 offset:9216
ds_read_b64_tr_b16 v[52:53], v76 offset:8192
ds_read_b64_tr_b16 v[54:55], v76 offset:9216
ds_read_b64_tr_b16 v[56:57], v77 offset:8192
ds_read_b64_tr_b16 v[58:59], v77 offset:9216
ds_read_b64_tr_b16 v[60:61], v78 offset:8192
ds_read_b64_tr_b16 v[62:63], v78 offset:9216
v_mfma_f32_16x16x32_bf16 v[192:195], v[32:35], v[112:115], v[192:195]
s_add_u32 m0, s97, 4096
s_add_u32 s99, s96, 0xd8000
buffer_load_dwordx4 v69, s[44:47], s99 offen offset:0 lds
v_mfma_f32_16x16x32_bf16 v[196:199], v[36:39], v[112:115], v[196:199]
v_mfma_f32_16x16x32_bf16 v[200:203], v[40:43], v[112:115], v[200:203]
v_mfma_f32_16x16x32_bf16 v[204:207], v[44:47], v[112:115], v[204:207]
s_add_u32 s98, s95, 0x4400
buffer_load_dwordx4 v[112:115], v64, s[48:51], s98 offen sc1
v_mfma_f32_16x16x32_bf16 v[208:211], v[32:35], v[116:119], v[208:211]
buffer_load_dwordx4 v70, s[44:47], s99 offen offset:1024 lds
v_mfma_f32_16x16x32_bf16 v[212:215], v[36:39], v[116:119], v[212:215]
v_mfma_f32_16x16x32_bf16 v[216:219], v[40:43], v[116:119], v[216:219]
v_mfma_f32_16x16x32_bf16 v[220:223], v[44:47], v[116:119], v[220:223]
buffer_load_dwordx4 v[116:119], v65, s[48:51], s98 offen sc1
v_mfma_f32_16x16x32_bf16 v[224:227], v[32:35], v[120:123], v[224:227]
buffer_load_dwordx4 v71, s[44:47], s99 offen offset:2048 lds
v_mfma_f32_16x16x32_bf16 v[228:231], v[36:39], v[120:123], v[228:231]
v_mfma_f32_16x16x32_bf16 v[232:235], v[40:43], v[120:123], v[232:235]
v_mfma_f32_16x16x32_bf16 v[236:239], v[44:47], v[120:123], v[236:239]
buffer_load_dwordx4 v[120:123], v66, s[48:51], s98 offen sc1
v_mfma_f32_16x16x32_bf16 v[240:243], v[32:35], v[124:127], v[240:243]
buffer_load_dwordx4 v72, s[44:47], s99 offen offset:3072 lds
v_mfma_f32_16x16x32_bf16 v[244:247], v[36:39], v[124:127], v[244:247]
v_mfma_f32_16x16x32_bf16 v[248:251], v[40:43], v[124:127], v[248:251]
v_mfma_f32_16x16x32_bf16 v[252:255], v[44:47], v[124:127], v[252:255]
buffer_load_dwordx4 v[124:127], v67, s[48:51], s98 offen sc1
v_mfma_f32_16x16x32_bf16 v[80:83], v[32:35], v[128:131], v[80:83]
v_mfma_f32_16x16x32_bf16 v[84:87], v[36:39], v[128:131], v[84:87]
v_mfma_f32_16x16x32_bf16 v[88:91], v[40:43], v[128:131], v[88:91]
v_mfma_f32_16x16x32_bf16 v[92:95], v[44:47], v[128:131], v[92:95]
buffer_load_dwordx4 v[128:131], v68, s[48:51], s98 offen sc1
s_waitcnt vmcnt(27)
s_waitcnt lgkmcnt(0)
ds_read_b64_tr_b16 v[32:33], v75 offset:12288
ds_read_b64_tr_b16 v[34:35], v75 offset:13312
ds_read_b64_tr_b16 v[36:37], v76 offset:12288
ds_read_b64_tr_b16 v[38:39], v76 offset:13312
ds_read_b64_tr_b16 v[40:41], v77 offset:12288
ds_read_b64_tr_b16 v[42:43], v77 offset:13312
ds_read_b64_tr_b16 v[44:45], v78 offset:12288
ds_read_b64_tr_b16 v[46:47], v78 offset:13312
v_mfma_f32_16x16x32_bf16 v[192:195], v[48:51], v[132:135], v[192:195]
s_add_u32 m0, s97, 8192
s_add_u32 s99, s96, 0xe1000
buffer_load_dwordx4 v69, s[44:47], s99 offen offset:0 lds
v_mfma_f32_16x16x32_bf16 v[196:199], v[52:55], v[132:135], v[196:199]
v_mfma_f32_16x16x32_bf16 v[200:203], v[56:59], v[132:135], v[200:203]
v_mfma_f32_16x16x32_bf16 v[204:207], v[60:63], v[132:135], v[204:207]
s_add_u32 s98, s95, 0x6000
buffer_load_dwordx4 v[132:135], v64, s[48:51], s98 offen sc1
v_mfma_f32_16x16x32_bf16 v[208:211], v[48:51], v[136:139], v[208:211]
buffer_load_dwordx4 v70, s[44:47], s99 offen offset:1024 lds
v_mfma_f32_16x16x32_bf16 v[212:215], v[52:55], v[136:139], v[212:215]
v_mfma_f32_16x16x32_bf16 v[216:219], v[56:59], v[136:139], v[216:219]
v_mfma_f32_16x16x32_bf16 v[220:223], v[60:63], v[136:139], v[220:223]
buffer_load_dwordx4 v[136:139], v65, s[48:51], s98 offen sc1
v_mfma_f32_16x16x32_bf16 v[224:227], v[48:51], v[140:143], v[224:227]
buffer_load_dwordx4 v71, s[44:47], s99 offen offset:2048 lds
v_mfma_f32_16x16x32_bf16 v[228:231], v[52:55], v[140:143], v[228:231]
v_mfma_f32_16x16x32_bf16 v[232:235], v[56:59], v[140:143], v[232:235]
v_mfma_f32_16x16x32_bf16 v[236:239], v[60:63], v[140:143], v[236:239]
buffer_load_dwordx4 v[140:143], v66, s[48:51], s98 offen sc1
v_mfma_f32_16x16x32_bf16 v[240:243], v[48:51], v[144:147], v[240:243]
buffer_load_dwordx4 v72, s[44:47], s99 offen offset:3072 lds
v_mfma_f32_16x16x32_bf16 v[244:247], v[52:55], v[144:147], v[244:247]
v_mfma_f32_16x16x32_bf16 v[248:251], v[56:59], v[144:147], v[248:251]
v_mfma_f32_16x16x32_bf16 v[252:255], v[60:63], v[144:147], v[252:255]
buffer_load_dwordx4 v[144:147], v67, s[48:51], s98 offen sc1
v_mfma_f32_16x16x32_bf16 v[80:83], v[48:51], v[148:151], v[80:83]
v_mfma_f32_16x16x32_bf16 v[84:87], v[52:55], v[148:151], v[84:87]
v_mfma_f32_16x16x32_bf16 v[88:91], v[56:59], v[148:151], v[88:91]
v_mfma_f32_16x16x32_bf16 v[92:95], v[60:63], v[148:151], v[92:95]
buffer_load_dwordx4 v[148:151], v68, s[48:51], s98 offen sc1
s_waitcnt vmcnt(27)
s_waitcnt lgkmcnt(0)
ds_read_b64_tr_b16 v[48:49], v75 offset:16384
ds_read_b64_tr_b16 v[50:51], v75 offset:17408
ds_read_b64_tr_b16 v[52:53], v76 offset:16384
ds_read_b64_tr_b16 v[54:55], v76 offset:17408
ds_read_b64_tr_b16 v[56:57], v77 offset:16384
ds_read_b64_tr_b16 v[58:59], v77 offset:17408
ds_read_b64_tr_b16 v[60:61], v78 offset:16384
ds_read_b64_tr_b16 v[62:63], v78 offset:17408
v_mfma_f32_16x16x32_bf16 v[192:195], v[32:35], v[152:155], v[192:195]
s_add_u32 m0, s97, 12288
s_add_u32 s99, s96, 0x132000
buffer_load_dwordx4 v69, s[44:47], s99 offen offset:0 lds
v_mfma_f32_16x16x32_bf16 v[196:199], v[36:39], v[152:155], v[196:199]
v_mfma_f32_16x16x32_bf16 v[200:203], v[40:43], v[152:155], v[200:203]
v_mfma_f32_16x16x32_bf16 v[204:207], v[44:47], v[152:155], v[204:207]
s_add_u32 s98, s95, 0x6400
buffer_load_dwordx4 v[152:155], v64, s[48:51], s98 offen sc1
v_mfma_f32_16x16x32_bf16 v[208:211], v[32:35], v[156:159], v[208:211]
buffer_load_dwordx4 v70, s[44:47], s99 offen offset:1024 lds
v_mfma_f32_16x16x32_bf16 v[212:215], v[36:39], v[156:159], v[212:215]
v_mfma_f32_16x16x32_bf16 v[216:219], v[40:43], v[156:159], v[216:219]
v_mfma_f32_16x16x32_bf16 v[220:223], v[44:47], v[156:159], v[220:223]
buffer_load_dwordx4 v[156:159], v65, s[48:51], s98 offen sc1
v_mfma_f32_16x16x32_bf16 v[224:227], v[32:35], v[160:163], v[224:227]
buffer_load_dwordx4 v71, s[44:47], s99 offen offset:2048 lds
v_mfma_f32_16x16x32_bf16 v[228:231], v[36:39], v[160:163], v[228:231]
v_mfma_f32_16x16x32_bf16 v[232:235], v[40:43], v[160:163], v[232:235]
v_mfma_f32_16x16x32_bf16 v[236:239], v[44:47], v[160:163], v[236:239]
buffer_load_dwordx4 v[160:163], v66, s[48:51], s98 offen sc1
v_mfma_f32_16x16x32_bf16 v[240:243], v[32:35], v[164:167], v[240:243]
buffer_load_dwordx4 v72, s[44:47], s99 offen offset:3072 lds
v_mfma_f32_16x16x32_bf16 v[244:247], v[36:39], v[164:167], v[244:247]
v_mfma_f32_16x16x32_bf16 v[248:251], v[40:43], v[164:167], v[248:251]
v_mfma_f32_16x16x32_bf16 v[252:255], v[44:47], v[164:167], v[252:255]
buffer_load_dwordx4 v[164:167], v67, s[48:51], s98 offen sc1
v_mfma_f32_16x16x32_bf16 v[80:83], v[32:35], v[168:171], v[80:83]
v_mfma_f32_16x16x32_bf16 v[84:87], v[36:39], v[168:171], v[84:87]
v_mfma_f32_16x16x32_bf16 v[88:91], v[40:43], v[168:171], v[88:91]
v_mfma_f32_16x16x32_bf16 v[92:95], v[44:47], v[168:171], v[92:95]
buffer_load_dwordx4 v[168:171], v68, s[48:51], s98 offen sc1
s_waitcnt vmcnt(27)
s_waitcnt lgkmcnt(0)
ds_read_b64_tr_b16 v[32:33], v75 offset:0
ds_read_b64_tr_b16 v[34:35], v75 offset:1024
ds_read_b64_tr_b16 v[36:37], v76 offset:0
ds_read_b64_tr_b16 v[38:39], v76 offset:1024
ds_read_b64_tr_b16 v[40:41], v77 offset:0
ds_read_b64_tr_b16 v[42:43], v77 offset:1024
ds_read_b64_tr_b16 v[44:45], v78 offset:0
ds_read_b64_tr_b16 v[46:47], v78 offset:1024
v_mfma_f32_16x16x32_bf16 v[192:195], v[48:51], v[172:175], v[192:195]
s_add_u32 m0, s97, 16384
s_add_u32 s99, s96, 0x13b000
buffer_load_dwordx4 v69, s[44:47], s99 offen offset:0 lds
v_mfma_f32_16x16x32_bf16 v[196:199], v[52:55], v[172:175], v[196:199]
v_mfma_f32_16x16x32_bf16 v[200:203], v[56:59], v[172:175], v[200:203]
v_mfma_f32_16x16x32_bf16 v[204:207], v[60:63], v[172:175], v[204:207]
s_add_u32 s98, s95, 0x8800
buffer_load_dwordx4 v[172:175], v64, s[48:51], s98 offen sc1
v_mfma_f32_16x16x32_bf16 v[208:211], v[48:51], v[176:179], v[208:211]
buffer_load_dwordx4 v70, s[44:47], s99 offen offset:1024 lds
v_mfma_f32_16x16x32_bf16 v[212:215], v[52:55], v[176:179], v[212:215]
v_mfma_f32_16x16x32_bf16 v[216:219], v[56:59], v[176:179], v[216:219]
v_mfma_f32_16x16x32_bf16 v[220:223], v[60:63], v[176:179], v[220:223]
buffer_load_dwordx4 v[176:179], v65, s[48:51], s98 offen sc1
v_mfma_f32_16x16x32_bf16 v[224:227], v[48:51], v[180:183], v[224:227]
buffer_load_dwordx4 v71, s[44:47], s99 offen offset:2048 lds
v_mfma_f32_16x16x32_bf16 v[228:231], v[52:55], v[180:183], v[228:231]
v_mfma_f32_16x16x32_bf16 v[232:235], v[56:59], v[180:183], v[232:235]
v_mfma_f32_16x16x32_bf16 v[236:239], v[60:63], v[180:183], v[236:239]
buffer_load_dwordx4 v[180:183], v66, s[48:51], s98 offen sc1
v_mfma_f32_16x16x32_bf16 v[240:243], v[48:51], v[184:187], v[240:243]
buffer_load_dwordx4 v72, s[44:47], s99 offen offset:3072 lds
v_mfma_f32_16x16x32_bf16 v[244:247], v[52:55], v[184:187], v[244:247]
v_mfma_f32_16x16x32_bf16 v[248:251], v[56:59], v[184:187], v[248:251]
v_mfma_f32_16x16x32_bf16 v[252:255], v[60:63], v[184:187], v[252:255]
buffer_load_dwordx4 v[184:187], v67, s[48:51], s98 offen sc1
v_mfma_f32_16x16x32_bf16 v[80:83], v[48:51], v[188:191], v[80:83]
v_mfma_f32_16x16x32_bf16 v[84:87], v[52:55], v[188:191], v[84:87]
v_mfma_f32_16x16x32_bf16 v[88:91], v[56:59], v[188:191], v[88:91]
v_mfma_f32_16x16x32_bf16 v[92:95], v[60:63], v[188:191], v[92:95]
buffer_load_dwordx4 v[188:191], v68, s[48:51], s98 offen sc1
s_waitcnt vmcnt(27)
s_waitcnt lgkmcnt(0)
ds_read_b64_tr_b16 v[48:49], v75 offset:4096
ds_read_b64_tr_b16 v[50:51], v75 offset:5120
ds_read_b64_tr_b16 v[52:53], v76 offset:4096
ds_read_b64_tr_b16 v[54:55], v76 offset:5120
ds_read_b64_tr_b16 v[56:57], v77 offset:4096
ds_read_b64_tr_b16 v[58:59], v77 offset:5120
ds_read_b64_tr_b16 v[60:61], v78 offset:4096
ds_read_b64_tr_b16 v[62:63], v78 offset:5120
v_mfma_f32_16x16x32_bf16 v[192:195], v[32:35], v[112:115], v[192:195]
s_add_u32 m0, s97, 0
s_add_u32 s99, s96, 0x48000
buffer_load_dwordx4 v69, s[44:47], s99 offen offset:0 lds
v_mfma_f32_16x16x32_bf16 v[196:199], v[36:39], v[112:115], v[196:199]
v_mfma_f32_16x16x32_bf16 v[200:203], v[40:43], v[112:115], v[200:203]
v_mfma_f32_16x16x32_bf16 v[204:207], v[44:47], v[112:115], v[204:207]
s_add_u32 s98, s95, 0x8c00
buffer_load_dwordx4 v[112:115], v64, s[48:51], s98 offen sc1
v_mfma_f32_16x16x32_bf16 v[208:211], v[32:35], v[116:119], v[208:211]
buffer_load_dwordx4 v70, s[44:47], s99 offen offset:1024 lds
v_mfma_f32_16x16x32_bf16 v[212:215], v[36:39], v[116:119], v[212:215]
v_mfma_f32_16x16x32_bf16 v[216:219], v[40:43], v[116:119], v[216:219]
v_mfma_f32_16x16x32_bf16 v[220:223], v[44:47], v[116:119], v[220:223]
buffer_load_dwordx4 v[116:119], v65, s[48:51], s98 offen sc1
v_mfma_f32_16x16x32_bf16 v[224:227], v[32:35], v[120:123], v[224:227]
buffer_load_dwordx4 v71, s[44:47], s99 offen offset:2048 lds
v_mfma_f32_16x16x32_bf16 v[228:231], v[36:39], v[120:123], v[228:231]
v_mfma_f32_16x16x32_bf16 v[232:235], v[40:43], v[120:123], v[232:235]
v_mfma_f32_16x16x32_bf16 v[236:239], v[44:47], v[120:123], v[236:239]
buffer_load_dwordx4 v[120:123], v66, s[48:51], s98 offen sc1
v_mfma_f32_16x16x32_bf16 v[240:243], v[32:35], v[124:127], v[240:243]
buffer_load_dwordx4 v72, s[44:47], s99 offen offset:3072 lds
v_mfma_f32_16x16x32_bf16 v[244:247], v[36:39], v[124:127], v[244:247]
v_mfma_f32_16x16x32_bf16 v[248:251], v[40:43], v[124:127], v[248:251]
v_mfma_f32_16x16x32_bf16 v[252:255], v[44:47], v[124:127], v[252:255]
buffer_load_dwordx4 v[124:127], v67, s[48:51], s98 offen sc1
v_mfma_f32_16x16x32_bf16 v[80:83], v[32:35], v[128:131], v[80:83]
v_mfma_f32_16x16x32_bf16 v[84:87], v[36:39], v[128:131], v[84:87]
v_mfma_f32_16x16x32_bf16 v[88:91], v[40:43], v[128:131], v[88:91]
v_mfma_f32_16x16x32_bf16 v[92:95], v[44:47], v[128:131], v[92:95]
buffer_load_dwordx4 v[128:131], v68, s[48:51], s98 offen sc1
s_waitcnt vmcnt(27)
s_waitcnt lgkmcnt(0)
ds_read_b64_tr_b16 v[32:33], v75 offset:8192
ds_read_b64_tr_b16 v[34:35], v75 offset:9216
ds_read_b64_tr_b16 v[36:37], v76 offset:8192
ds_read_b64_tr_b16 v[38:39], v76 offset:9216
ds_read_b64_tr_b16 v[40:41], v77 offset:8192
ds_read_b64_tr_b16 v[42:43], v77 offset:9216
ds_read_b64_tr_b16 v[44:45], v78 offset:8192
ds_read_b64_tr_b16 v[46:47], v78 offset:9216
v_mfma_f32_16x16x32_bf16 v[192:195], v[48:51], v[132:135], v[192:195]
s_add_u32 m0, s97, 4096
s_add_u32 s99, s96, 0x51000
buffer_load_dwordx4 v69, s[44:47], s99 offen offset:0 lds
v_mfma_f32_16x16x32_bf16 v[196:199], v[52:55], v[132:135], v[196:199]
v_mfma_f32_16x16x32_bf16 v[200:203], v[56:59], v[132:135], v[200:203]
v_mfma_f32_16x16x32_bf16 v[204:207], v[60:63], v[132:135], v[204:207]
s_add_u32 s98, s95, 0x2000
buffer_load_dwordx4 v[132:135], v64, s[48:51], s98 offen sc1
v_mfma_f32_16x16x32_bf16 v[208:211], v[48:51], v[136:139], v[208:211]
buffer_load_dwordx4 v70, s[44:47], s99 offen offset:1024 lds
v_mfma_f32_16x16x32_bf16 v[212:215], v[52:55], v[136:139], v[212:215]
v_mfma_f32_16x16x32_bf16 v[216:219], v[56:59], v[136:139], v[216:219]
v_mfma_f32_16x16x32_bf16 v[220:223], v[60:63], v[136:139], v[220:223]
buffer_load_dwordx4 v[136:139], v65, s[48:51], s98 offen sc1
v_mfma_f32_16x16x32_bf16 v[224:227], v[48:51], v[140:143], v[224:227]
buffer_load_dwordx4 v71, s[44:47], s99 offen offset:2048 lds
v_mfma_f32_16x16x32_bf16 v[228:231], v[52:55], v[140:143], v[228:231]
v_mfma_f32_16x16x32_bf16 v[232:235], v[56:59], v[140:143], v[232:235]
v_mfma_f32_16x16x32_bf16 v[236:239], v[60:63], v[140:143], v[236:239]
buffer_load_dwordx4 v[140:143], v66, s[48:51], s98 offen sc1
v_mfma_f32_16x16x32_bf16 v[240:243], v[48:51], v[144:147], v[240:243]
buffer_load_dwordx4 v72, s[44:47], s99 offen offset:3072 lds
v_mfma_f32_16x16x32_bf16 v[244:247], v[52:55], v[144:147], v[244:247]
v_mfma_f32_16x16x32_bf16 v[248:251], v[56:59], v[144:147], v[248:251]
v_mfma_f32_16x16x32_bf16 v[252:255], v[60:63], v[144:147], v[252:255]
buffer_load_dwordx4 v[144:147], v67, s[48:51], s98 offen sc1
v_mfma_f32_16x16x32_bf16 v[80:83], v[48:51], v[148:151], v[80:83]
v_mfma_f32_16x16x32_bf16 v[84:87], v[52:55], v[148:151], v[84:87]
v_mfma_f32_16x16x32_bf16 v[88:91], v[56:59], v[148:151], v[88:91]
v_mfma_f32_16x16x32_bf16 v[92:95], v[60:63], v[148:151], v[92:95]
buffer_load_dwordx4 v[148:151], v68, s[48:51], s98 offen sc1
s_waitcnt vmcnt(27)
s_waitcnt lgkmcnt(0)
ds_read_b64_tr_b16 v[48:49], v75 offset:12288
ds_read_b64_tr_b16 v[50:51], v75 offset:13312
ds_read_b64_tr_b16 v[52:53], v76 offset:12288
ds_read_b64_tr_b16 v[54:55], v76 offset:13312
ds_read_b64_tr_b16 v[56:57], v77 offset:12288
ds_read_b64_tr_b16 v[58:59], v77 offset:13312
ds_read_b64_tr_b16 v[60:61], v78 offset:12288
ds_read_b64_tr_b16 v[62:63], v78 offset:13312
v_mfma_f32_16x16x32_bf16 v[192:195], v[32:35], v[152:155], v[192:195]
s_add_u32 m0, s97, 8192
s_add_u32 s99, s96, 0xea000
buffer_load_dwordx4 v69, s[44:47], s99 offen offset:0 lds
v_mfma_f32_16x16x32_bf16 v[196:199], v[36:39], v[152:155], v[196:199]
v_mfma_f32_16x16x32_bf16 v[200:203], v[40:43], v[152:155], v[200:203]
v_mfma_f32_16x16x32_bf16 v[204:207], v[44:47], v[152:155], v[204:207]
s_add_u32 s98, s95, 0x2400
buffer_load_dwordx4 v[152:155], v64, s[48:51], s98 offen sc1
v_mfma_f32_16x16x32_bf16 v[208:211], v[32:35], v[156:159], v[208:211]
buffer_load_dwordx4 v70, s[44:47], s99 offen offset:1024 lds
v_mfma_f32_16x16x32_bf16 v[212:215], v[36:39], v[156:159], v[212:215]
v_mfma_f32_16x16x32_bf16 v[216:219], v[40:43], v[156:159], v[216:219]
v_mfma_f32_16x16x32_bf16 v[220:223], v[44:47], v[156:159], v[220:223]
buffer_load_dwordx4 v[156:159], v65, s[48:51], s98 offen sc1
v_mfma_f32_16x16x32_bf16 v[224:227], v[32:35], v[160:163], v[224:227]
buffer_load_dwordx4 v71, s[44:47], s99 offen offset:2048 lds
v_mfma_f32_16x16x32_bf16 v[228:231], v[36:39], v[160:163], v[228:231]
v_mfma_f32_16x16x32_bf16 v[232:235], v[40:43], v[160:163], v[232:235]
v_mfma_f32_16x16x32_bf16 v[236:239], v[44:47], v[160:163], v[236:239]
buffer_load_dwordx4 v[160:163], v66, s[48:51], s98 offen sc1
v_mfma_f32_16x16x32_bf16 v[240:243], v[32:35], v[164:167], v[240:243]
buffer_load_dwordx4 v72, s[44:47], s99 offen offset:3072 lds
v_mfma_f32_16x16x32_bf16 v[244:247], v[36:39], v[164:167], v[244:247]
v_mfma_f32_16x16x32_bf16 v[248:251], v[40:43], v[164:167], v[248:251]
v_mfma_f32_16x16x32_bf16 v[252:255], v[44:47], v[164:167], v[252:255]
buffer_load_dwordx4 v[164:167], v67, s[48:51], s98 offen sc1
v_mfma_f32_16x16x32_bf16 v[80:83], v[32:35], v[168:171], v[80:83]
v_mfma_f32_16x16x32_bf16 v[84:87], v[36:39], v[168:171], v[84:87]
v_mfma_f32_16x16x32_bf16 v[88:91], v[40:43], v[168:171], v[88:91]
v_mfma_f32_16x16x32_bf16 v[92:95], v[44:47], v[168:171], v[92:95]
buffer_load_dwordx4 v[168:171], v68, s[48:51], s98 offen sc1
s_waitcnt vmcnt(27)
s_waitcnt lgkmcnt(0)
ds_read_b64_tr_b16 v[32:33], v75 offset:16384
ds_read_b64_tr_b16 v[34:35], v75 offset:17408
ds_read_b64_tr_b16 v[36:37], v76 offset:16384
ds_read_b64_tr_b16 v[38:39], v76 offset:17408
ds_read_b64_tr_b16 v[40:41], v77 offset:16384
ds_read_b64_tr_b16 v[42:43], v77 offset:17408
ds_read_b64_tr_b16 v[44:45], v78 offset:16384
ds_read_b64_tr_b16 v[46:47], v78 offset:17408
v_mfma_f32_16x16x32_bf16 v[192:195], v[48:51], v[172:175], v[192:195]
s_add_u32 m0, s97, 12288
s_add_u32 s99, s96, 0xf3000
buffer_load_dwordx4 v69, s[44:47], s99 offen offset:0 lds
v_mfma_f32_16x16x32_bf16 v[196:199], v[52:55], v[172:175], v[196:199]
v_mfma_f32_16x16x32_bf16 v[200:203], v[56:59], v[172:175], v[200:203]
v_mfma_f32_16x16x32_bf16 v[204:207], v[60:63], v[172:175], v[204:207]
s_add_u32 s98, s95, 0x6800
buffer_load_dwordx4 v[172:175], v64, s[48:51], s98 offen sc1
v_mfma_f32_16x16x32_bf16 v[208:211], v[48:51], v[176:179], v[208:211]
buffer_load_dwordx4 v70, s[44:47], s99 offen offset:1024 lds
v_mfma_f32_16x16x32_bf16 v[212:215], v[52:55], v[176:179], v[212:215]
v_mfma_f32_16x16x32_bf16 v[216:219], v[56:59], v[176:179], v[216:219]
v_mfma_f32_16x16x32_bf16 v[220:223], v[60:63], v[176:179], v[220:223]
buffer_load_dwordx4 v[176:179], v65, s[48:51], s98 offen sc1
v_mfma_f32_16x16x32_bf16 v[224:227], v[48:51], v[180:183], v[224:227]
buffer_load_dwordx4 v71, s[44:47], s99 offen offset:2048 lds
v_mfma_f32_16x16x32_bf16 v[228:231], v[52:55], v[180:183], v[228:231]
v_mfma_f32_16x16x32_bf16 v[232:235], v[56:59], v[180:183], v[232:235]
v_mfma_f32_16x16x32_bf16 v[236:239], v[60:63], v[180:183], v[236:239]
buffer_load_dwordx4 v[180:183], v66, s[48:51], s98 offen sc1
v_mfma_f32_16x16x32_bf16 v[240:243], v[48:51], v[184:187], v[240:243]
buffer_load_dwordx4 v72, s[44:47], s99 offen offset:3072 lds
v_mfma_f32_16x16x32_bf16 v[244:247], v[52:55], v[184:187], v[244:247]
v_mfma_f32_16x16x32_bf16 v[248:251], v[56:59], v[184:187], v[248:251]
v_mfma_f32_16x16x32_bf16 v[252:255], v[60:63], v[184:187], v[252:255]
buffer_load_dwordx4 v[184:187], v67, s[48:51], s98 offen sc1
v_mfma_f32_16x16x32_bf16 v[80:83], v[48:51], v[188:191], v[80:83]
v_mfma_f32_16x16x32_bf16 v[84:87], v[52:55], v[188:191], v[84:87]
v_mfma_f32_16x16x32_bf16 v[88:91], v[56:59], v[188:191], v[88:91]
v_mfma_f32_16x16x32_bf16 v[92:95], v[60:63], v[188:191], v[92:95]
buffer_load_dwordx4 v[188:191], v68, s[48:51], s98 offen sc1
s_waitcnt vmcnt(27)
s_waitcnt lgkmcnt(0)
ds_read_b64_tr_b16 v[48:49], v75 offset:0
ds_read_b64_tr_b16 v[50:51], v75 offset:1024
ds_read_b64_tr_b16 v[52:53], v76 offset:0
ds_read_b64_tr_b16 v[54:55], v76 offset:1024
ds_read_b64_tr_b16 v[56:57], v77 offset:0
ds_read_b64_tr_b16 v[58:59], v77 offset:1024
ds_read_b64_tr_b16 v[60:61], v78 offset:0
ds_read_b64_tr_b16 v[62:63], v78 offset:1024
buffer_load_dword v31, v13, s[84:87], 0 offen offset:0 sc1
v_mfma_f32_16x16x32_bf16 v[192:195], v[32:35], v[112:115], v[192:195]
v_mfma_f32_16x16x32_bf16 v[196:199], v[36:39], v[112:115], v[196:199]
v_mfma_f32_16x16x32_bf16 v[200:203], v[40:43], v[112:115], v[200:203]
v_mfma_f32_16x16x32_bf16 v[204:207], v[44:47], v[112:115], v[204:207]
s_add_u32 s98, s95, 0x6c00
buffer_load_dwordx4 v[112:115], v64, s[48:51], s98 offen sc1
v_mfma_f32_16x16x32_bf16 v[208:211], v[32:35], v[116:119], v[208:211]
v_mfma_f32_16x16x32_bf16 v[212:215], v[36:39], v[116:119], v[212:215]
v_mfma_f32_16x16x32_bf16 v[216:219], v[40:43], v[116:119], v[216:219]
v_mfma_f32_16x16x32_bf16 v[220:223], v[44:47], v[116:119], v[220:223]
buffer_load_dwordx4 v[116:119], v65, s[48:51], s98 offen sc1
v_mfma_f32_16x16x32_bf16 v[224:227], v[32:35], v[120:123], v[224:227]
v_mfma_f32_16x16x32_bf16 v[228:231], v[36:39], v[120:123], v[228:231]
v_mfma_f32_16x16x32_bf16 v[232:235], v[40:43], v[120:123], v[232:235]
v_mfma_f32_16x16x32_bf16 v[236:239], v[44:47], v[120:123], v[236:239]
buffer_load_dwordx4 v[120:123], v66, s[48:51], s98 offen sc1
v_mfma_f32_16x16x32_bf16 v[240:243], v[32:35], v[124:127], v[240:243]
v_mfma_f32_16x16x32_bf16 v[244:247], v[36:39], v[124:127], v[244:247]
v_mfma_f32_16x16x32_bf16 v[248:251], v[40:43], v[124:127], v[248:251]
v_mfma_f32_16x16x32_bf16 v[252:255], v[44:47], v[124:127], v[252:255]
buffer_load_dwordx4 v[124:127], v67, s[48:51], s98 offen sc1
v_mfma_f32_16x16x32_bf16 v[80:83], v[32:35], v[128:131], v[80:83]
v_mfma_f32_16x16x32_bf16 v[84:87], v[36:39], v[128:131], v[84:87]
v_mfma_f32_16x16x32_bf16 v[88:91], v[40:43], v[128:131], v[88:91]
v_mfma_f32_16x16x32_bf16 v[92:95], v[44:47], v[128:131], v[92:95]
buffer_load_dwordx4 v[128:131], v68, s[48:51], s98 offen sc1
s_waitcnt vmcnt(24)
s_waitcnt lgkmcnt(0)
ds_read_b64_tr_b16 v[32:33], v75 offset:4096
ds_read_b64_tr_b16 v[34:35], v75 offset:5120
ds_read_b64_tr_b16 v[36:37], v76 offset:4096
ds_read_b64_tr_b16 v[38:39], v76 offset:5120
ds_read_b64_tr_b16 v[40:41], v77 offset:4096
ds_read_b64_tr_b16 v[42:43], v77 offset:5120
ds_read_b64_tr_b16 v[44:45], v78 offset:4096
ds_read_b64_tr_b16 v[46:47], v78 offset:5120
v_mfma_f32_16x16x32_bf16 v[192:195], v[48:51], v[132:135], v[192:195]
v_mfma_f32_16x16x32_bf16 v[196:199], v[52:55], v[132:135], v[196:199]
v_mfma_f32_16x16x32_bf16 v[200:203], v[56:59], v[132:135], v[200:203]
v_mfma_f32_16x16x32_bf16 v[204:207], v[60:63], v[132:135], v[204:207]
v_mfma_f32_16x16x32_bf16 v[208:211], v[48:51], v[136:139], v[208:211]
v_mfma_f32_16x16x32_bf16 v[212:215], v[52:55], v[136:139], v[212:215]
v_mfma_f32_16x16x32_bf16 v[216:219], v[56:59], v[136:139], v[216:219]
v_mfma_f32_16x16x32_bf16 v[220:223], v[60:63], v[136:139], v[220:223]
v_mfma_f32_16x16x32_bf16 v[224:227], v[48:51], v[140:143], v[224:227]
v_mfma_f32_16x16x32_bf16 v[228:231], v[52:55], v[140:143], v[228:231]
v_mfma_f32_16x16x32_bf16 v[232:235], v[56:59], v[140:143], v[232:235]
v_mfma_f32_16x16x32_bf16 v[236:239], v[60:63], v[140:143], v[236:239]
v_mfma_f32_16x16x32_bf16 v[240:243], v[48:51], v[144:147], v[240:243]
v_mfma_f32_16x16x32_bf16 v[244:247], v[52:55], v[144:147], v[244:247]
v_mfma_f32_16x16x32_bf16 v[248:251], v[56:59], v[144:147], v[248:251]
v_mfma_f32_16x16x32_bf16 v[252:255], v[60:63], v[144:147], v[252:255]
v_mfma_f32_16x16x32_bf16 v[80:83], v[48:51], v[148:151], v[80:83]
v_mfma_f32_16x16x32_bf16 v[84:87], v[52:55], v[148:151], v[84:87]
v_mfma_f32_16x16x32_bf16 v[88:91], v[56:59], v[148:151], v[88:91]
v_mfma_f32_16x16x32_bf16 v[92:95], v[60:63], v[148:151], v[92:95]
s_waitcnt vmcnt(15)
s_waitcnt vmcnt(5)
v_cmp_ne_u32 vcc, s100, v31
s_nop 1
s_cbranch_vccz Lok19
s_mov_b32 s83, 20000
Llp20:
buffer_load_dword v31, v13, s[84:87], 0 offen offset:0 sc1
s_sub_u32 s83, s83, 1
s_cbranch_scc1 Lok19
s_waitcnt vmcnt(0)
v_cmp_ne_u32 vcc, s100, v31
s_nop 1
s_cbranch_vccnz Llp20
Lok19:
buffer_load_dwordx4 v[132:135], v98, s[68:71], 0 offen sc1
buffer_load_dwordx4 v[136:139], v99, s[68:71], 0 offen sc1
buffer_load_dwordx4 v[140:143], v100, s[68:71], 0 offen sc1
buffer_load_dword v105, v101, s[72:75], 0 offen offset:256 sc1
buffer_load_dword v104, v101, s[72:75], 0 offen offset:192 sc1
buffer_load_dword v103, v101, s[72:75], 0 offen offset:128 sc1
buffer_load_dword v102, v101, s[72:75], 0 offen offset:64 sc1
buffer_load_dword v101, v101, s[72:75], 0 offen offset:0 sc1
s_waitcnt lgkmcnt(0)
ds_read_b64_tr_b16 v[48:49], v75 offset:8192
ds_read_b64_tr_b16 v[50:51], v75 offset:9216
ds_read_b64_tr_b16 v[52:53], v76 offset:8192
ds_read_b64_tr_b16 v[54:55], v76 offset:9216
ds_read_b64_tr_b16 v[56:57], v77 offset:8192
ds_read_b64_tr_b16 v[58:59], v77 offset:9216
ds_read_b64_tr_b16 v[60:61], v78 offset:8192
ds_read_b64_tr_b16 v[62:63], v78 offset:9216
v_mfma_f32_16x16x32_bf16 v[192:195], v[32:35], v[152:155], v[192:195]
v_mfma_f32_16x16x32_bf16 v[196:199], v[36:39], v[152:155], v[196:199]
v_mfma_f32_16x16x32_bf16 v[200:203], v[40:43], v[152:155], v[200:203]
v_mfma_f32_16x16x32_bf16 v[204:207], v[44:47], v[152:155], v[204:207]
v_mfma_f32_16x16x32_bf16 v[208:211], v[32:35], v[156:159], v[208:211]
v_mfma_f32_16x16x32_bf16 v[212:215], v[36:39], v[156:159], v[212:215]
v_mfma_f32_16x16x32_bf16 v[216:219], v[40:43], v[156:159], v[216:219]
v_mfma_f32_16x16x32_bf16 v[220:223], v[44:47], v[156:159], v[220:223]
v_mfma_f32_16x16x32_bf16 v[224:227], v[32:35], v[160:163], v[224:227]
v_mfma_f32_16x16x32_bf16 v[228:231], v[36:39], v[160:163], v[228:231]
v_mfma_f32_16x16x32_bf16 v[232:235], v[40:43], v[160:163], v[232:235]
v_mfma_f32_16x16x32_bf16 v[236:239], v[44:47], v[160:163], v[236:239]
v_mfma_f32_16x16x32_bf16 v[240:243], v[32:35], v[164:167], v[240:243]
v_mfma_f32_16x16x32_bf16 v[244:247], v[36:39], v[164:167], v[244:247]
v_mfma_f32_16x16x32_bf16 v[248:251], v[40:43], v[164:167], v[248:251]
v_mfma_f32_16x16x32_bf16 v[252:255], v[44:47], v[164:167], v[252:255]
v_mfma_f32_16x16x32_bf16 v[80:83], v[32:35], v[168:171], v[80:83]
v_mfma_f32_16x16x32_bf16 v[84:87], v[36:39], v[168:171], v[84:87]
v_mfma_f32_16x16x32_bf16 v[88:91], v[40:43], v[168:171], v[88:91]
v_mfma_f32_16x16x32_bf16 v[92:95], v[44:47], v[168:171], v[92:95]
s_waitcnt lgkmcnt(0)
ds_read_b64_tr_b16 v[32:33], v75 offset:12288
ds_read_b64_tr_b16 v[34:35], v75 offset:13312
ds_read_b64_tr_b16 v[36:37], v76 offset:12288
ds_read_b64_tr_b16 v[38:39], v76 offset:13312
ds_read_b64_tr_b16 v[40:41], v77 offset:12288
ds_read_b64_tr_b16 v[42:43], v77 offset:13312
ds_read_b64_tr_b16 v[44:45], v78 offset:12288
ds_read_b64_tr_b16 v[46:47], v78 offset:13312
v_mfma_f32_16x16x32_bf16 v[192:195], v[48:51], v[172:175], v[192:195]
v_mfma_f32_16x16x32_bf16 v[196:199], v[52:55], v[172:175], v[196:199]
v_mfma_f32_16x16x32_bf16 v[200:203], v[56:59], v[172:175], v[200:203]
v_mfma_f32_16x16x32_bf16 v[204:207], v[60:63], v[172:175], v[204:207]
v_mfma_f32_16x16x32_bf16 v[208:211], v[48:51], v[176:179], v[208:211]
v_mfma_f32_16x16x32_bf16 v[212:215], v[52:55], v[176:179], v[212:215]
v_mfma_f32_16x16x32_bf16 v[216:219], v[56:59], v[176:179], v[216:219]
v_mfma_f32_16x16x32_bf16 v[220:223], v[60:63], v[176:179], v[220:223]
v_mfma_f32_16x16x32_bf16 v[224:227], v[48:51], v[180:183], v[224:227]
v_mfma_f32_16x16x32_bf16 v[228:231], v[52:55], v[180:183], v[228:231]
v_mfma_f32_16x16x32_bf16 v[232:235], v[56:59], v[180:183], v[232:235]
v_mfma_f32_16x16x32_bf16 v[236:239], v[60:63], v[180:183], v[236:239]
v_mfma_f32_16x16x32_bf16 v[240:243], v[48:51], v[184:187], v[240:243]
v_mfma_f32_16x16x32_bf16 v[244:247], v[52:55], v[184:187], v[244:247]
v_mfma_f32_16x16x32_bf16 v[248:251], v[56:59], v[184:187], v[248:251]
v_mfma_f32_16x16x32_bf16 v[252:255], v[60:63], v[184:187], v[252:255]
v_mfma_f32_16x16x32_bf16 v[80:83], v[48:51], v[188:191], v[80:83]
v_mfma_f32_16x16x32_bf16 v[84:87], v[52:55], v[188:191], v[84:87]
v_mfma_f32_16x16x32_bf16 v[88:91], v[56:59], v[188:191], v[88:91]
v_mfma_f32_16x16x32_bf16 v[92:95], v[60:63], v[188:191], v[92:95]
s_waitcnt vmcnt(8)
s_waitcnt lgkmcnt(0)
v_mfma_f32_16x16x32_bf16 v[192:195], v[32:35], v[112:115], v[192:195]
v_mfma_f32_16x16x32_bf16 v[196:199], v[36:39], v[112:115], v[196:199]
v_mfma_f32_16x16x32_bf16 v[200:203], v[40:43], v[112:115], v[200:203]
v_mfma_f32_16x16x32_bf16 v[204:207], v[44:47], v[112:115], v[204:207]
v_mfma_f32_16x16x32_bf16 v[208:211], v[32:35], v[116:119], v[208:211]
v_mfma_f32_16x16x32_bf16 v[212:215], v[36:39], v[116:119], v[212:215]
v_mfma_f32_16x16x32_bf16 v[216:219], v[40:43], v[116:119], v[216:219]
v_mfma_f32_16x16x32_bf16 v[220:223], v[44:47], v[116:119], v[220:223]
v_mfma_f32_16x16x32_bf16 v[224:227], v[32:35], v[120:123], v[224:227]
v_mfma_f32_16x16x32_bf16 v[228:231], v[36:39], v[120:123], v[228:231]
v_mfma_f32_16x16x32_bf16 v[232:235], v[40:43], v[120:123], v[232:235]
v_mfma_f32_16x16x32_bf16 v[236:239], v[44:47], v[120:123], v[236:239]
v_mfma_f32_16x16x32_bf16 v[240:243], v[32:35], v[124:127], v[240:243]
v_mfma_f32_16x16x32_bf16 v[244:247], v[36:39], v[124:127], v[244:247]
v_mfma_f32_16x16x32_bf16 v[248:251], v[40:43], v[124:127], v[248:251]
v_mfma_f32_16x16x32_bf16 v[252:255], v[44:47], v[124:127], v[252:255]
v_mfma_f32_16x16x32_bf16 v[80:83], v[32:35], v[128:131], v[80:83]
v_mfma_f32_16x16x32_bf16 v[84:87], v[36:39], v[128:131], v[84:87]
v_mfma_f32_16x16x32_bf16 v[88:91], v[40:43], v[128:131], v[88:91]
v_mfma_f32_16x16x32_bf16 v[92:95], v[44:47], v[128:131], v[92:95]
s_waitcnt vmcnt(0)
ds_write_b128 v79, v[132:135] offset:16384
ds_write_b128 v79, v[136:139] offset:17408
ds_write_b128 v79, v[140:143] offset:18432
s_waitcnt lgkmcnt(0)
ds_read_b64_tr_b16 v[2:3], v97 offset:16384
ds_read_b64_tr_b16 v[4:5], v97 offset:16416
ds_read_b64_tr_b16 v[6:7], v97 offset:16448
ds_read_b64_tr_b16 v[8:9], v97 offset:16480
ds_read_b64_tr_b16 v[10:11], v97 offset:16512
s_waitcnt lgkmcnt(0)
s_branch Lbtail
Lsrole:
s_waitcnt vmcnt(1)
v_cmp_ne_u32 vcc, s100, v31
s_nop 1
s_cbranch_vccz Lok32
s_mov_b32 s83, 20000
Llp33:
buffer_load_dword v31, v30, s[84:87], 0 offen offset:0 sc1
s_sub_u32 s83, s83, 1
s_cbranch_scc1 Lok32
s_waitcnt vmcnt(0)
v_cmp_ne_u32 vcc, s100, v31
s_nop 1
s_cbranch_vccnz Llp33
Lok32:
s_lshl_b32 s72, s80, 8
v_lshlrev_b32 v1, 2, v0
s_mov_b32 s68, s6
s_mov_b32 s69, s7
s_mov_b32 s70, 0x24000
s_mov_b32 s71, 0x20000
buffer_load_dword v64, v1, s[68:71], s72 offen
s_mov_b32 s68, s8
s_mov_b32 s69, s9
s_mov_b32 s70, 0x24000
s_mov_b32 s71, 0x20000
buffer_load_dword v65, v1, s[68:71], s72 offen
s_mov_b32 s68, s10
s_mov_b32 s69, s11
s_mov_b32 s70, 0x24000
s_mov_b32 s71, 0x20000
buffer_load_dword v66, v1, s[68:71], s72 offen
s_mov_b32 s68, s12
s_mov_b32 s69, s13
s_mov_b32 s70, 0x24000
s_mov_b32 s71, 0x20000
buffer_load_dword v67, v1, s[68:71], s72 offen
s_mov_b32 s68, s14
s_mov_b32 s69, s15
s_mov_b32 s70, 0x24000
s_mov_b32 s71, 0x20000
buffer_load_dword v68, v1, s[68:71], s72 offen
s_mov_b32 s68, s16
s_mov_b32 s69, s17
s_mov_b32 s70, 0x24000
s_mov_b32 s71, 0x20000
buffer_load_dword v69, v1, s[68:71], s72 offen
s_lshl_b32 s73, s80, 1
v_mov_b32 v10, 0
s_mov_b32 s68, s18
s_mov_b32 s69, s19
s_mov_b32 s70, 0x480
s_mov_b32 s71, 0x20000
buffer_load_ushort v70, v10, s[68:71], s73 offen
s_mov_b32 s68, s20
s_mov_b32 s69, s21
s_mov_b32 s70, 0x480
s_mov_b32 s71, 0x20000
buffer_load_ushort v71, v10, s[68:71], s73 offen
v_mfma_f32_32x32x16_bf16 v[48:63], v[32:35], v[184:187], v[48:63]
v_add_u32 v2, 0xfffdc000, v2
v_add_u32 v3, 0xfffdc000, v3
v_add_u32 v9, 0xfffdc000, v9
ds_read_b64_tr_b16 v[32:33], v9 offset:0
ds_read_b64_tr_b16 v[34:35], v9 offset:512
v_mul_f32 v18, 0xbfb8aa3b, v102
v_mul_f32 v19, 0xbfb8aa3b, v103
v_exp_f32 v12, v12
v_exp_f32 v13, v13
v_mfma_f32_32x32x16_bf16 v[48:63], v[40:43], v[188:191], v[48:63]
ds_read_b64_tr_b16 v[40:41], v9 offset:2048
ds_read_b64_tr_b16 v[42:43], v9 offset:2560
v_exp_f32 v14, v14
v_exp_f32 v15, v15
v_exp_f32 v16, v16
v_exp_f32 v17, v17
s_waitcnt lgkmcnt(2)
v_mfma_f32_32x32x16_bf16 v[48:63], v[32:35], v[192:195], v[48:63]
ds_read_b64_tr_b16 v[32:33], v9 offset:4096
ds_read_b64_tr_b16 v[34:35], v9 offset:4608
v_exp_f32 v18, v18
v_exp_f32 v19, v19
v_mul_f32 v104, v96, v104
v_mul_f32 v105, v97, v105
s_waitcnt lgkmcnt(2)
v_mfma_f32_32x32x16_bf16 v[48:63], v[40:43], v[196:199], v[48:63]
ds_read_b64_tr_b16 v[40:41], v9 offset:6144
ds_read_b64_tr_b16 v[42:43], v9 offset:6656
v_mul_f32 v106, v98, v106
v_mul_f32 v107, v99, v107
v_mul_f32 v108, v100, v108
v_mul_f32 v109, v101, v109
s_waitcnt lgkmcnt(2)
v_mfma_f32_32x32x16_bf16 v[48:63], v[32:35], v[200:203], v[48:63]
ds_read_b64_tr_b16 v[32:33], v9 offset:16384
ds_read_b64_tr_b16 v[34:35], v9 offset:16896
v_mul_f32 v110, v102, v110
v_mul_f32 v111, v103, v111
v_add_f32 v12, 1.0, v12
v_add_f32 v13, 1.0, v13
s_waitcnt lgkmcnt(2)
v_mfma_f32_32x32x16_bf16 v[48:63], v[40:43], v[204:207], v[48:63]
ds_read_b64_tr_b16 v[40:41], v9 offset:18432
ds_read_b64_tr_b16 v[42:43], v9 offset:18944
v_add_f32 v14, 1.0, v14
v_add_f32 v15, 1.0, v15
v_add_f32 v16, 1.0, v16
v_add_f32 v17, 1.0, v17
s_waitcnt lgkmcnt(2)
v_mfma_f32_32x32x16_bf16 v[48:63], v[32:35], v[208:211], v[48:63]
ds_read_b64_tr_b16 v[32:33], v9 offset:20480
ds_read_b64_tr_b16 v[34:35], v9 offset:20992
v_add_f32 v18, 1.0, v18
v_add_f32 v19, 1.0, v19
v_rcp_f32 v12, v12
v_rcp_f32 v13, v13
s_waitcnt lgkmcnt(2)
v_mfma_f32_32x32x16_bf16 v[48:63], v[40:43], v[212:215], v[48:63]
ds_read_b64_tr_b16 v[40:41], v9 offset:22528
ds_read_b64_tr_b16 v[42:43], v9 offset:23040
v_rcp_f32 v14, v14
v_rcp_f32 v15, v15
v_rcp_f32 v16, v16
v_rcp_f32 v17, v17
s_barrier
s_waitcnt lgkmcnt(2)
v_mfma_f32_32x32x16_bf16 v[48:63], v[32:35], v[216:219], v[48:63]
ds_read_b64_tr_b16 v[32:33], v9 offset:32768
ds_read_b64_tr_b16 v[34:35], v9 offset:33280
v_rcp_f32 v18, v18
v_rcp_f32 v19, v19
s_nop 0
v_mul_f32 v104, v104, v12
s_waitcnt lgkmcnt(2)
v_mfma_f32_32x32x16_bf16 v[48:63], v[40:43], v[220:223], v[48:63]
ds_read_b64_tr_b16 v[40:41], v9 offset:34816
ds_read_b64_tr_b16 v[42:43], v9 offset:35328
v_mul_f32 v105, v105, v13
v_mul_f32 v106, v106, v14
v_mul_f32 v107, v107, v15
v_mul_f32 v108, v108, v16
s_waitcnt lgkmcnt(2)
v_mfma_f32_32x32x16_bf16 v[48:63], v[32:35], v[224:227], v[48:63]
ds_read_b64_tr_b16 v[32:33], v9 offset:36864
ds_read_b64_tr_b16 v[34:35], v9 offset:37376
v_mul_f32 v109, v109, v17
v_mul_f32 v110, v110, v18
v_mul_f32 v111, v111, v19
v_cvt_pk_bf16_f32 v24, v104, v105
s_waitcnt lgkmcnt(2)
v_mfma_f32_32x32x16_bf16 v[48:63], v[40:43], v[228:231], v[48:63]
ds_read_b64_tr_b16 v[40:41], v9 offset:38912
ds_read_b64_tr_b16 v[42:43], v9 offset:39424
v_cvt_pk_bf16_f32 v25, v106, v107
v_cvt_pk_bf16_f32 v26, v108, v109
v_cvt_pk_bf16_f32 v27, v110, v111
s_add_u32 s59, s66, 6656
buffer_store_dwordx4 v[24:27], v8, s[48:51], s59 offen sc1
s_waitcnt lgkmcnt(2)
v_mfma_f32_32x32x16_bf16 v[48:63], v[32:35], v[232:235], v[48:63]
v_add_u32 v2, 0xc000, v2
v_add_u32 v3, 0xc000, v3
v_add_u32 v9, 0xc000, v9
ds_read_b64_tr_b16 v[32:33], v9 offset:0
ds_read_b64_tr_b16 v[34:35], v9 offset:512
s_waitcnt lgkmcnt(2)
v_mfma_f32_32x32x16_bf16 v[48:63], v[40:43], v[236:239], v[48:63]
ds_read_b64_tr_b16 v[40:41], v9 offset:2048
ds_read_b64_tr_b16 v[42:43], v9 offset:2560
s_waitcnt lgkmcnt(2)
v_mfma_f32_32x32x16_bf16 v[48:63], v[32:35], v[240:243], v[48:63]
ds_read_b64_tr_b16 v[32:33], v9 offset:4096
ds_read_b64_tr_b16 v[34:35], v9 offset:4608
s_waitcnt lgkmcnt(2)
v_mfma_f32_32x32x16_bf16 v[48:63], v[40:43], v[244:247], v[48:63]
ds_read_b64_tr_b16 v[40:41], v9 offset:6144
ds_read_b64_tr_b16 v[42:43], v9 offset:6656
s_waitcnt lgkmcnt(2)
v_mfma_f32_32x32x16_bf16 v[48:63], v[32:35], v[248:251], v[48:63]
s_waitcnt lgkmcnt(0)
s_barrier
v_mfma_f32_32x32x16_bf16 v[48:63], v[40:43], v[252:255], v[48:63]
s_nop 15
v_mul_f32 v12, 0xbfb8aa3b, v48
v_mul_f32 v13, 0xbfb8aa3b, v49
v_mul_f32 v14, 0xbfb8aa3b, v50
v_mul_f32 v15, 0xbfb8aa3b, v51
v_mul_f32 v16, 0xbfb8aa3b, v52
v_mul_f32 v17, 0xbfb8aa3b, v53
v_mul_f32 v18, 0xbfb8aa3b, v54
v_mul_f32 v19, 0xbfb8aa3b, v55
v_exp_f32 v12, v12
v_exp_f32 v13, v13
v_exp_f32 v14, v14
v_exp_f32 v15, v15
v_exp_f32 v16, v16
v_exp_f32 v17, v17
v_exp_f32 v18, v18
v_exp_f32 v19, v19
v_mul_f32 v56, v48, v56
v_mul_f32 v57, v49, v57
v_mul_f32 v58, v50, v58
v_mul_f32 v59, v51, v59
v_mul_f32 v60, v52, v60
v_mul_f32 v61, v53, v61
v_mul_f32 v62, v54, v62
v_mul_f32 v63, v55, v63
v_add_f32 v12, 1.0, v12
v_add_f32 v13, 1.0, v13
v_add_f32 v14, 1.0, v14
v_add_f32 v15, 1.0, v15
v_add_f32 v16, 1.0, v16
v_add_f32 v17, 1.0, v17
v_add_f32 v18, 1.0, v18
v_add_f32 v19, 1.0, v19
v_rcp_f32 v12, v12
v_rcp_f32 v13, v13
v_rcp_f32 v14, v14
v_rcp_f32 v15, v15
v_rcp_f32 v16, v16
v_rcp_f32 v17, v17
v_rcp_f32 v18, v18
v_rcp_f32 v19, v19
s_nop 0
v_mul_f32 v56, v56, v12
v_mul_f32 v57, v57, v13
v_mul_f32 v58, v58, v14
v_mul_f32 v59, v59, v15
v_mul_f32 v60, v60, v16
v_mul_f32 v61, v61, v17
v_mul_f32 v62, v62, v18
v_mul_f32 v63, v63, v19
v_cvt_pk_bf16_f32 v20, v56, v57
v_cvt_pk_bf16_f32 v21, v58, v59
v_cvt_pk_bf16_f32 v22, v60, v61
v_cvt_pk_bf16_f32 v23, v62, v63
s_mov_b32 s59, s67
buffer_store_dwordx4 v[20:23], v8, s[48:51], s59 offen sc1
s_waitcnt vmcnt(0)
s_lshl_b32 s60, s52, 7
s_lshl_b32 s61, s53, 2
s_add_u32 s60, s60, s61
s_add_u32 s60, s60, 4096
s_mov_b64 exec, 1
v_mov_b32 v14, 72768
v_mov_b32 v15, 1
ds_add_rtn_u32 v14, v14, v15
s_waitcnt lgkmcnt(0)
v_cmp_ne_u32 vcc, 7, v14
v_mov_b32 v14, s60
v_mov_b32 v15, s100
s_cbranch_vccnz Lsk34
buffer_store_dword v15, v14, s[84:87], 0 offen sc1
Lsk34:
s_mov_b64 exec, -1
s_cmp_eq_u32 s82, 0
s_cbranch_scc1 Lend
s_setprio 3
v_mov_b32 v2, v64
v_mov_b32 v3, v65
v_mov_b32 v4, v66
v_mov_b32 v5, v67
v_mov_b32 v6, v68
v_mov_b32 v7, v69
v_mov_b32 v8, v70
v_mov_b32 v9, v71
v_lshlrev_b32 v1, 2, v0
v_add_u32 v11, s81, v1
v_and_b32 v12, 31, v0
v_lshrrev_b32 v13, 5, v0
v_mul_u32_u24 v14, 272, v12
v_lshl_add_u32 v14, v13, 4, v14
v_add_u32 v14, s81, v14
s_add_u32 s68, s36, 0x1200000
s_addc_u32 s69, s37, 0
s_mov_b32 s70, 0x240000
s_mov_b32 s71, 0x20000
s_lshl_b32 s72, s80, 12
v_lshlrev_b32 v1, 4, v0
buffer_load_dwordx4 v[120:123], v1, s[68:71], s72 offen offset:0 sc1
buffer_load_dwordx4 v[124:127], v1, s[68:71], s72 offen offset:1024 sc1
buffer_load_dwordx4 v[128:131], v1, s[68:71], s72 offen offset:2048 sc1
buffer_load_dwordx4 v[132:135], v1, s[68:71], s72 offen offset:3072 sc1
v_lshlrev_b32 v8, 16, v8
s_mov_b32 s74, 0x3fb8aa3b
v_mul_f32 v15, s74, v8
v_fma_f32 v16, v8, s74, -v15
v_fmac_f32 v16, 0x32a57060, v8
v_exp_f32 v15, v15
v_mul_f32 v16, 0x3f317218, v16
v_fma_f32 v15, v15, v16, v15
v_cvt_pk_bf16_f32 v15, v15, v15
v_lshlrev_b32 v8, 16, v15
v_lshlrev_b32 v22, 16, v2
v_lshlrev_b32 v23, 16, v3
v_lshlrev_b32 v24, 16, v4
v_lshlrev_b32 v25, 16, v5
v_lshlrev_b32 v26, 16, v6
v_lshlrev_b32 v27, 16, v7
v_mul_f32 v22, v8, v22
v_mul_f32 v23, v8, v23
v_mul_f32 v24, v8, v24
v_mul_f32 v25, v8, v25
v_mul_f32 v20, 0x3fb8aa3b, v22
v_mul_f32 v21, 0x3e22f983, v23
v_mul_f32 v40, v25, v27
v_mul_f32 v41, v25, v26
v_fma_f32 v28, v24, v26, -v40
v_fma_f32 v29, v24, v27, v41
v_mul_f32 v56, 0x3f800000, v20
v_mul_f32 v58, 0x41000000, v20
v_mul_f32 v60, 0x43800000, v20
v_mul_f32 v57, 0x3f800000, v21
v_mul_f32 v59, 0x41000000, v21
v_mul_f32 v61, 0x43800000, v21
v_exp_f32 v56, v56
v_exp_f32 v58, v58
v_exp_f32 v60, v60
v_fract_f32 v57, v57
v_fract_f32 v59, v59
v_fract_f32 v61, v61
v_cos_f32 v30, v57
v_cos_f32 v32, v59
v_cos_f32 v34, v61
v_sin_f32 v31, v57
v_sin_f32 v33, v59
v_sin_f32 v35, v61
v_mul_f32 v30, v56, v30
v_mul_f32 v32, v58, v32
v_mul_f32 v34, v60, v34
v_mul_f32 v31, v56, v31
v_mul_f32 v33, v58, v33
v_mul_f32 v35, v60, v35
v_mov_b32 v48, 0x3f80
v_cvt_pk_bf16_f32 v46, v28, -v29
ds_write_b32 v11, v48 offset:0
ds_write_b32 v11, v46 offset:8704
v_cvt_pk_bf16_f32 v44, v32, v33
v_mul_f32 v42, v29, v31
ds_write_b32 v11, v44 offset:272
v_mul_f32 v43, v29, v30
v_mul_f32 v40, v33, v33
v_fma_f32 v62, v28, v30, -v42
v_mul_f32 v41, v33, v32
v_fma_f32 v63, v28, v31, v43
v_fma_f32 v36, v32, v32, -v40
v_cvt_pk_bf16_f32 v47, v62, -v63
v_fma_f32 v37, v32, v33, v41
ds_write_b32 v11, v47 offset:8976
v_cvt_pk_bf16_f32 v44, v36, v37
v_mul_f32 v42, v63, v31
ds_write_b32 v11, v44 offset:544
v_mul_f32 v43, v63, v30
v_mul_f32 v40, v37, v33
v_fma_f32 v64, v62, v30, -v42
v_mul_f32 v41, v37, v32
v_fma_f32 v65, v62, v31, v43
v_fma_f32 v38, v36, v32, -v40
v_cvt_pk_bf16_f32 v46, v64, -v65
v_fma_f32 v39, v36, v33, v41
ds_write_b32 v11, v46 offset:9248
v_cvt_pk_bf16_f32 v45, v38, v39
v_mul_f32 v42, v65, v31
ds_write_b32 v11, v45 offset:816
v_mul_f32 v43, v65, v30
v_mul_f32 v40, v39, v33
v_fma_f32 v62, v64, v30, -v42
v_mul_f32 v41, v39, v32
v_fma_f32 v63, v64, v31, v43
v_fma_f32 v36, v38, v32, -v40
v_cvt_pk_bf16_f32 v47, v62, -v63
v_fma_f32 v37, v38, v33, v41
ds_write_b32 v11, v47 offset:9520
v_cvt_pk_bf16_f32 v44, v36, v37
v_mul_f32 v42, v63, v31
ds_write_b32 v11, v44 offset:1088
v_mul_f32 v43, v63, v30
v_mul_f32 v40, v37, v33
v_fma_f32 v64, v62, v30, -v42
v_mul_f32 v41, v37, v32
v_fma_f32 v65, v62, v31, v43
v_fma_f32 v38, v36, v32, -v40
v_cvt_pk_bf16_f32 v46, v64, -v65
v_fma_f32 v39, v36, v33, v41
ds_write_b32 v11, v46 offset:9792
v_cvt_pk_bf16_f32 v45, v38, v39
v_mul_f32 v42, v65, v31
ds_write_b32 v11, v45 offset:1360
v_mul_f32 v43, v65, v30
v_mul_f32 v40, v39, v33
v_fma_f32 v62, v64, v30, -v42
v_mul_f32 v41, v39, v32
v_fma_f32 v63, v64, v31, v43
v_fma_f32 v36, v38, v32, -v40
v_cvt_pk_bf16_f32 v47, v62, -v63
v_fma_f32 v37, v38, v33, v41
ds_write_b32 v11, v47 offset:10064
v_cvt_pk_bf16_f32 v44, v36, v37
v_mul_f32 v42, v63, v31
ds_write_b32 v11, v44 offset:1632
v_mul_f32 v43, v63, v30
v_mul_f32 v40, v37, v33
v_fma_f32 v64, v62, v30, -v42
v_mul_f32 v41, v37, v32
v_fma_f32 v65, v62, v31, v43
v_fma_f32 v38, v36, v32, -v40
v_cvt_pk_bf16_f32 v46, v64, -v65
v_fma_f32 v39, v36, v33, v41
ds_write_b32 v11, v46 offset:10336
v_cvt_pk_bf16_f32 v45, v38, v39
v_mul_f32 v42, v65, v31
ds_write_b32 v11, v45 offset:1904
v_mul_f32 v43, v65, v30
v_mul_f32 v40, v39, v33
v_fma_f32 v62, v64, v30, -v42
v_mul_f32 v41, v39, v32
v_fma_f32 v63, v64, v31, v43
v_fma_f32 v36, v38, v32, -v40
v_cvt_pk_bf16_f32 v47, v62, -v63
v_fma_f32 v37, v38, v33, v41
ds_write_b32 v11, v47 offset:10608
v_cvt_pk_bf16_f32 v44, v36, v37
v_mul_f32 v42, v31, v31
ds_write_b32 v11, v44 offset:2176
v_mul_f32 v43, v31, v30
v_mul_f32 v40, v37, v33
v_fma_f32 v50, v30, v30, -v42
v_mul_f32 v41, v37, v32
v_fma_f32 v51, v30, v31, v43
v_fma_f32 v38, v36, v32, -v40
v_mul_f32 v42, v51, v51
v_fma_f32 v39, v36, v33, v41
v_mul_f32 v43, v51, v50
v_cvt_pk_bf16_f32 v45, v38, v39
v_fma_f32 v52, v50, v50, -v42
ds_write_b32 v11, v45 offset:2448
v_fma_f32 v53, v50, v51, v43
v_mul_f32 v40, v39, v33
v_mul_f32 v42, v29, v35
v_mul_f32 v41, v39, v32
v_mul_f32 v43, v29, v34
v_fma_f32 v36, v38, v32, -v40
v_fma_f32 v54, v28, v34, -v42
v_fma_f32 v37, v38, v33, v41
v_fma_f32 v55, v28, v35, v43
v_cvt_pk_bf16_f32 v44, v36, v37
v_cvt_pk_bf16_f32 v46, v54, -v55
ds_write_b32 v11, v44 offset:2720
ds_write_b32 v11, v46 offset:10880
v_mul_f32 v40, v37, v33
v_mul_f32 v42, v55, v51
v_mul_f32 v41, v37, v32
v_mul_f32 v43, v55, v50
v_fma_f32 v38, v36, v32, -v40
v_fma_f32 v62, v54, v50, -v42
v_fma_f32 v39, v36, v33, v41
v_fma_f32 v63, v54, v51, v43
v_cvt_pk_bf16_f32 v45, v38, v39
v_cvt_pk_bf16_f32 v47, v62, -v63
ds_write_b32 v11, v45 offset:2992
ds_write_b32 v11, v47 offset:11152
v_mul_f32 v40, v39, v33
v_mul_f32 v42, v63, v51
v_mul_f32 v41, v39, v32
v_mul_f32 v43, v63, v50
v_fma_f32 v36, v38, v32, -v40
v_fma_f32 v64, v62, v50, -v42
v_fma_f32 v37, v38, v33, v41
v_fma_f32 v65, v62, v51, v43
v_cvt_pk_bf16_f32 v44, v36, v37
v_cvt_pk_bf16_f32 v46, v64, -v65
ds_write_b32 v11, v44 offset:3264
ds_write_b32 v11, v46 offset:11424
v_mul_f32 v40, v37, v33
v_mul_f32 v42, v65, v51
v_mul_f32 v41, v37, v32
v_mul_f32 v43, v65, v50
v_fma_f32 v38, v36, v32, -v40
v_fma_f32 v62, v64, v50, -v42
v_fma_f32 v39, v36, v33, v41
v_fma_f32 v63, v64, v51, v43
v_cvt_pk_bf16_f32 v45, v38, v39
v_cvt_pk_bf16_f32 v47, v62, -v63
ds_write_b32 v11, v45 offset:3536
ds_write_b32 v11, v47 offset:11696
v_mul_f32 v40, v39, v33
v_mul_f32 v42, v55, v35
v_mul_f32 v41, v39, v32
v_mul_f32 v43, v55, v34
v_fma_f32 v36, v38, v32, -v40
v_fma_f32 v28, v54, v34, -v42
v_fma_f32 v37, v38, v33, v41
v_fma_f32 v29, v54, v35, v43
v_cvt_pk_bf16_f32 v44, v36, v37
v_cvt_pk_bf16_f32 v46, v28, -v29
ds_write_b32 v11, v44 offset:3808
ds_write_b32 v11, v46 offset:11968
v_mul_f32 v40, v37, v33
v_mul_f32 v42, v29, v53
v_mul_f32 v41, v37, v32
v_mul_f32 v43, v29, v52
v_fma_f32 v38, v36, v32, -v40
v_fma_f32 v62, v28, v52, -v42
v_fma_f32 v39, v36, v33, v41
v_fma_f32 v63, v28, v53, v43
v_cvt_pk_bf16_f32 v45, v38, v39
v_cvt_pk_bf16_f32 v47, v62, -v63
ds_write_b32 v11, v45 offset:4080
ds_write_b32 v11, v47 offset:12240
v_mul_f32 v40, v39, v33
v_mul_f32 v42, v29, v35
v_mul_f32 v41, v39, v32
v_mul_f32 v43, v29, v34
v_fma_f32 v36, v38, v32, -v40
v_fma_f32 v54, v28, v34, -v42
v_fma_f32 v37, v38, v33, v41
v_fma_f32 v55, v28, v35, v43
v_cvt_pk_bf16_f32 v44, v36, v37
v_cvt_pk_bf16_f32 v46, v54, -v55
ds_write_b32 v11, v44 offset:4352
ds_write_b32 v11, v46 offset:12512
v_mul_f32 v40, v37, v33
v_mul_f32 v42, v55, v53
v_mul_f32 v41, v37, v32
v_mul_f32 v43, v55, v52
v_fma_f32 v38, v36, v32, -v40
v_fma_f32 v62, v54, v52, -v42
v_fma_f32 v39, v36, v33, v41
v_fma_f32 v63, v54, v53, v43
v_cvt_pk_bf16_f32 v45, v38, v39
v_cvt_pk_bf16_f32 v47, v62, -v63
ds_write_b32 v11, v45 offset:4624
ds_write_b32 v11, v47 offset:12784
v_mul_f32 v40, v39, v33
v_mul_f32 v42, v55, v35
v_mul_f32 v41, v39, v32
v_mul_f32 v43, v55, v34
v_fma_f32 v36, v38, v32, -v40
v_fma_f32 v28, v54, v34, -v42
v_fma_f32 v37, v38, v33, v41
v_fma_f32 v29, v54, v35, v43
v_cvt_pk_bf16_f32 v44, v36, v37
v_cvt_pk_bf16_f32 v46, v28, -v29
ds_write_b32 v11, v44 offset:4896
ds_write_b32 v11, v46 offset:13056
v_mul_f32 v40, v37, v33
v_mul_f32 v42, v29, v35
v_mul_f32 v41, v37, v32
v_mul_f32 v43, v29, v34
v_fma_f32 v38, v36, v32, -v40
v_fma_f32 v54, v28, v34, -v42
v_fma_f32 v39, v36, v33, v41
v_fma_f32 v55, v28, v35, v43
v_cvt_pk_bf16_f32 v45, v38, v39
v_cvt_pk_bf16_f32 v47, v54, -v55
ds_write_b32 v11, v45 offset:5168
ds_write_b32 v11, v47 offset:13328
v_mul_f32 v40, v39, v33
v_mul_f32 v42, v55, v35
v_mul_f32 v41, v39, v32
v_mul_f32 v43, v55, v34
v_fma_f32 v36, v38, v32, -v40
v_fma_f32 v28, v54, v34, -v42
v_fma_f32 v37, v38, v33, v41
v_fma_f32 v29, v54, v35, v43
v_cvt_pk_bf16_f32 v44, v36, v37
v_cvt_pk_bf16_f32 v46, v28, -v29
ds_write_b32 v11, v44 offset:5440
ds_write_b32 v11, v46 offset:13600
v_mul_f32 v40, v37, v33
v_mul_f32 v42, v29, v35
v_mul_f32 v41, v37, v32
v_mul_f32 v43, v29, v34
v_fma_f32 v38, v36, v32, -v40
v_fma_f32 v54, v28, v34, -v42
v_fma_f32 v39, v36, v33, v41
v_fma_f32 v55, v28, v35, v43
v_cvt_pk_bf16_f32 v45, v38, v39
v_cvt_pk_bf16_f32 v47, v54, -v55
ds_write_b32 v11, v45 offset:5712
ds_write_b32 v11, v47 offset:13872
v_mul_f32 v40, v39, v33
v_mul_f32 v42, v55, v35
v_mul_f32 v41, v39, v32
v_mul_f32 v43, v55, v34
v_fma_f32 v36, v38, v32, -v40
v_fma_f32 v28, v54, v34, -v42
v_fma_f32 v37, v38, v33, v41
v_fma_f32 v29, v54, v35, v43
v_cvt_pk_bf16_f32 v44, v36, v37
v_cvt_pk_bf16_f32 v46, v28, -v29
ds_write_b32 v11, v44 offset:5984
ds_write_b32 v11, v46 offset:14144
v_mul_f32 v40, v37, v33
v_mul_f32 v41, v37, v32
v_fma_f32 v38, v36, v32, -v40
v_fma_f32 v39, v36, v33, v41
v_cvt_pk_bf16_f32 v45, v38, v39
ds_write_b32 v11, v45 offset:6256
v_mul_f32 v40, v39, v33
v_mul_f32 v41, v39, v32
v_fma_f32 v36, v38, v32, -v40
v_fma_f32 v37, v38, v33, v41
v_cvt_pk_bf16_f32 v44, v36, v37
ds_write_b32 v11, v44 offset:6528
v_mul_f32 v40, v37, v33
v_mul_f32 v41, v37, v32
v_fma_f32 v38, v36, v32, -v40
v_fma_f32 v39, v36, v33, v41
v_cvt_pk_bf16_f32 v45, v38, v39
ds_write_b32 v11, v45 offset:6800
v_mul_f32 v40, v39, v33
v_mul_f32 v41, v39, v32
v_fma_f32 v36, v38, v32, -v40
v_fma_f32 v37, v38, v33, v41
v_cvt_pk_bf16_f32 v44, v36, v37
ds_write_b32 v11, v44 offset:7072
v_mul_f32 v40, v37, v33
v_mul_f32 v41, v37, v32
v_fma_f32 v38, v36, v32, -v40
v_fma_f32 v39, v36, v33, v41
v_cvt_pk_bf16_f32 v45, v38, v39
ds_write_b32 v11, v45 offset:7344
v_mul_f32 v40, v39, v33
v_mul_f32 v41, v39, v32
v_fma_f32 v36, v38, v32, -v40
v_fma_f32 v37, v38, v33, v41
v_cvt_pk_bf16_f32 v44, v36, v37
ds_write_b32 v11, v44 offset:7616
v_mul_f32 v40, v37, v33
v_mul_f32 v41, v37, v32
v_fma_f32 v38, v36, v32, -v40
v_fma_f32 v39, v36, v33, v41
v_cvt_pk_bf16_f32 v45, v38, v39
ds_write_b32 v11, v45 offset:7888
v_mul_f32 v40, v39, v33
v_mul_f32 v41, v39, v32
v_fma_f32 v36, v38, v32, -v40
v_fma_f32 v37, v38, v33, v41
v_cvt_pk_bf16_f32 v44, v36, v37
ds_write_b32 v11, v44 offset:8160
v_mul_f32 v40, v37, v33
v_mul_f32 v41, v37, v32
v_fma_f32 v38, v36, v32, -v40
v_fma_f32 v39, v36, v33, v41
v_cvt_pk_bf16_f32 v45, v38, v39
ds_write_b32 v11, v45 offset:8432
s_waitcnt lgkmcnt(0)
ds_read_b128 v[136:139], v14 offset:0
ds_read_b128 v[140:143], v14 offset:8704
ds_read_b128 v[144:147], v14 offset:32
ds_read_b128 v[148:151], v14 offset:8736
ds_read_b128 v[152:155], v14 offset:64
ds_read_b128 v[156:159], v14 offset:8768
ds_read_b128 v[160:163], v14 offset:96
ds_read_b128 v[164:167], v14 offset:8800
ds_read_b128 v[168:171], v14 offset:128
ds_read_b128 v[172:175], v14 offset:8832
ds_read_b128 v[176:179], v14 offset:160
ds_read_b128 v[180:183], v14 offset:8864
ds_read_b128 v[184:187], v14 offset:192
ds_read_b128 v[188:191], v14 offset:8896
ds_read_b128 v[192:195], v14 offset:224
ds_read_b128 v[196:199], v14 offset:8928
s_waitcnt lgkmcnt(14)
v_mfma_f32_32x32x16_bf16 v[100:115], v[136:139], v[140:143], 0
s_waitcnt lgkmcnt(12)
v_mfma_f32_32x32x16_bf16 v[100:115], v[144:147], v[148:151], v[100:115]
s_waitcnt lgkmcnt(10)
v_mfma_f32_32x32x16_bf16 v[100:115], v[152:155], v[156:159], v[100:115]
s_waitcnt lgkmcnt(8)
v_mfma_f32_32x32x16_bf16 v[100:115], v[160:163], v[164:167], v[100:115]
s_waitcnt lgkmcnt(6)
v_mfma_f32_32x32x16_bf16 v[100:115], v[168:171], v[172:175], v[100:115]
s_waitcnt lgkmcnt(4)
v_mfma_f32_32x32x16_bf16 v[100:115], v[176:179], v[180:183], v[100:115]
s_waitcnt lgkmcnt(2)
v_mfma_f32_32x32x16_bf16 v[100:115], v[184:187], v[188:191], v[100:115]
s_waitcnt lgkmcnt(0)
v_mfma_f32_32x32x16_bf16 v[100:115], v[192:195], v[196:199], v[100:115]
v_and_b32 v22, 0xffff0000, v2
v_and_b32 v23, 0xffff0000, v3
v_and_b32 v24, 0xffff0000, v4
v_and_b32 v25, 0xffff0000, v5
v_and_b32 v26, 0xffff0000, v6
v_and_b32 v27, 0xffff0000, v7
v_mul_f32 v22, v8, v22
v_mul_f32 v23, v8, v23
v_mul_f32 v24, v8, v24
v_mul_f32 v25, v8, v25
v_mul_f32 v20, 0x3fb8aa3b, v22
v_mul_f32 v21, 0x3e22f983, v23
v_mul_f32 v40, v25, v27
v_mul_f32 v41, v25, v26
v_fma_f32 v28, v24, v26, -v40
v_fma_f32 v29, v24, v27, v41
v_mul_f32 v56, 0x3f800000, v20
v_mul_f32 v58, 0x41000000, v20
v_mul_f32 v60, 0x43800000, v20
v_mul_f32 v57, 0x3f800000, v21
v_mul_f32 v59, 0x41000000, v21
v_mul_f32 v61, 0x43800000, v21
v_exp_f32 v56, v56
v_exp_f32 v58, v58
v_exp_f32 v60, v60
v_fract_f32 v57, v57
v_fract_f32 v59, v59
v_fract_f32 v61, v61
v_cos_f32 v30, v57
v_cos_f32 v32, v59
v_cos_f32 v34, v61
v_sin_f32 v31, v57
v_sin_f32 v33, v59
v_sin_f32 v35, v61
v_mul_f32 v30, v56, v30
v_mul_f32 v32, v58, v32
v_mul_f32 v34, v60, v34
v_mul_f32 v31, v56, v31
v_mul_f32 v33, v58, v33
v_mul_f32 v35, v60, v35
v_mov_b32 v48, 0x3f80
v_cvt_pk_bf16_f32 v46, v28, -v29
ds_write_b32 v11, v48 offset:0
ds_write_b32 v11, v46 offset:8704
v_cvt_pk_bf16_f32 v44, v32, v33
v_mul_f32 v42, v29, v31
ds_write_b32 v11, v44 offset:272
v_mul_f32 v43, v29, v30
v_mul_f32 v40, v33, v33
v_fma_f32 v62, v28, v30, -v42
v_mul_f32 v41, v33, v32
v_fma_f32 v63, v28, v31, v43
v_fma_f32 v36, v32, v32, -v40
v_cvt_pk_bf16_f32 v47, v62, -v63
v_fma_f32 v37, v32, v33, v41
ds_write_b32 v11, v47 offset:8976
v_cvt_pk_bf16_f32 v44, v36, v37
v_mul_f32 v42, v63, v31
ds_write_b32 v11, v44 offset:544
v_mul_f32 v43, v63, v30
v_mul_f32 v40, v37, v33
v_fma_f32 v64, v62, v30, -v42
v_mul_f32 v41, v37, v32
v_fma_f32 v65, v62, v31, v43
v_fma_f32 v38, v36, v32, -v40
v_cvt_pk_bf16_f32 v46, v64, -v65
v_fma_f32 v39, v36, v33, v41
ds_write_b32 v11, v46 offset:9248
v_cvt_pk_bf16_f32 v45, v38, v39
v_mul_f32 v42, v65, v31
ds_write_b32 v11, v45 offset:816
v_mul_f32 v43, v65, v30
v_mul_f32 v40, v39, v33
v_fma_f32 v62, v64, v30, -v42
v_mul_f32 v41, v39, v32
v_fma_f32 v63, v64, v31, v43
v_fma_f32 v36, v38, v32, -v40
v_cvt_pk_bf16_f32 v47, v62, -v63
v_fma_f32 v37, v38, v33, v41
ds_write_b32 v11, v47 offset:9520
v_cvt_pk_bf16_f32 v44, v36, v37
v_mul_f32 v42, v63, v31
ds_write_b32 v11, v44 offset:1088
v_mul_f32 v43, v63, v30
v_mul_f32 v40, v37, v33
v_fma_f32 v64, v62, v30, -v42
v_mul_f32 v41, v37, v32
v_fma_f32 v65, v62, v31, v43
v_fma_f32 v38, v36, v32, -v40
v_cvt_pk_bf16_f32 v46, v64, -v65
v_fma_f32 v39, v36, v33, v41
ds_write_b32 v11, v46 offset:9792
v_cvt_pk_bf16_f32 v45, v38, v39
v_mul_f32 v42, v65, v31
ds_write_b32 v11, v45 offset:1360
v_mul_f32 v43, v65, v30
v_mul_f32 v40, v39, v33
v_fma_f32 v62, v64, v30, -v42
v_mul_f32 v41, v39, v32
v_fma_f32 v63, v64, v31, v43
v_fma_f32 v36, v38, v32, -v40
v_cvt_pk_bf16_f32 v47, v62, -v63
v_fma_f32 v37, v38, v33, v41
ds_write_b32 v11, v47 offset:10064
v_cvt_pk_bf16_f32 v44, v36, v37
v_mul_f32 v42, v63, v31
ds_write_b32 v11, v44 offset:1632
v_mul_f32 v43, v63, v30
v_mul_f32 v40, v37, v33
v_fma_f32 v64, v62, v30, -v42
v_mul_f32 v41, v37, v32
v_fma_f32 v65, v62, v31, v43
v_fma_f32 v38, v36, v32, -v40
v_cvt_pk_bf16_f32 v46, v64, -v65
v_fma_f32 v39, v36, v33, v41
ds_write_b32 v11, v46 offset:10336
v_cvt_pk_bf16_f32 v45, v38, v39
v_mul_f32 v42, v65, v31
ds_write_b32 v11, v45 offset:1904
v_mul_f32 v43, v65, v30
v_mul_f32 v40, v39, v33
v_fma_f32 v62, v64, v30, -v42
v_mul_f32 v41, v39, v32
v_fma_f32 v63, v64, v31, v43
v_fma_f32 v36, v38, v32, -v40
v_cvt_pk_bf16_f32 v47, v62, -v63
v_fma_f32 v37, v38, v33, v41
ds_write_b32 v11, v47 offset:10608
v_cvt_pk_bf16_f32 v44, v36, v37
v_mul_f32 v42, v31, v31
ds_write_b32 v11, v44 offset:2176
v_mul_f32 v43, v31, v30
v_mul_f32 v40, v37, v33
v_fma_f32 v50, v30, v30, -v42
v_mul_f32 v41, v37, v32
v_fma_f32 v51, v30, v31, v43
v_fma_f32 v38, v36, v32, -v40
v_mul_f32 v42, v51, v51
v_fma_f32 v39, v36, v33, v41
v_mul_f32 v43, v51, v50
v_cvt_pk_bf16_f32 v45, v38, v39
v_fma_f32 v52, v50, v50, -v42
ds_write_b32 v11, v45 offset:2448
v_fma_f32 v53, v50, v51, v43
v_mul_f32 v40, v39, v33
v_mul_f32 v42, v29, v35
v_mul_f32 v41, v39, v32
v_mul_f32 v43, v29, v34
v_fma_f32 v36, v38, v32, -v40
v_fma_f32 v54, v28, v34, -v42
v_fma_f32 v37, v38, v33, v41
v_fma_f32 v55, v28, v35, v43
v_cvt_pk_bf16_f32 v44, v36, v37
v_cvt_pk_bf16_f32 v46, v54, -v55
ds_write_b32 v11, v44 offset:2720
ds_write_b32 v11, v46 offset:10880
v_mul_f32 v40, v37, v33
v_mul_f32 v42, v55, v51
v_mul_f32 v41, v37, v32
v_mul_f32 v43, v55, v50
v_fma_f32 v38, v36, v32, -v40
v_fma_f32 v62, v54, v50, -v42
v_fma_f32 v39, v36, v33, v41
v_fma_f32 v63, v54, v51, v43
v_cvt_pk_bf16_f32 v45, v38, v39
v_cvt_pk_bf16_f32 v47, v62, -v63
ds_write_b32 v11, v45 offset:2992
ds_write_b32 v11, v47 offset:11152
v_mul_f32 v40, v39, v33
v_mul_f32 v42, v63, v51
v_mul_f32 v41, v39, v32
v_mul_f32 v43, v63, v50
v_fma_f32 v36, v38, v32, -v40
v_fma_f32 v64, v62, v50, -v42
v_fma_f32 v37, v38, v33, v41
v_fma_f32 v65, v62, v51, v43
v_cvt_pk_bf16_f32 v44, v36, v37
v_cvt_pk_bf16_f32 v46, v64, -v65
ds_write_b32 v11, v44 offset:3264
ds_write_b32 v11, v46 offset:11424
v_mul_f32 v40, v37, v33
v_mul_f32 v42, v65, v51
v_mul_f32 v41, v37, v32
v_mul_f32 v43, v65, v50
v_fma_f32 v38, v36, v32, -v40
v_fma_f32 v62, v64, v50, -v42
v_fma_f32 v39, v36, v33, v41
v_fma_f32 v63, v64, v51, v43
v_cvt_pk_bf16_f32 v45, v38, v39
v_cvt_pk_bf16_f32 v47, v62, -v63
ds_write_b32 v11, v45 offset:3536
ds_write_b32 v11, v47 offset:11696
v_mul_f32 v40, v39, v33
v_mul_f32 v42, v55, v35
v_mul_f32 v41, v39, v32
v_mul_f32 v43, v55, v34
v_fma_f32 v36, v38, v32, -v40
v_fma_f32 v28, v54, v34, -v42
v_fma_f32 v37, v38, v33, v41
v_fma_f32 v29, v54, v35, v43
v_cvt_pk_bf16_f32 v44, v36, v37
v_cvt_pk_bf16_f32 v46, v28, -v29
ds_write_b32 v11, v44 offset:3808
ds_write_b32 v11, v46 offset:11968
v_mul_f32 v40, v37, v33
v_mul_f32 v42, v29, v53
v_mul_f32 v41, v37, v32
v_mul_f32 v43, v29, v52
v_fma_f32 v38, v36, v32, -v40
v_fma_f32 v62, v28, v52, -v42
v_fma_f32 v39, v36, v33, v41
v_fma_f32 v63, v28, v53, v43
v_cvt_pk_bf16_f32 v45, v38, v39
v_cvt_pk_bf16_f32 v47, v62, -v63
ds_write_b32 v11, v45 offset:4080
ds_write_b32 v11, v47 offset:12240
v_mul_f32 v40, v39, v33
v_mul_f32 v42, v29, v35
v_mul_f32 v41, v39, v32
v_mul_f32 v43, v29, v34
v_fma_f32 v36, v38, v32, -v40
v_fma_f32 v54, v28, v34, -v42
v_fma_f32 v37, v38, v33, v41
v_fma_f32 v55, v28, v35, v43
v_cvt_pk_bf16_f32 v44, v36, v37
v_cvt_pk_bf16_f32 v46, v54, -v55
ds_write_b32 v11, v44 offset:4352
ds_write_b32 v11, v46 offset:12512
v_mul_f32 v40, v37, v33
v_mul_f32 v42, v55, v53
v_mul_f32 v41, v37, v32
v_mul_f32 v43, v55, v52
v_fma_f32 v38, v36, v32, -v40
v_fma_f32 v62, v54, v52, -v42
v_fma_f32 v39, v36, v33, v41
v_fma_f32 v63, v54, v53, v43
v_cvt_pk_bf16_f32 v45, v38, v39
v_cvt_pk_bf16_f32 v47, v62, -v63
ds_write_b32 v11, v45 offset:4624
ds_write_b32 v11, v47 offset:12784
v_mul_f32 v40, v39, v33
v_mul_f32 v42, v55, v35
v_mul_f32 v41, v39, v32
v_mul_f32 v43, v55, v34
v_fma_f32 v36, v38, v32, -v40
v_fma_f32 v28, v54, v34, -v42
v_fma_f32 v37, v38, v33, v41
v_fma_f32 v29, v54, v35, v43
v_cvt_pk_bf16_f32 v44, v36, v37
v_cvt_pk_bf16_f32 v46, v28, -v29
ds_write_b32 v11, v44 offset:4896
ds_write_b32 v11, v46 offset:13056
v_mul_f32 v40, v37, v33
v_mul_f32 v42, v29, v35
v_mul_f32 v41, v37, v32
v_mul_f32 v43, v29, v34
v_fma_f32 v38, v36, v32, -v40
v_fma_f32 v54, v28, v34, -v42
v_fma_f32 v39, v36, v33, v41
v_fma_f32 v55, v28, v35, v43
v_cvt_pk_bf16_f32 v45, v38, v39
v_cvt_pk_bf16_f32 v47, v54, -v55
ds_write_b32 v11, v45 offset:5168
ds_write_b32 v11, v47 offset:13328
v_mul_f32 v40, v39, v33
v_mul_f32 v42, v55, v35
v_mul_f32 v41, v39, v32
v_mul_f32 v43, v55, v34
v_fma_f32 v36, v38, v32, -v40
v_fma_f32 v28, v54, v34, -v42
v_fma_f32 v37, v38, v33, v41
v_fma_f32 v29, v54, v35, v43
v_cvt_pk_bf16_f32 v44, v36, v37
v_cvt_pk_bf16_f32 v46, v28, -v29
ds_write_b32 v11, v44 offset:5440
ds_write_b32 v11, v46 offset:13600
v_mul_f32 v40, v37, v33
v_mul_f32 v42, v29, v35
v_mul_f32 v41, v37, v32
v_mul_f32 v43, v29, v34
v_fma_f32 v38, v36, v32, -v40
v_fma_f32 v54, v28, v34, -v42
v_fma_f32 v39, v36, v33, v41
v_fma_f32 v55, v28, v35, v43
v_cvt_pk_bf16_f32 v45, v38, v39
v_cvt_pk_bf16_f32 v47, v54, -v55
ds_write_b32 v11, v45 offset:5712
ds_write_b32 v11, v47 offset:13872
v_mul_f32 v40, v39, v33
v_mul_f32 v42, v55, v35
v_mul_f32 v41, v39, v32
v_mul_f32 v43, v55, v34
v_fma_f32 v36, v38, v32, -v40
v_fma_f32 v28, v54, v34, -v42
v_fma_f32 v37, v38, v33, v41
v_fma_f32 v29, v54, v35, v43
v_cvt_pk_bf16_f32 v44, v36, v37
v_cvt_pk_bf16_f32 v46, v28, -v29
ds_write_b32 v11, v44 offset:5984
ds_write_b32 v11, v46 offset:14144
v_mul_f32 v40, v37, v33
v_mul_f32 v41, v37, v32
v_fma_f32 v38, v36, v32, -v40
v_fma_f32 v39, v36, v33, v41
v_cvt_pk_bf16_f32 v45, v38, v39
ds_write_b32 v11, v45 offset:6256
v_mul_f32 v40, v39, v33
v_mul_f32 v41, v39, v32
v_fma_f32 v36, v38, v32, -v40
v_fma_f32 v37, v38, v33, v41
v_cvt_pk_bf16_f32 v44, v36, v37
ds_write_b32 v11, v44 offset:6528
v_mul_f32 v40, v37, v33
v_mul_f32 v41, v37, v32
v_fma_f32 v38, v36, v32, -v40
v_fma_f32 v39, v36, v33, v41
v_cvt_pk_bf16_f32 v45, v38, v39
ds_write_b32 v11, v45 offset:6800
v_mul_f32 v40, v39, v33
v_mul_f32 v41, v39, v32
v_fma_f32 v36, v38, v32, -v40
v_fma_f32 v37, v38, v33, v41
v_cvt_pk_bf16_f32 v44, v36, v37
ds_write_b32 v11, v44 offset:7072
v_mul_f32 v40, v37, v33
v_mul_f32 v41, v37, v32
v_fma_f32 v38, v36, v32, -v40
v_fma_f32 v39, v36, v33, v41
v_cvt_pk_bf16_f32 v45, v38, v39
ds_write_b32 v11, v45 offset:7344
v_mul_f32 v40, v39, v33
v_mul_f32 v41, v39, v32
v_fma_f32 v36, v38, v32, -v40
v_fma_f32 v37, v38, v33, v41
v_cvt_pk_bf16_f32 v44, v36, v37
ds_write_b32 v11, v44 offset:7616
v_mul_f32 v40, v37, v33
v_mul_f32 v41, v37, v32
v_fma_f32 v38, v36, v32, -v40
v_fma_f32 v39, v36, v33, v41
v_cvt_pk_bf16_f32 v45, v38, v39
ds_write_b32 v11, v45 offset:7888
v_mul_f32 v40, v39, v33
v_mul_f32 v41, v39, v32
v_fma_f32 v36, v38, v32, -v40
v_fma_f32 v37, v38, v33, v41
v_cvt_pk_bf16_f32 v44, v36, v37
ds_write_b32 v11, v44 offset:8160
v_mul_f32 v40, v37, v33
v_mul_f32 v41, v37, v32
v_fma_f32 v38, v36, v32, -v40
v_fma_f32 v39, v36, v33, v41
v_cvt_pk_bf16_f32 v45, v38, v39
ds_write_b32 v11, v45 offset:8432
s_waitcnt lgkmcnt(0)
ds_read_b128 v[136:139], v14 offset:0
ds_read_b128 v[140:143], v14 offset:8704
ds_read_b128 v[144:147], v14 offset:32
ds_read_b128 v[148:151], v14 offset:8736
ds_read_b128 v[152:155], v14 offset:64
ds_read_b128 v[156:159], v14 offset:8768
ds_read_b128 v[160:163], v14 offset:96
ds_read_b128 v[164:167], v14 offset:8800
ds_read_b128 v[168:171], v14 offset:128
ds_read_b128 v[172:175], v14 offset:8832
ds_read_b128 v[176:179], v14 offset:160
ds_read_b128 v[180:183], v14 offset:8864
ds_read_b128 v[184:187], v14 offset:192
ds_read_b128 v[188:191], v14 offset:8896
ds_read_b128 v[192:195], v14 offset:224
ds_read_b128 v[196:199], v14 offset:8928
s_waitcnt lgkmcnt(14)
v_mfma_f32_32x32x16_bf16 v[100:115], v[136:139], v[140:143], v[100:115]
s_waitcnt lgkmcnt(12)
v_mfma_f32_32x32x16_bf16 v[100:115], v[144:147], v[148:151], v[100:115]
s_waitcnt lgkmcnt(10)
v_mfma_f32_32x32x16_bf16 v[100:115], v[152:155], v[156:159], v[100:115]
s_waitcnt lgkmcnt(8)
v_mfma_f32_32x32x16_bf16 v[100:115], v[160:163], v[164:167], v[100:115]
s_waitcnt lgkmcnt(6)
v_mfma_f32_32x32x16_bf16 v[100:115], v[168:171], v[172:175], v[100:115]
s_waitcnt lgkmcnt(4)
v_mfma_f32_32x32x16_bf16 v[100:115], v[176:179], v[180:183], v[100:115]
s_waitcnt lgkmcnt(2)
v_mfma_f32_32x32x16_bf16 v[100:115], v[184:187], v[188:191], v[100:115]
s_waitcnt lgkmcnt(0)
v_mfma_f32_32x32x16_bf16 v[100:115], v[192:195], v[196:199], v[100:115]
v_and_b32 v15, 3, v12
v_lshlrev_b32 v16, 1, v15
v_add_u32 v16, 256, v16
v_and_b32 v17, 1, v12
v_lshlrev_b32 v17, 2, v17
v_bfe_u32 v18, v12, 1, 1
v_lshl_add_u32 v17, v18, 8, v17
v_add_u32 v17, 512, v17
v_subrev_u32 v18, 12, v12
v_lshlrev_b32 v18, 8, v18
v_cmp_gt_u32 vcc, 16, v12
v_cmp_gt_u32 s[76:77], 12, v12
v_cmp_gt_u32 s[78:79], 8, v12
v_cndmask_b32 v18, v18, v17, vcc
v_cndmask_b32 v18, v18, v16, s[76:77]
v_cmp_gt_u32 vcc, 21, v12
v_cndmask_b32 v18, v18, v12, s[78:79]
v_lshlrev_b32 v18, 1, v18
v_lshl_add_u32 v18, v13, 6, v18
v_add_u32 v18, s81, v18
v_lshl_add_u32 v16, v0, 4, s81
v_cvt_pk_bf16_f32 v56, v100, v101
v_cvt_pk_bf16_f32 v57, v102, v103
v_cvt_pk_bf16_f32 v58, v104, v105
v_cvt_pk_bf16_f32 v59, v106, v107
v_cvt_pk_bf16_f32 v60, v108, v109
v_cvt_pk_bf16_f32 v61, v110, v111
v_cvt_pk_bf16_f32 v62, v112, v113
v_cvt_pk_bf16_f32 v63, v114, v115
s_and_saveexec_b64 s[76:77], vcc
ds_write_b16 v18, v56 offset:12928
ds_write_b16_d16_hi v18, v56 offset:12944
ds_write_b16 v18, v57 offset:12960
ds_write_b16_d16_hi v18, v57 offset:12976
ds_write_b16 v18, v58 offset:13056
ds_write_b16_d16_hi v18, v58 offset:13072
ds_write_b16 v18, v59 offset:13088
ds_write_b16_d16_hi v18, v59 offset:13104
ds_write_b16 v18, v60 offset:13184
ds_write_b16_d16_hi v18, v60 offset:13200
ds_write_b16 v18, v61 offset:13216
ds_write_b16_d16_hi v18, v61 offset:13232
ds_write_b16 v18, v62 offset:13312
ds_write_b16_d16_hi v18, v62 offset:13328
ds_write_b16 v18, v63 offset:13344
ds_write_b16_d16_hi v18, v63 offset:13360
s_mov_b64 exec, s[76:77]
s_waitcnt vmcnt(0)
ds_write_b128 v16, v[120:123] offset:8832
ds_write_b128 v16, v[124:127] offset:9856
ds_write_b128 v16, v[128:131] offset:10880
ds_write_b128 v16, v[132:135] offset:11904
v_mov_b32 v40, 0
v_mov_b32 v41, 0
v_mov_b32 v42, 0
v_mov_b32 v43, 0
v_cmp_gt_u32 vcc, 32, v0
s_and_saveexec_b64 s[76:77], vcc
ds_write_b128 v16, v[40:43] offset:8320
s_mov_b64 exec, 15
ds_write_b128 v16, v[40:43] offset:4096
ds_write_b128 v16, v[40:43] offset:8256
s_mov_b64 exec, s[76:77]
v_sub_u32 v17, 63, v0
v_lshl_add_u32 v17, v17, 4, s81
v_lshlrev_b32 v15, 3, v0
v_sub_u32 v15, 511, v15
v_subrev_u32 v20, 0, v15
v_subrev_u32 v21, 1, v15
v_subrev_u32 v22, 2, v15
v_subrev_u32 v23, 3, v15
v_subrev_u32 v24, 4, v15
v_subrev_u32 v25, 5, v15
v_subrev_u32 v26, 6, v15
v_subrev_u32 v27, 7, v15
v_subrev_u32 v28, 8, v15
v_max_i32 v28, 0, v28
v_cvt_f32_u32 v20, v20
v_cvt_f32_u32 v21, v21
v_cvt_f32_u32 v22, v22
v_cvt_f32_u32 v23, v23
v_cvt_f32_u32 v24, v24
v_cvt_f32_u32 v25, v25
v_cvt_f32_u32 v26, v26
v_cvt_f32_u32 v27, v27
v_cvt_f32_u32 v28, v28
v_cvt_pk_bf16_f32 v20, v20, v20
v_cvt_pk_bf16_f32 v21, v21, v21
v_cvt_pk_bf16_f32 v22, v22, v22
v_cvt_pk_bf16_f32 v23, v23, v23
v_cvt_pk_bf16_f32 v24, v24, v24
v_cvt_pk_bf16_f32 v25, v25, v25
v_cvt_pk_bf16_f32 v26, v26, v26
v_cvt_pk_bf16_f32 v27, v27, v27
v_cvt_pk_bf16_f32 v28, v28, v28
v_and_b32 v20, 0xffff0000, v20
v_and_b32 v21, 0xffff0000, v21
v_and_b32 v22, 0xffff0000, v22
v_and_b32 v23, 0xffff0000, v23
v_and_b32 v24, 0xffff0000, v24
v_and_b32 v25, 0xffff0000, v25
v_and_b32 v26, 0xffff0000, v26
v_and_b32 v27, 0xffff0000, v27
v_and_b32 v28, 0xffff0000, v28
v_cvt_u32_f32 v20, v20
v_cvt_u32_f32 v21, v21
v_cvt_u32_f32 v22, v22
v_cvt_u32_f32 v23, v23
v_cvt_u32_f32 v24, v24
v_cvt_u32_f32 v25, v25
v_cvt_u32_f32 v26, v26
v_cvt_u32_f32 v27, v27
v_cvt_u32_f32 v28, v28
v_lshl_add_u32 v20, v20, 1, s81
v_lshl_add_u32 v21, v21, 1, s81
v_lshl_add_u32 v22, v22, 1, s81
v_lshl_add_u32 v23, v23, 1, s81
v_lshl_add_u32 v24, v24, 1, s81
v_lshl_add_u32 v25, v25, 1, s81
v_lshl_add_u32 v26, v26, 1, s81
v_lshl_add_u32 v27, v27, 1, s81
v_lshl_add_u32 v28, v28, 1, s81
s_waitcnt lgkmcnt(0)
ds_read_u16 v60, v17 offset:16016
ds_read_u16 v61, v17 offset:16000
ds_read_u16 v62, v17 offset:14992
ds_read_u16 v63, v17 offset:14976
ds_read_u16 v64, v17 offset:13968
ds_read_u16 v65, v17 offset:13960
ds_read_u16 v66, v17 offset:13952
ds_read_u16 v30, v20 offset:12928
ds_read_u16 v31, v21 offset:12928
ds_read_u16 v32, v22 offset:12928
ds_read_u16 v33, v23 offset:12928
ds_read_u16 v34, v24 offset:12928
ds_read_u16 v35, v25 offset:12928
ds_read_u16 v36, v26 offset:12928
ds_read_u16 v37, v27 offset:12928
ds_read_u16 v38, v28 offset:12928
v_and_b32 v15, 1, v0
v_cmp_eq_u32 vcc, 0, v15
s_mov_b32 s74, 0x10001
s_waitcnt lgkmcnt(12)
v_cndmask_b32 v15, v61, v60, vcc
v_mul_u32_u24 v68, s74, v60
v_mul_u32_u24 v70, s74, v61
v_lshl_or_b32 v69, v15, 16, v60
v_lshl_or_b32 v73, v61, 16, v15
v_mov_b32 v71, v70
v_mov_b32 v72, v68
v_mov_b32 v74, v70
v_mov_b32 v75, v70
ds_write_b128 v16, v[68:71] offset:0
ds_write_b128 v16, v[72:75] offset:4160
v_cndmask_b32 v15, v63, v62, vcc
v_mul_u32_u24 v76, s74, v62
v_mul_u32_u24 v78, s74, v63
v_lshl_or_b32 v77, v15, 16, v62
v_lshl_or_b32 v81, v63, 16, v15
v_mov_b32 v79, v78
v_mov_b32 v80, v76
v_mov_b32 v82, v78
v_mov_b32 v83, v78
ds_write_b128 v16, v[76:79] offset:1024
ds_write_b128 v16, v[80:83] offset:5184
s_waitcnt lgkmcnt(13)
v_mul_u32_u24 v84, s74, v64
v_mul_u32_u24 v85, s74, v65
v_lshl_or_b32 v86, v66, 16, v65
v_mul_u32_u24 v87, s74, v66
v_lshl_or_b32 v88, v65, 16, v64
v_mov_b32 v89, v85
v_mov_b32 v90, v87
v_mov_b32 v91, v87
ds_write_b128 v16, v[84:87] offset:2048
ds_write_b128 v16, v[88:91] offset:6208
v_cmp_eq_u32 vcc, 63, v0
s_waitcnt lgkmcnt(6)
s_nop 0
v_cndmask_b32 v38, v38, 0, vcc
v_lshl_or_b32 v40, v31, 16, v30
v_lshl_or_b32 v41, v33, 16, v32
v_lshl_or_b32 v42, v35, 16, v34
v_lshl_or_b32 v43, v37, 16, v36
v_lshl_or_b32 v44, v32, 16, v31
v_lshl_or_b32 v45, v34, 16, v33
v_lshl_or_b32 v46, v36, 16, v35
v_lshl_or_b32 v47, v38, 16, v37
ds_write_b128 v16, v[40:43] offset:3072
ds_write_b128 v16, v[44:47] offset:7232
v_and_b32 v12, 15, v0
v_lshrrev_b32 v13, 4, v0
v_or_b32 v15, 1, v12
v_sub_u32 v15, 1775, v15
v_lshlrev_b32 v15, 1, v15
v_and_b32 v17, 1, v12
v_sub_u32 v17, 1, v17
v_mul_u32_u24 v17, 4160, v17
v_add3_u32 v15, v15, v17, s81
v_lshl_add_u32 v20, v13, 4, v15
v_subrev_u32 v21, 1024, v20
v_subrev_u32 v22, 2048, v20
v_subrev_u32 v23, 3072, v20
v_lshlrev_b32 v24, 5, v12
v_lshl_add_u32 v24, v13, 4, v24
v_add_u32 v24, s81, v24
v_add_u32 v24, 8800, v24
v_lshrrev_b32 v15, 3, v12
v_add_u32 v15, 2, v15
v_cmp_eq_u32 vcc, v15, v13
v_and_b32 v15, 1, v12
v_lshlrev_b32 v15, 4, v15
v_lshlrev_b32 v15, v15, v9
v_cndmask_b32 v15, 0, v15, vcc
v_bfe_u32 v17, v12, 1, 2
v_cmp_eq_u32 vcc, 0, v17
v_cmp_eq_u32 s[74:75], 1, v17
v_cmp_eq_u32 s[76:77], 2, v17
v_cmp_eq_u32 s[78:79], 3, v17
v_cndmask_b32 v28, 0, v15, vcc
v_cndmask_b32 v29, 0, v15, s[74:75]
v_cndmask_b32 v30, 0, v15, s[76:77]
v_cndmask_b32 v31, 0, v15, s[78:79]
v_and_b32 v15, 1, v13
v_lshlrev_b32 v1, 9, v15
v_lshl_add_u32 v1, v12, 5, v1
v_lshrrev_b32 v15, 1, v13
v_lshl_add_u32 v1, v15, 4, v1
s_waitcnt lgkmcnt(0)
ds_read_b128 v[96:99], v24 offset:0
ds_read2_b32 v[64:65], v20 offset0:128 offset1:129
ds_read2_b32 v[66:67], v20 offset0:130 offset1:131
ds_read_b128 v[100:103], v24 offset:512
ds_read2_b32 v[68:69], v20 offset0:0 offset1:1
ds_read2_b32 v[70:71], v20 offset0:2 offset1:3
ds_read_b128 v[104:107], v24 offset:1024
ds_read2_b32 v[72:73], v21 offset0:128 offset1:129
ds_read2_b32 v[74:75], v21 offset0:130 offset1:131
ds_read_b128 v[108:111], v24 offset:1536
ds_read2_b32 v[76:77], v21 offset0:0 offset1:1
ds_read2_b32 v[78:79], v21 offset0:2 offset1:3
ds_read_b128 v[112:115], v24 offset:2048
ds_read2_b32 v[80:81], v22 offset0:128 offset1:129
ds_read2_b32 v[82:83], v22 offset0:130 offset1:131
ds_read_b128 v[116:119], v24 offset:2560
ds_read2_b32 v[84:85], v22 offset0:0 offset1:1
ds_read2_b32 v[86:87], v22 offset0:2 offset1:3
ds_read_b128 v[120:123], v24 offset:3072
ds_read2_b32 v[88:89], v23 offset0:128 offset1:129
ds_read2_b32 v[90:91], v23 offset0:130 offset1:131
ds_read_b128 v[124:127], v24 offset:3584
ds_read2_b32 v[92:93], v23 offset0:0 offset1:1
ds_read2_b32 v[94:95], v23 offset0:2 offset1:3
s_waitcnt lgkmcnt(0)
v_mfma_f32_16x16x32_bf16 v[32:35], v[28:31], v[96:99], 0
v_mfma_f32_16x16x32_bf16 v[36:39], v[28:31], v[100:103], 0
v_mfma_f32_16x16x32_bf16 v[40:43], v[28:31], v[104:107], 0
v_mfma_f32_16x16x32_bf16 v[44:47], v[28:31], v[108:111], 0
v_mfma_f32_16x16x32_bf16 v[48:51], v[28:31], v[112:115], 0
v_mfma_f32_16x16x32_bf16 v[52:55], v[28:31], v[116:119], 0
v_mfma_f32_16x16x32_bf16 v[56:59], v[28:31], v[120:123], 0
v_mfma_f32_16x16x32_bf16 v[60:63], v[28:31], v[124:127], 0
v_mfma_f32_16x16x32_bf16 v[32:35], v[64:67], v[96:99], v[32:35]
v_subrev_u32 v20, 64, v20
v_mfma_f32_16x16x32_bf16 v[36:39], v[64:67], v[100:103], v[36:39]
v_subrev_u32 v21, 64, v21
v_mfma_f32_16x16x32_bf16 v[40:43], v[64:67], v[104:107], v[40:43]
v_subrev_u32 v22, 64, v22
v_mfma_f32_16x16x32_bf16 v[44:47], v[64:67], v[108:111], v[44:47]
v_subrev_u32 v23, 64, v23
v_mfma_f32_16x16x32_bf16 v[48:51], v[64:67], v[112:115], v[48:51]
v_subrev_u32 v24, 64, v24
v_mfma_f32_16x16x32_bf16 v[52:55], v[64:67], v[116:119], v[52:55]
ds_read_b128 v[160:163], v24 offset:0
v_mfma_f32_16x16x32_bf16 v[56:59], v[64:67], v[120:123], v[56:59]
ds_read2_b32 v[128:129], v20 offset0:128 offset1:129
v_mfma_f32_16x16x32_bf16 v[60:63], v[64:67], v[124:127], v[60:63]
ds_read2_b32 v[130:131], v20 offset0:130 offset1:131
v_mfma_f32_16x16x32_bf16 v[36:39], v[68:71], v[96:99], v[36:39]
ds_read_b128 v[164:167], v24 offset:512
v_mfma_f32_16x16x32_bf16 v[40:43], v[68:71], v[100:103], v[40:43]
ds_read2_b32 v[132:133], v20 offset0:0 offset1:1
v_mfma_f32_16x16x32_bf16 v[44:47], v[68:71], v[104:107], v[44:47]
ds_read2_b32 v[134:135], v20 offset0:2 offset1:3
v_mfma_f32_16x16x32_bf16 v[48:51], v[68:71], v[108:111], v[48:51]
ds_read_b128 v[168:171], v24 offset:1024
v_mfma_f32_16x16x32_bf16 v[52:55], v[68:71], v[112:115], v[52:55]
ds_read2_b32 v[136:137], v21 offset0:128 offset1:129
v_mfma_f32_16x16x32_bf16 v[56:59], v[68:71], v[116:119], v[56:59]
ds_read2_b32 v[138:139], v21 offset0:130 offset1:131
v_mfma_f32_16x16x32_bf16 v[60:63], v[68:71], v[120:123], v[60:63]
ds_read_b128 v[172:175], v24 offset:1536
v_mfma_f32_16x16x32_bf16 v[40:43], v[72:75], v[96:99], v[40:43]
ds_read2_b32 v[140:141], v21 offset0:0 offset1:1
v_mfma_f32_16x16x32_bf16 v[44:47], v[72:75], v[100:103], v[44:47]
ds_read2_b32 v[142:143], v21 offset0:2 offset1:3
v_mfma_f32_16x16x32_bf16 v[48:51], v[72:75], v[104:107], v[48:51]
ds_read_b128 v[176:179], v24 offset:2048
v_mfma_f32_16x16x32_bf16 v[52:55], v[72:75], v[108:111], v[52:55]
ds_read2_b32 v[144:145], v22 offset0:128 offset1:129
v_mfma_f32_16x16x32_bf16 v[56:59], v[72:75], v[112:115], v[56:59]
ds_read2_b32 v[146:147], v22 offset0:130 offset1:131
v_mfma_f32_16x16x32_bf16 v[60:63], v[72:75], v[116:119], v[60:63]
ds_read_b128 v[180:183], v24 offset:2560
v_mfma_f32_16x16x32_bf16 v[44:47], v[76:79], v[96:99], v[44:47]
ds_read2_b32 v[148:149], v22 offset0:0 offset1:1
v_mfma_f32_16x16x32_bf16 v[48:51], v[76:79], v[100:103], v[48:51]
ds_read2_b32 v[150:151], v22 offset0:2 offset1:3
v_mfma_f32_16x16x32_bf16 v[52:55], v[76:79], v[104:107], v[52:55]
ds_read_b128 v[184:187], v24 offset:3072
v_mfma_f32_16x16x32_bf16 v[56:59], v[76:79], v[108:111], v[56:59]
ds_read2_b32 v[152:153], v23 offset0:128 offset1:129
v_mfma_f32_16x16x32_bf16 v[60:63], v[76:79], v[112:115], v[60:63]
ds_read2_b32 v[154:155], v23 offset0:130 offset1:131
v_mfma_f32_16x16x32_bf16 v[48:51], v[80:83], v[96:99], v[48:51]
ds_read_b128 v[188:191], v24 offset:3584
v_mfma_f32_16x16x32_bf16 v[52:55], v[80:83], v[100:103], v[52:55]
ds_read2_b32 v[156:157], v23 offset0:0 offset1:1
v_mfma_f32_16x16x32_bf16 v[56:59], v[80:83], v[104:107], v[56:59]
ds_read2_b32 v[158:159], v23 offset0:2 offset1:3
v_mfma_f32_16x16x32_bf16 v[60:63], v[80:83], v[108:111], v[60:63]
v_mfma_f32_16x16x32_bf16 v[52:55], v[84:87], v[96:99], v[52:55]
v_mfma_f32_16x16x32_bf16 v[56:59], v[84:87], v[100:103], v[56:59]
v_mfma_f32_16x16x32_bf16 v[60:63], v[84:87], v[104:107], v[60:63]
v_mfma_f32_16x16x32_bf16 v[56:59], v[88:91], v[96:99], v[56:59]
v_mfma_f32_16x16x32_bf16 v[60:63], v[88:91], v[100:103], v[60:63]
v_mfma_f32_16x16x32_bf16 v[60:63], v[92:95], v[96:99], v[60:63]
s_waitcnt lgkmcnt(0)
v_mfma_f32_16x16x32_bf16 v[32:35], v[128:131], v[160:163], v[32:35]
v_subrev_u32 v20, 64, v20
v_mfma_f32_16x16x32_bf16 v[36:39], v[128:131], v[164:167], v[36:39]
v_subrev_u32 v21, 64, v21
v_mfma_f32_16x16x32_bf16 v[40:43], v[128:131], v[168:171], v[40:43]
v_subrev_u32 v22, 64, v22
v_mfma_f32_16x16x32_bf16 v[44:47], v[128:131], v[172:175], v[44:47]
v_subrev_u32 v23, 64, v23
v_mfma_f32_16x16x32_bf16 v[48:51], v[128:131], v[176:179], v[48:51]
v_subrev_u32 v24, 64, v24
v_mfma_f32_16x16x32_bf16 v[52:55], v[128:131], v[180:183], v[52:55]
ds_read_b128 v[96:99], v24 offset:0
v_mfma_f32_16x16x32_bf16 v[56:59], v[128:131], v[184:187], v[56:59]
ds_read2_b32 v[64:65], v20 offset0:128 offset1:129
v_mfma_f32_16x16x32_bf16 v[60:63], v[128:131], v[188:191], v[60:63]
ds_read2_b32 v[66:67], v20 offset0:130 offset1:131
v_mfma_f32_16x16x32_bf16 v[36:39], v[132:135], v[160:163], v[36:39]
ds_read_b128 v[100:103], v24 offset:512
v_mfma_f32_16x16x32_bf16 v[40:43], v[132:135], v[164:167], v[40:43]
ds_read2_b32 v[68:69], v20 offset0:0 offset1:1
v_mfma_f32_16x16x32_bf16 v[44:47], v[132:135], v[168:171], v[44:47]
ds_read2_b32 v[70:71], v20 offset0:2 offset1:3
v_mfma_f32_16x16x32_bf16 v[48:51], v[132:135], v[172:175], v[48:51]
ds_read_b128 v[104:107], v24 offset:1024
v_mfma_f32_16x16x32_bf16 v[52:55], v[132:135], v[176:179], v[52:55]
ds_read2_b32 v[72:73], v21 offset0:128 offset1:129
v_mfma_f32_16x16x32_bf16 v[56:59], v[132:135], v[180:183], v[56:59]
ds_read2_b32 v[74:75], v21 offset0:130 offset1:131
v_mfma_f32_16x16x32_bf16 v[60:63], v[132:135], v[184:187], v[60:63]
ds_read_b128 v[108:111], v24 offset:1536
v_mfma_f32_16x16x32_bf16 v[40:43], v[136:139], v[160:163], v[40:43]
ds_read2_b32 v[76:77], v21 offset0:0 offset1:1
v_mfma_f32_16x16x32_bf16 v[44:47], v[136:139], v[164:167], v[44:47]
ds_read2_b32 v[78:79], v21 offset0:2 offset1:3
v_mfma_f32_16x16x32_bf16 v[48:51], v[136:139], v[168:171], v[48:51]
ds_read_b128 v[112:115], v24 offset:2048
v_mfma_f32_16x16x32_bf16 v[52:55], v[136:139], v[172:175], v[52:55]
ds_read2_b32 v[80:81], v22 offset0:128 offset1:129
v_mfma_f32_16x16x32_bf16 v[56:59], v[136:139], v[176:179], v[56:59]
ds_read2_b32 v[82:83], v22 offset0:130 offset1:131
v_mfma_f32_16x16x32_bf16 v[60:63], v[136:139], v[180:183], v[60:63]
ds_read_b128 v[116:119], v24 offset:2560
v_mfma_f32_16x16x32_bf16 v[44:47], v[140:143], v[160:163], v[44:47]
ds_read2_b32 v[84:85], v22 offset0:0 offset1:1
v_mfma_f32_16x16x32_bf16 v[48:51], v[140:143], v[164:167], v[48:51]
ds_read2_b32 v[86:87], v22 offset0:2 offset1:3
v_mfma_f32_16x16x32_bf16 v[52:55], v[140:143], v[168:171], v[52:55]
ds_read_b128 v[120:123], v24 offset:3072
v_mfma_f32_16x16x32_bf16 v[56:59], v[140:143], v[172:175], v[56:59]
ds_read2_b32 v[88:89], v23 offset0:128 offset1:129
v_mfma_f32_16x16x32_bf16 v[60:63], v[140:143], v[176:179], v[60:63]
ds_read2_b32 v[90:91], v23 offset0:130 offset1:131
v_mfma_f32_16x16x32_bf16 v[48:51], v[144:147], v[160:163], v[48:51]
ds_read_b128 v[124:127], v24 offset:3584
v_mfma_f32_16x16x32_bf16 v[52:55], v[144:147], v[164:167], v[52:55]
ds_read2_b32 v[92:93], v23 offset0:0 offset1:1
v_mfma_f32_16x16x32_bf16 v[56:59], v[144:147], v[168:171], v[56:59]
ds_read2_b32 v[94:95], v23 offset0:2 offset1:3
v_mfma_f32_16x16x32_bf16 v[60:63], v[144:147], v[172:175], v[60:63]
v_mfma_f32_16x16x32_bf16 v[52:55], v[148:151], v[160:163], v[52:55]
v_mfma_f32_16x16x32_bf16 v[56:59], v[148:151], v[164:167], v[56:59]
v_mfma_f32_16x16x32_bf16 v[60:63], v[148:151], v[168:171], v[60:63]
v_mfma_f32_16x16x32_bf16 v[56:59], v[152:155], v[160:163], v[56:59]
v_mfma_f32_16x16x32_bf16 v[60:63], v[152:155], v[164:167], v[60:63]
v_mfma_f32_16x16x32_bf16 v[60:63], v[156:159], v[160:163], v[60:63]
s_waitcnt lgkmcnt(0)
v_mfma_f32_16x16x32_bf16 v[32:35], v[64:67], v[96:99], v[32:35]
v_subrev_u32 v20, 64, v20
v_mfma_f32_16x16x32_bf16 v[36:39], v[64:67], v[100:103], v[36:39]
v_subrev_u32 v21, 64, v21
v_mfma_f32_16x16x32_bf16 v[40:43], v[64:67], v[104:107], v[40:43]
v_subrev_u32 v22, 64, v22
v_mfma_f32_16x16x32_bf16 v[44:47], v[64:67], v[108:111], v[44:47]
v_subrev_u32 v23, 64, v23
v_mfma_f32_16x16x32_bf16 v[48:51], v[64:67], v[112:115], v[48:51]
v_subrev_u32 v24, 64, v24
v_mfma_f32_16x16x32_bf16 v[52:55], v[64:67], v[116:119], v[52:55]
ds_read_b128 v[160:163], v24 offset:0
v_mfma_f32_16x16x32_bf16 v[56:59], v[64:67], v[120:123], v[56:59]
ds_read2_b32 v[128:129], v20 offset0:128 offset1:129
v_mfma_f32_16x16x32_bf16 v[60:63], v[64:67], v[124:127], v[60:63]
ds_read2_b32 v[130:131], v20 offset0:130 offset1:131
v_mfma_f32_16x16x32_bf16 v[36:39], v[68:71], v[96:99], v[36:39]
ds_read_b128 v[164:167], v24 offset:512
v_mfma_f32_16x16x32_bf16 v[40:43], v[68:71], v[100:103], v[40:43]
ds_read2_b32 v[132:133], v20 offset0:0 offset1:1
v_mfma_f32_16x16x32_bf16 v[44:47], v[68:71], v[104:107], v[44:47]
ds_read2_b32 v[134:135], v20 offset0:2 offset1:3
v_mfma_f32_16x16x32_bf16 v[48:51], v[68:71], v[108:111], v[48:51]
ds_read_b128 v[168:171], v24 offset:1024
v_mfma_f32_16x16x32_bf16 v[52:55], v[68:71], v[112:115], v[52:55]
ds_read2_b32 v[136:137], v21 offset0:128 offset1:129
v_mfma_f32_16x16x32_bf16 v[56:59], v[68:71], v[116:119], v[56:59]
ds_read2_b32 v[138:139], v21 offset0:130 offset1:131
v_mfma_f32_16x16x32_bf16 v[60:63], v[68:71], v[120:123], v[60:63]
ds_read_b128 v[172:175], v24 offset:1536
v_mfma_f32_16x16x32_bf16 v[40:43], v[72:75], v[96:99], v[40:43]
ds_read2_b32 v[140:141], v21 offset0:0 offset1:1
v_mfma_f32_16x16x32_bf16 v[44:47], v[72:75], v[100:103], v[44:47]
ds_read2_b32 v[142:143], v21 offset0:2 offset1:3
v_mfma_f32_16x16x32_bf16 v[48:51], v[72:75], v[104:107], v[48:51]
ds_read_b128 v[176:179], v24 offset:2048
v_mfma_f32_16x16x32_bf16 v[52:55], v[72:75], v[108:111], v[52:55]
ds_read2_b32 v[144:145], v22 offset0:128 offset1:129
v_mfma_f32_16x16x32_bf16 v[56:59], v[72:75], v[112:115], v[56:59]
ds_read2_b32 v[146:147], v22 offset0:130 offset1:131
v_mfma_f32_16x16x32_bf16 v[60:63], v[72:75], v[116:119], v[60:63]
ds_read_b128 v[180:183], v24 offset:2560
v_mfma_f32_16x16x32_bf16 v[44:47], v[76:79], v[96:99], v[44:47]
ds_read2_b32 v[148:149], v22 offset0:0 offset1:1
v_mfma_f32_16x16x32_bf16 v[48:51], v[76:79], v[100:103], v[48:51]
ds_read2_b32 v[150:151], v22 offset0:2 offset1:3
v_mfma_f32_16x16x32_bf16 v[52:55], v[76:79], v[104:107], v[52:55]
ds_read_b128 v[184:187], v24 offset:3072
v_mfma_f32_16x16x32_bf16 v[56:59], v[76:79], v[108:111], v[56:59]
ds_read2_b32 v[152:153], v23 offset0:128 offset1:129
v_mfma_f32_16x16x32_bf16 v[60:63], v[76:79], v[112:115], v[60:63]
ds_read2_b32 v[154:155], v23 offset0:130 offset1:131
v_mfma_f32_16x16x32_bf16 v[48:51], v[80:83], v[96:99], v[48:51]
ds_read_b128 v[188:191], v24 offset:3584
v_mfma_f32_16x16x32_bf16 v[52:55], v[80:83], v[100:103], v[52:55]
ds_read2_b32 v[156:157], v23 offset0:0 offset1:1
v_mfma_f32_16x16x32_bf16 v[56:59], v[80:83], v[104:107], v[56:59]
ds_read2_b32 v[158:159], v23 offset0:2 offset1:3
v_mfma_f32_16x16x32_bf16 v[60:63], v[80:83], v[108:111], v[60:63]
v_mfma_f32_16x16x32_bf16 v[52:55], v[84:87], v[96:99], v[52:55]
v_mfma_f32_16x16x32_bf16 v[56:59], v[84:87], v[100:103], v[56:59]
v_mfma_f32_16x16x32_bf16 v[60:63], v[84:87], v[104:107], v[60:63]
v_mfma_f32_16x16x32_bf16 v[56:59], v[88:91], v[96:99], v[56:59]
v_mfma_f32_16x16x32_bf16 v[60:63], v[88:91], v[100:103], v[60:63]
v_mfma_f32_16x16x32_bf16 v[60:63], v[92:95], v[96:99], v[60:63]
s_waitcnt lgkmcnt(0)
v_mfma_f32_16x16x32_bf16 v[32:35], v[128:131], v[160:163], v[32:35]
v_subrev_u32 v20, 64, v20
v_mfma_f32_16x16x32_bf16 v[36:39], v[128:131], v[164:167], v[36:39]
v_subrev_u32 v21, 64, v21
v_mfma_f32_16x16x32_bf16 v[40:43], v[128:131], v[168:171], v[40:43]
v_subrev_u32 v22, 64, v22
v_mfma_f32_16x16x32_bf16 v[44:47], v[128:131], v[172:175], v[44:47]
v_subrev_u32 v23, 64, v23
v_mfma_f32_16x16x32_bf16 v[48:51], v[128:131], v[176:179], v[48:51]
v_subrev_u32 v24, 64, v24
v_mfma_f32_16x16x32_bf16 v[52:55], v[128:131], v[180:183], v[52:55]
ds_read_b128 v[96:99], v24 offset:0
v_mfma_f32_16x16x32_bf16 v[56:59], v[128:131], v[184:187], v[56:59]
ds_read2_b32 v[64:65], v20 offset0:128 offset1:129
v_mfma_f32_16x16x32_bf16 v[60:63], v[128:131], v[188:191], v[60:63]
ds_read2_b32 v[66:67], v20 offset0:130 offset1:131
v_mfma_f32_16x16x32_bf16 v[36:39], v[132:135], v[160:163], v[36:39]
ds_read_b128 v[100:103], v24 offset:512
v_mfma_f32_16x16x32_bf16 v[40:43], v[132:135], v[164:167], v[40:43]
ds_read2_b32 v[68:69], v20 offset0:0 offset1:1
v_mfma_f32_16x16x32_bf16 v[44:47], v[132:135], v[168:171], v[44:47]
ds_read2_b32 v[70:71], v20 offset0:2 offset1:3
v_mfma_f32_16x16x32_bf16 v[48:51], v[132:135], v[172:175], v[48:51]
ds_read_b128 v[104:107], v24 offset:1024
v_mfma_f32_16x16x32_bf16 v[52:55], v[132:135], v[176:179], v[52:55]
ds_read2_b32 v[72:73], v21 offset0:128 offset1:129
v_mfma_f32_16x16x32_bf16 v[56:59], v[132:135], v[180:183], v[56:59]
ds_read2_b32 v[74:75], v21 offset0:130 offset1:131
v_mfma_f32_16x16x32_bf16 v[60:63], v[132:135], v[184:187], v[60:63]
ds_read_b128 v[108:111], v24 offset:1536
v_mfma_f32_16x16x32_bf16 v[40:43], v[136:139], v[160:163], v[40:43]
ds_read2_b32 v[76:77], v21 offset0:0 offset1:1
v_mfma_f32_16x16x32_bf16 v[44:47], v[136:139], v[164:167], v[44:47]
ds_read2_b32 v[78:79], v21 offset0:2 offset1:3
v_mfma_f32_16x16x32_bf16 v[48:51], v[136:139], v[168:171], v[48:51]
ds_read_b128 v[112:115], v24 offset:2048
v_mfma_f32_16x16x32_bf16 v[52:55], v[136:139], v[172:175], v[52:55]
ds_read2_b32 v[80:81], v22 offset0:128 offset1:129
v_mfma_f32_16x16x32_bf16 v[56:59], v[136:139], v[176:179], v[56:59]
ds_read2_b32 v[82:83], v22 offset0:130 offset1:131
v_mfma_f32_16x16x32_bf16 v[60:63], v[136:139], v[180:183], v[60:63]
ds_read_b128 v[116:119], v24 offset:2560
v_mfma_f32_16x16x32_bf16 v[44:47], v[140:143], v[160:163], v[44:47]
ds_read2_b32 v[84:85], v22 offset0:0 offset1:1
v_mfma_f32_16x16x32_bf16 v[48:51], v[140:143], v[164:167], v[48:51]
ds_read2_b32 v[86:87], v22 offset0:2 offset1:3
v_mfma_f32_16x16x32_bf16 v[52:55], v[140:143], v[168:171], v[52:55]
ds_read_b128 v[120:123], v24 offset:3072
v_mfma_f32_16x16x32_bf16 v[56:59], v[140:143], v[172:175], v[56:59]
ds_read2_b32 v[88:89], v23 offset0:128 offset1:129
v_mfma_f32_16x16x32_bf16 v[60:63], v[140:143], v[176:179], v[60:63]
ds_read2_b32 v[90:91], v23 offset0:130 offset1:131
v_mfma_f32_16x16x32_bf16 v[48:51], v[144:147], v[160:163], v[48:51]
ds_read_b128 v[124:127], v24 offset:3584
v_mfma_f32_16x16x32_bf16 v[52:55], v[144:147], v[164:167], v[52:55]
ds_read2_b32 v[92:93], v23 offset0:0 offset1:1
v_mfma_f32_16x16x32_bf16 v[56:59], v[144:147], v[168:171], v[56:59]
ds_read2_b32 v[94:95], v23 offset0:2 offset1:3
v_mfma_f32_16x16x32_bf16 v[60:63], v[144:147], v[172:175], v[60:63]
v_mfma_f32_16x16x32_bf16 v[52:55], v[148:151], v[160:163], v[52:55]
v_mfma_f32_16x16x32_bf16 v[56:59], v[148:151], v[164:167], v[56:59]
v_mfma_f32_16x16x32_bf16 v[60:63], v[148:151], v[168:171], v[60:63]
v_mfma_f32_16x16x32_bf16 v[56:59], v[152:155], v[160:163], v[56:59]
v_mfma_f32_16x16x32_bf16 v[60:63], v[152:155], v[164:167], v[60:63]
v_mfma_f32_16x16x32_bf16 v[60:63], v[156:159], v[160:163], v[60:63]
s_waitcnt lgkmcnt(0)
v_mfma_f32_16x16x32_bf16 v[32:35], v[64:67], v[96:99], v[32:35]
v_subrev_u32 v20, 64, v20
v_mfma_f32_16x16x32_bf16 v[36:39], v[64:67], v[100:103], v[36:39]
v_subrev_u32 v21, 64, v21
v_mfma_f32_16x16x32_bf16 v[40:43], v[64:67], v[104:107], v[40:43]
v_subrev_u32 v22, 64, v22
v_mfma_f32_16x16x32_bf16 v[44:47], v[64:67], v[108:111], v[44:47]
v_subrev_u32 v23, 64, v23
v_mfma_f32_16x16x32_bf16 v[48:51], v[64:67], v[112:115], v[48:51]
v_subrev_u32 v24, 64, v24
v_mfma_f32_16x16x32_bf16 v[52:55], v[64:67], v[116:119], v[52:55]
ds_read_b128 v[160:163], v24 offset:0
v_mfma_f32_16x16x32_bf16 v[56:59], v[64:67], v[120:123], v[56:59]
ds_read2_b32 v[128:129], v20 offset0:128 offset1:129
v_mfma_f32_16x16x32_bf16 v[60:63], v[64:67], v[124:127], v[60:63]
ds_read2_b32 v[130:131], v20 offset0:130 offset1:131
v_mfma_f32_16x16x32_bf16 v[36:39], v[68:71], v[96:99], v[36:39]
ds_read_b128 v[164:167], v24 offset:512
v_mfma_f32_16x16x32_bf16 v[40:43], v[68:71], v[100:103], v[40:43]
ds_read2_b32 v[132:133], v20 offset0:0 offset1:1
v_mfma_f32_16x16x32_bf16 v[44:47], v[68:71], v[104:107], v[44:47]
ds_read2_b32 v[134:135], v20 offset0:2 offset1:3
v_mfma_f32_16x16x32_bf16 v[48:51], v[68:71], v[108:111], v[48:51]
ds_read_b128 v[168:171], v24 offset:1024
v_mfma_f32_16x16x32_bf16 v[52:55], v[68:71], v[112:115], v[52:55]
ds_read2_b32 v[136:137], v21 offset0:128 offset1:129
v_mfma_f32_16x16x32_bf16 v[56:59], v[68:71], v[116:119], v[56:59]
ds_read2_b32 v[138:139], v21 offset0:130 offset1:131
v_mfma_f32_16x16x32_bf16 v[60:63], v[68:71], v[120:123], v[60:63]
ds_read_b128 v[172:175], v24 offset:1536
v_mfma_f32_16x16x32_bf16 v[40:43], v[72:75], v[96:99], v[40:43]
ds_read2_b32 v[140:141], v21 offset0:0 offset1:1
v_mfma_f32_16x16x32_bf16 v[44:47], v[72:75], v[100:103], v[44:47]
ds_read2_b32 v[142:143], v21 offset0:2 offset1:3
v_mfma_f32_16x16x32_bf16 v[48:51], v[72:75], v[104:107], v[48:51]
ds_read_b128 v[176:179], v24 offset:2048
v_mfma_f32_16x16x32_bf16 v[52:55], v[72:75], v[108:111], v[52:55]
ds_read2_b32 v[144:145], v22 offset0:128 offset1:129
v_mfma_f32_16x16x32_bf16 v[56:59], v[72:75], v[112:115], v[56:59]
ds_read2_b32 v[146:147], v22 offset0:130 offset1:131
v_mfma_f32_16x16x32_bf16 v[60:63], v[72:75], v[116:119], v[60:63]
ds_read_b128 v[180:183], v24 offset:2560
v_mfma_f32_16x16x32_bf16 v[44:47], v[76:79], v[96:99], v[44:47]
ds_read2_b32 v[148:149], v22 offset0:0 offset1:1
v_mfma_f32_16x16x32_bf16 v[48:51], v[76:79], v[100:103], v[48:51]
ds_read2_b32 v[150:151], v22 offset0:2 offset1:3
v_mfma_f32_16x16x32_bf16 v[52:55], v[76:79], v[104:107], v[52:55]
ds_read_b128 v[184:187], v24 offset:3072
v_mfma_f32_16x16x32_bf16 v[56:59], v[76:79], v[108:111], v[56:59]
ds_read2_b32 v[152:153], v23 offset0:128 offset1:129
v_mfma_f32_16x16x32_bf16 v[60:63], v[76:79], v[112:115], v[60:63]
ds_read2_b32 v[154:155], v23 offset0:130 offset1:131
v_mfma_f32_16x16x32_bf16 v[48:51], v[80:83], v[96:99], v[48:51]
ds_read_b128 v[188:191], v24 offset:3584
v_mfma_f32_16x16x32_bf16 v[52:55], v[80:83], v[100:103], v[52:55]
ds_read2_b32 v[156:157], v23 offset0:0 offset1:1
v_mfma_f32_16x16x32_bf16 v[56:59], v[80:83], v[104:107], v[56:59]
ds_read2_b32 v[158:159], v23 offset0:2 offset1:3
v_mfma_f32_16x16x32_bf16 v[60:63], v[80:83], v[108:111], v[60:63]
v_mfma_f32_16x16x32_bf16 v[52:55], v[84:87], v[96:99], v[52:55]
v_mfma_f32_16x16x32_bf16 v[56:59], v[84:87], v[100:103], v[56:59]
v_mfma_f32_16x16x32_bf16 v[60:63], v[84:87], v[104:107], v[60:63]
v_mfma_f32_16x16x32_bf16 v[56:59], v[88:91], v[96:99], v[56:59]
v_mfma_f32_16x16x32_bf16 v[60:63], v[88:91], v[100:103], v[60:63]
v_mfma_f32_16x16x32_bf16 v[60:63], v[92:95], v[96:99], v[60:63]
s_waitcnt lgkmcnt(0)
v_mfma_f32_16x16x32_bf16 v[32:35], v[128:131], v[160:163], v[32:35]
v_subrev_u32 v20, 64, v20
v_mfma_f32_16x16x32_bf16 v[36:39], v[128:131], v[164:167], v[36:39]
v_subrev_u32 v21, 64, v21
v_mfma_f32_16x16x32_bf16 v[40:43], v[128:131], v[168:171], v[40:43]
v_subrev_u32 v22, 64, v22
v_mfma_f32_16x16x32_bf16 v[44:47], v[128:131], v[172:175], v[44:47]
v_subrev_u32 v23, 64, v23
v_mfma_f32_16x16x32_bf16 v[48:51], v[128:131], v[176:179], v[48:51]
v_subrev_u32 v24, 64, v24
v_mfma_f32_16x16x32_bf16 v[52:55], v[128:131], v[180:183], v[52:55]
ds_read_b128 v[96:99], v24 offset:0
v_mfma_f32_16x16x32_bf16 v[56:59], v[128:131], v[184:187], v[56:59]
ds_read2_b32 v[64:65], v20 offset0:128 offset1:129
v_mfma_f32_16x16x32_bf16 v[60:63], v[128:131], v[188:191], v[60:63]
ds_read2_b32 v[66:67], v20 offset0:130 offset1:131
v_mfma_f32_16x16x32_bf16 v[36:39], v[132:135], v[160:163], v[36:39]
ds_read_b128 v[100:103], v24 offset:512
v_mfma_f32_16x16x32_bf16 v[40:43], v[132:135], v[164:167], v[40:43]
ds_read2_b32 v[68:69], v20 offset0:0 offset1:1
v_mfma_f32_16x16x32_bf16 v[44:47], v[132:135], v[168:171], v[44:47]
ds_read2_b32 v[70:71], v20 offset0:2 offset1:3
v_mfma_f32_16x16x32_bf16 v[48:51], v[132:135], v[172:175], v[48:51]
ds_read_b128 v[104:107], v24 offset:1024
v_mfma_f32_16x16x32_bf16 v[52:55], v[132:135], v[176:179], v[52:55]
ds_read2_b32 v[72:73], v21 offset0:128 offset1:129
v_mfma_f32_16x16x32_bf16 v[56:59], v[132:135], v[180:183], v[56:59]
ds_read2_b32 v[74:75], v21 offset0:130 offset1:131
v_mfma_f32_16x16x32_bf16 v[60:63], v[132:135], v[184:187], v[60:63]
ds_read_b128 v[108:111], v24 offset:1536
v_mfma_f32_16x16x32_bf16 v[40:43], v[136:139], v[160:163], v[40:43]
ds_read2_b32 v[76:77], v21 offset0:0 offset1:1
v_mfma_f32_16x16x32_bf16 v[44:47], v[136:139], v[164:167], v[44:47]
ds_read2_b32 v[78:79], v21 offset0:2 offset1:3
v_mfma_f32_16x16x32_bf16 v[48:51], v[136:139], v[168:171], v[48:51]
ds_read_b128 v[112:115], v24 offset:2048
v_mfma_f32_16x16x32_bf16 v[52:55], v[136:139], v[172:175], v[52:55]
ds_read2_b32 v[80:81], v22 offset0:128 offset1:129
v_mfma_f32_16x16x32_bf16 v[56:59], v[136:139], v[176:179], v[56:59]
ds_read2_b32 v[82:83], v22 offset0:130 offset1:131
v_mfma_f32_16x16x32_bf16 v[60:63], v[136:139], v[180:183], v[60:63]
ds_read_b128 v[116:119], v24 offset:2560
v_mfma_f32_16x16x32_bf16 v[44:47], v[140:143], v[160:163], v[44:47]
ds_read2_b32 v[84:85], v22 offset0:0 offset1:1
v_mfma_f32_16x16x32_bf16 v[48:51], v[140:143], v[164:167], v[48:51]
ds_read2_b32 v[86:87], v22 offset0:2 offset1:3
v_mfma_f32_16x16x32_bf16 v[52:55], v[140:143], v[168:171], v[52:55]
ds_read_b128 v[120:123], v24 offset:3072
v_mfma_f32_16x16x32_bf16 v[56:59], v[140:143], v[172:175], v[56:59]
ds_read2_b32 v[88:89], v23 offset0:128 offset1:129
v_mfma_f32_16x16x32_bf16 v[60:63], v[140:143], v[176:179], v[60:63]
ds_read2_b32 v[90:91], v23 offset0:130 offset1:131
v_mfma_f32_16x16x32_bf16 v[48:51], v[144:147], v[160:163], v[48:51]
ds_read_b128 v[124:127], v24 offset:3584
v_mfma_f32_16x16x32_bf16 v[52:55], v[144:147], v[164:167], v[52:55]
ds_read2_b32 v[92:93], v23 offset0:0 offset1:1
v_mfma_f32_16x16x32_bf16 v[56:59], v[144:147], v[168:171], v[56:59]
ds_read2_b32 v[94:95], v23 offset0:2 offset1:3
v_mfma_f32_16x16x32_bf16 v[60:63], v[144:147], v[172:175], v[60:63]
v_mfma_f32_16x16x32_bf16 v[52:55], v[148:151], v[160:163], v[52:55]
v_mfma_f32_16x16x32_bf16 v[56:59], v[148:151], v[164:167], v[56:59]
v_mfma_f32_16x16x32_bf16 v[60:63], v[148:151], v[168:171], v[60:63]
v_mfma_f32_16x16x32_bf16 v[56:59], v[152:155], v[160:163], v[56:59]
v_mfma_f32_16x16x32_bf16 v[60:63], v[152:155], v[164:167], v[60:63]
v_mfma_f32_16x16x32_bf16 v[60:63], v[156:159], v[160:163], v[60:63]
s_waitcnt lgkmcnt(0)
v_mfma_f32_16x16x32_bf16 v[32:35], v[64:67], v[96:99], v[32:35]
v_subrev_u32 v20, 64, v20
v_mfma_f32_16x16x32_bf16 v[36:39], v[64:67], v[100:103], v[36:39]
v_subrev_u32 v21, 64, v21
v_mfma_f32_16x16x32_bf16 v[40:43], v[64:67], v[104:107], v[40:43]
v_subrev_u32 v22, 64, v22
v_mfma_f32_16x16x32_bf16 v[44:47], v[64:67], v[108:111], v[44:47]
v_subrev_u32 v23, 64, v23
v_mfma_f32_16x16x32_bf16 v[48:51], v[64:67], v[112:115], v[48:51]
v_subrev_u32 v24, 64, v24
v_mfma_f32_16x16x32_bf16 v[52:55], v[64:67], v[116:119], v[52:55]
ds_read_b128 v[160:163], v24 offset:0
v_mfma_f32_16x16x32_bf16 v[56:59], v[64:67], v[120:123], v[56:59]
ds_read2_b32 v[128:129], v20 offset0:128 offset1:129
v_mfma_f32_16x16x32_bf16 v[60:63], v[64:67], v[124:127], v[60:63]
ds_read2_b32 v[130:131], v20 offset0:130 offset1:131
v_mfma_f32_16x16x32_bf16 v[36:39], v[68:71], v[96:99], v[36:39]
ds_read_b128 v[164:167], v24 offset:512
v_mfma_f32_16x16x32_bf16 v[40:43], v[68:71], v[100:103], v[40:43]
ds_read2_b32 v[132:133], v20 offset0:0 offset1:1
v_mfma_f32_16x16x32_bf16 v[44:47], v[68:71], v[104:107], v[44:47]
ds_read2_b32 v[134:135], v20 offset0:2 offset1:3
v_mfma_f32_16x16x32_bf16 v[48:51], v[68:71], v[108:111], v[48:51]
ds_read_b128 v[168:171], v24 offset:1024
v_mfma_f32_16x16x32_bf16 v[52:55], v[68:71], v[112:115], v[52:55]
ds_read2_b32 v[136:137], v21 offset0:128 offset1:129
v_mfma_f32_16x16x32_bf16 v[56:59], v[68:71], v[116:119], v[56:59]
ds_read2_b32 v[138:139], v21 offset0:130 offset1:131
v_mfma_f32_16x16x32_bf16 v[60:63], v[68:71], v[120:123], v[60:63]
ds_read_b128 v[172:175], v24 offset:1536
v_mfma_f32_16x16x32_bf16 v[40:43], v[72:75], v[96:99], v[40:43]
ds_read2_b32 v[140:141], v21 offset0:0 offset1:1
v_mfma_f32_16x16x32_bf16 v[44:47], v[72:75], v[100:103], v[44:47]
ds_read2_b32 v[142:143], v21 offset0:2 offset1:3
v_mfma_f32_16x16x32_bf16 v[48:51], v[72:75], v[104:107], v[48:51]
ds_read_b128 v[176:179], v24 offset:2048
v_mfma_f32_16x16x32_bf16 v[52:55], v[72:75], v[108:111], v[52:55]
ds_read2_b32 v[144:145], v22 offset0:128 offset1:129
v_mfma_f32_16x16x32_bf16 v[56:59], v[72:75], v[112:115], v[56:59]
ds_read2_b32 v[146:147], v22 offset0:130 offset1:131
v_mfma_f32_16x16x32_bf16 v[60:63], v[72:75], v[116:119], v[60:63]
ds_read_b128 v[180:183], v24 offset:2560
v_mfma_f32_16x16x32_bf16 v[44:47], v[76:79], v[96:99], v[44:47]
ds_read2_b32 v[148:149], v22 offset0:0 offset1:1
v_mfma_f32_16x16x32_bf16 v[48:51], v[76:79], v[100:103], v[48:51]
ds_read2_b32 v[150:151], v22 offset0:2 offset1:3
v_mfma_f32_16x16x32_bf16 v[52:55], v[76:79], v[104:107], v[52:55]
ds_read_b128 v[184:187], v24 offset:3072
v_mfma_f32_16x16x32_bf16 v[56:59], v[76:79], v[108:111], v[56:59]
ds_read2_b32 v[152:153], v23 offset0:128 offset1:129
v_mfma_f32_16x16x32_bf16 v[60:63], v[76:79], v[112:115], v[60:63]
ds_read2_b32 v[154:155], v23 offset0:130 offset1:131
v_mfma_f32_16x16x32_bf16 v[48:51], v[80:83], v[96:99], v[48:51]
ds_read_b128 v[188:191], v24 offset:3584
v_mfma_f32_16x16x32_bf16 v[52:55], v[80:83], v[100:103], v[52:55]
ds_read2_b32 v[156:157], v23 offset0:0 offset1:1
v_mfma_f32_16x16x32_bf16 v[56:59], v[80:83], v[104:107], v[56:59]
ds_read2_b32 v[158:159], v23 offset0:2 offset1:3
v_mfma_f32_16x16x32_bf16 v[60:63], v[80:83], v[108:111], v[60:63]
v_mfma_f32_16x16x32_bf16 v[52:55], v[84:87], v[96:99], v[52:55]
v_mfma_f32_16x16x32_bf16 v[56:59], v[84:87], v[100:103], v[56:59]
v_mfma_f32_16x16x32_bf16 v[60:63], v[84:87], v[104:107], v[60:63]
v_mfma_f32_16x16x32_bf16 v[56:59], v[88:91], v[96:99], v[56:59]
v_mfma_f32_16x16x32_bf16 v[60:63], v[88:91], v[100:103], v[60:63]
v_mfma_f32_16x16x32_bf16 v[60:63], v[92:95], v[96:99], v[60:63]
s_waitcnt lgkmcnt(0)
v_mfma_f32_16x16x32_bf16 v[32:35], v[128:131], v[160:163], v[32:35]
v_mfma_f32_16x16x32_bf16 v[36:39], v[128:131], v[164:167], v[36:39]
v_mfma_f32_16x16x32_bf16 v[40:43], v[128:131], v[168:171], v[40:43]
v_mfma_f32_16x16x32_bf16 v[44:47], v[128:131], v[172:175], v[44:47]
v_mfma_f32_16x16x32_bf16 v[48:51], v[128:131], v[176:179], v[48:51]
v_mfma_f32_16x16x32_bf16 v[52:55], v[128:131], v[180:183], v[52:55]
v_mfma_f32_16x16x32_bf16 v[56:59], v[128:131], v[184:187], v[56:59]
v_mfma_f32_16x16x32_bf16 v[60:63], v[128:131], v[188:191], v[60:63]
v_mfma_f32_16x16x32_bf16 v[36:39], v[132:135], v[160:163], v[36:39]
v_mfma_f32_16x16x32_bf16 v[40:43], v[132:135], v[164:167], v[40:43]
v_mfma_f32_16x16x32_bf16 v[44:47], v[132:135], v[168:171], v[44:47]
v_mfma_f32_16x16x32_bf16 v[48:51], v[132:135], v[172:175], v[48:51]
v_mfma_f32_16x16x32_bf16 v[52:55], v[132:135], v[176:179], v[52:55]
v_mfma_f32_16x16x32_bf16 v[56:59], v[132:135], v[180:183], v[56:59]
v_mfma_f32_16x16x32_bf16 v[60:63], v[132:135], v[184:187], v[60:63]
v_mfma_f32_16x16x32_bf16 v[40:43], v[136:139], v[160:163], v[40:43]
v_mfma_f32_16x16x32_bf16 v[44:47], v[136:139], v[164:167], v[44:47]
v_mfma_f32_16x16x32_bf16 v[48:51], v[136:139], v[168:171], v[48:51]
v_mfma_f32_16x16x32_bf16 v[52:55], v[136:139], v[172:175], v[52:55]
v_mfma_f32_16x16x32_bf16 v[56:59], v[136:139], v[176:179], v[56:59]
v_mfma_f32_16x16x32_bf16 v[60:63], v[136:139], v[180:183], v[60:63]
v_mfma_f32_16x16x32_bf16 v[44:47], v[140:143], v[160:163], v[44:47]
v_mfma_f32_16x16x32_bf16 v[48:51], v[140:143], v[164:167], v[48:51]
v_mfma_f32_16x16x32_bf16 v[52:55], v[140:143], v[168:171], v[52:55]
v_mfma_f32_16x16x32_bf16 v[56:59], v[140:143], v[172:175], v[56:59]
v_mfma_f32_16x16x32_bf16 v[60:63], v[140:143], v[176:179], v[60:63]
v_mfma_f32_16x16x32_bf16 v[48:51], v[144:147], v[160:163], v[48:51]
v_mfma_f32_16x16x32_bf16 v[52:55], v[144:147], v[164:167], v[52:55]
v_mfma_f32_16x16x32_bf16 v[56:59], v[144:147], v[168:171], v[56:59]
v_mfma_f32_16x16x32_bf16 v[60:63], v[144:147], v[172:175], v[60:63]
v_mfma_f32_16x16x32_bf16 v[52:55], v[148:151], v[160:163], v[52:55]
v_mfma_f32_16x16x32_bf16 v[56:59], v[148:151], v[164:167], v[56:59]
v_mfma_f32_16x16x32_bf16 v[60:63], v[148:151], v[168:171], v[60:63]
v_mfma_f32_16x16x32_bf16 v[56:59], v[152:155], v[160:163], v[56:59]
v_mfma_f32_16x16x32_bf16 v[60:63], v[152:155], v[164:167], v[60:63]
v_mfma_f32_16x16x32_bf16 v[60:63], v[156:159], v[160:163], v[60:63]
s_add_u32 s68, s36, 0x1440000
s_addc_u32 s69, s37, 0
s_mov_b32 s70, 0x240000
s_mov_b32 s71, 0x20000
s_lshl_b32 s72, s80, 12
s_nop 2
v_cvt_pk_bf16_f32 v64, v32, v33
v_cvt_pk_bf16_f32 v65, v34, v35
v_cvt_pk_bf16_f32 v66, v36, v37
v_cvt_pk_bf16_f32 v67, v38, v39
v_cvt_pk_bf16_f32 v68, v40, v41
v_cvt_pk_bf16_f32 v69, v42, v43
v_cvt_pk_bf16_f32 v70, v44, v45
v_cvt_pk_bf16_f32 v71, v46, v47
v_cvt_pk_bf16_f32 v72, v48, v49
v_cvt_pk_bf16_f32 v73, v50, v51
v_cvt_pk_bf16_f32 v74, v52, v53
v_cvt_pk_bf16_f32 v75, v54, v55
v_cvt_pk_bf16_f32 v76, v56, v57
v_cvt_pk_bf16_f32 v77, v58, v59
v_cvt_pk_bf16_f32 v78, v60, v61
v_cvt_pk_bf16_f32 v79, v62, v63
s_nop 1
v_permlane16_swap_b32 v64, v66
v_permlane16_swap_b32 v65, v67
v_permlane16_swap_b32 v68, v70
v_permlane16_swap_b32 v69, v71
v_permlane16_swap_b32 v72, v74
v_permlane16_swap_b32 v73, v75
v_permlane16_swap_b32 v76, v78
v_permlane16_swap_b32 v77, v79
buffer_store_dwordx4 v[64:67], v1, s[68:71], s72 offen offset:0 sc1
buffer_store_dwordx4 v[68:71], v1, s[68:71], s72 offen offset:1024 sc1
buffer_store_dwordx4 v[72:75], v1, s[68:71], s72 offen offset:2048 sc1
buffer_store_dwordx4 v[76:79], v1, s[68:71], s72 offen offset:3072 sc1
s_waitcnt vmcnt(0)
s_lshl_b32 s60, s80, 2
s_add_u32 s60, s60, 6144
s_mov_b64 exec, 1
v_mov_b32 v14, s60
v_mov_b32 v15, s100
buffer_store_dword v15, v14, s[84:87], 0 offen sc1
s_mov_b64 exec, -1
Lend:
s_endpgm
.section .rodata,"a"
.p2align 6
.amdhsa_kernel gated_mix__ssm_conv_s4__swiglu_ffn__prompt_kernel
  .amdhsa_next_free_vgpr 256
  .amdhsa_next_free_sgpr 102
  .amdhsa_accum_offset 256
  .amdhsa_group_segment_fixed_size 0
  .amdhsa_kernarg_size 136
  .amdhsa_user_sgpr_count 2
  .amdhsa_user_sgpr_kernarg_segment_ptr 1
  .amdhsa_system_sgpr_workgroup_id_x 1
  .amdhsa_float_denorm_mode_32 3
.end_amdhsa_kernel
```
